```python
import torch

def _softmax(x, axis=-1):
    return torch.softmax(x, dim=axis)

def _gelu(x):
    return torch.nn.functional.gelu(x, approximate='tanh')

def _silu(x):
    return torch.nn.functional.silu(x)

def _sigmoid(x):
    return torch.sigmoid(x)

def _layernorm(x, axis=-1, eps=1e-05):
    m = x.mean(dim=axis, keepdim=True)
    v = x.var(dim=axis, keepdim=True, unbiased=False)
    return (x - m) / torch.sqrt(v + eps)

def _scatter_add(tgt, idx, src, axis=0):
    return tgt.clone().index_add_(axis, idx, src)

def _segment_sum(src, seg, n):
    out = torch.zeros((n,) + src.shape[1:], dtype=src.dtype)
    return out.index_add_(0, seg, src)

def _pad(x, pw):
    flat = tuple((v for pair in reversed(pw) for v in pair))
    return torch.nn.functional.pad(x, flat)
kernel_name = 'adaLN_cond__sliding_local_dilated__glu_gated_geglu__prompt'

def setup_inputs():

    _w = lambda a: (lambda t: t.to(torch.bfloat16) if t.is_floating_point() else t)(torch.as_tensor(a))

    def _A_setup():
        B, S, D = (1, 2048, 512)
        return {'x': _w((lambda *s: torch.randn(*s, dtype=torch.bfloat16) * 0.05)(B, S, D)), 'wqkv': _w((lambda *s: torch.randn(*s, dtype=torch.bfloat16) * 0.05)(D, 3 * D)), 'wo': _w((lambda *s: torch.randn(*s, dtype=torch.bfloat16) * 0.05)(D, D))}
    _A_in = _A_setup()

    def _B_setup():
        B, S, Dm, Df = (1, 2048, 512, 1792)
        return {'x': _w((lambda *s: torch.randn(*s, dtype=torch.bfloat16) * 0.05)(B, S, Dm)), 'w_gate': _w((lambda *s: torch.randn(*s, dtype=torch.bfloat16) * 0.8)(Dm, Df) * Dm ** (-0.5)), 'w_up': _w((lambda *s: torch.randn(*s, dtype=torch.bfloat16) * 0.8)(Dm, Df) * Dm ** (-0.5)), 'w_down': _w((lambda *s: torch.randn(*s, dtype=torch.bfloat16) * 0.8)(Df, Dm) * Df ** (-0.5))}
    _B_in = _B_setup()
    return {'A_x': _A_in['x'], 'A_wqkv': _A_in['wqkv'], 'A_wo': _A_in['wo'], 'B_x': _B_in['x'], 'B_w_gate': _B_in['w_gate'], 'B_w_up': _B_in['w_up'], 'B_w_down': _B_in['w_down'], 'c': _w((lambda *s: torch.randn(*s, dtype=torch.bfloat16) * 0.2)(1, 512) * 8.0), 'w_mod': _w((lambda *s: torch.randn(*s, dtype=torch.bfloat16) * 0.2)(512, 6 * 512) * 512 ** (-0.5) * 8.0)}

def reference(A_x, A_wqkv, A_wo, B_x, B_w_gate, B_w_up, B_w_down, c, w_mod):

    def _A_ref(x, wqkv, wo):
        B, S, D = x.shape
        H = 32
        Dh = D // H
        W, dil = (8, 2)
        qkv = (lambda x, *d: x.permute(*d))((x @ wqkv).reshape(B, S, 3, H, Dh), 2, 0, 3, 1, 4)
        q, k, v = (qkv[0], qkv[1], qkv[2])
        scale = Dh ** (-0.5)
        pos = torch.arange(S)
        off = torch.arange(W) * dil
        idx = pos[:, None] - off[None, :]
        mask = idx >= 0
        idx_c = torch.where(mask, idx, 0).reshape(-1)
        kg = k[:, :, idx_c, :].reshape(B, H, S, W, Dh)
        vg = v[:, :, idx_c, :].reshape(B, H, S, W, Dh)
        logits = torch.einsum('bhsd,bhswd->bhsw', q, kg) * scale
        logits = torch.where(mask[None, None, :, :], logits, -1000000000.0)
        attn = _softmax(logits, axis=-1)
        o = torch.einsum('bhsw,bhswd->bhsd', attn, vg)
        return (lambda x, *d: x.permute(*d))(o, 0, 2, 1, 3).reshape(B, S, D) @ wo

    def _B_ref(x, w_gate, w_up, w_down):
        g = torch.einsum('bsd,df->bsf', x, w_gate)
        u = torch.einsum('bsd,df->bsf', x, w_up)
        h = _gelu(g) * u
        return torch.einsum('bsf,fd->bsd', h, w_down)
    x = A_x
    mod = (_silu(c) @ w_mod).reshape(c.shape[0], 6, 1, -1)
    sa, ca, ga, sb, cb, gb = (mod[:, 0].clone(), mod[:, 1].clone(), mod[:, 2].clone(), mod[:, 3].clone(), mod[:, 4].clone(), mod[:, 5].clone())
    h = _layernorm(x, axis=-1) * (1 + ca) + sa
    x = x + ga * _A_ref(h, A_wqkv, A_wo)
    h = _layernorm(x, axis=-1) * (1 + cb) + sb
    x = x + gb * _B_ref(h, B_w_gate, B_w_up, B_w_down)
    return x
```

```asm
; @launch kernel=k0_kernel grid=(256,1,1) block=(256,1,1) lds=4096
; @launch kernel=k1_kernel grid=(256,1,1) block=(256,1,1) lds=103424
; @launch kernel=k2_kernel grid=(256,1,1) block=(256,1,1) lds=131072
; @launch kernel=k3_kernel grid=(256,1,1) block=(256,1,1) lds=143360
; @launch kernel=k4_kernel grid=(256,1,1) block=(256,1,1) lds=131072
.amdgcn_target "amdgcn-amd-amdhsa--gfx950"
.text
.globl k0_kernel
.type k0_kernel,@function
.p2align 8
k0_kernel:
    s_cmp_ge_u32 s2, 256
    s_cbranch_scc1 k0_end
    s_cmp_ge_u32 s2, 160
    s_cbranch_scc1 k0_warm
    s_cmp_ge_u32 s2, 96
    s_cbranch_scc1 k0_stats
    s_load_dwordx4 s[4:7], s[0:1], 56
    s_load_dwordx2 s[8:9], s[0:1], 88
    v_and_b32 v1, 15, v0
    v_lshrrev_b32 v2, 4, v0
    v_mul_u32_u24 v3, 0x30000, v2
    v_lshlrev_b32 v4, 2, v1
    v_add_u32 v3, v3, v4
    s_lshl_b32 s3, s2, 6
    v_add_u32 v3, s3, v3
    v_lshlrev_b32 v5, 2, v0
    s_waitcnt lgkmcnt(0)
    s_mov_b32 s12, s4
    s_mov_b32 s13, s5
    s_mov_b32 s14, 1024
    s_mov_b32 s15, 0x20000
    s_mov_b32 s16, s6
    s_mov_b32 s17, s7
    s_mov_b32 s18, 3145728
    s_mov_b32 s19, 0x20000
    s_mov_b32 s20, s8
    s_mov_b32 s21, s9
    s_mov_b32 s22, 12288
    s_mov_b32 s23, 0x20000
    buffer_load_dword v6, v5, s[12:15], 0 offen
    s_mov_b32 s24, 0
    buffer_load_dword v32, v3, s[16:19], s24 offen
    s_mov_b32 s24, 6144
    buffer_load_dword v33, v3, s[16:19], s24 offen
    s_mov_b32 s24, 12288
    buffer_load_dword v34, v3, s[16:19], s24 offen
    s_mov_b32 s24, 18432
    buffer_load_dword v35, v3, s[16:19], s24 offen
    s_mov_b32 s24, 24576
    buffer_load_dword v36, v3, s[16:19], s24 offen
    s_mov_b32 s24, 30720
    buffer_load_dword v37, v3, s[16:19], s24 offen
    s_mov_b32 s24, 36864
    buffer_load_dword v38, v3, s[16:19], s24 offen
    s_mov_b32 s24, 43008
    buffer_load_dword v39, v3, s[16:19], s24 offen
    s_mov_b32 s24, 49152
    buffer_load_dword v40, v3, s[16:19], s24 offen
    s_mov_b32 s24, 55296
    buffer_load_dword v41, v3, s[16:19], s24 offen
    s_mov_b32 s24, 61440
    buffer_load_dword v42, v3, s[16:19], s24 offen
    s_mov_b32 s24, 67584
    buffer_load_dword v43, v3, s[16:19], s24 offen
    s_mov_b32 s24, 73728
    buffer_load_dword v44, v3, s[16:19], s24 offen
    s_mov_b32 s24, 79872
    buffer_load_dword v45, v3, s[16:19], s24 offen
    s_mov_b32 s24, 86016
    buffer_load_dword v46, v3, s[16:19], s24 offen
    s_mov_b32 s24, 92160
    buffer_load_dword v47, v3, s[16:19], s24 offen
    s_mov_b32 s24, 98304
    buffer_load_dword v48, v3, s[16:19], s24 offen
    s_mov_b32 s24, 104448
    buffer_load_dword v49, v3, s[16:19], s24 offen
    s_mov_b32 s24, 110592
    buffer_load_dword v50, v3, s[16:19], s24 offen
    s_mov_b32 s24, 116736
    buffer_load_dword v51, v3, s[16:19], s24 offen
    s_mov_b32 s24, 122880
    buffer_load_dword v52, v3, s[16:19], s24 offen
    s_mov_b32 s24, 129024
    buffer_load_dword v53, v3, s[16:19], s24 offen
    s_mov_b32 s24, 135168
    buffer_load_dword v54, v3, s[16:19], s24 offen
    s_mov_b32 s24, 141312
    buffer_load_dword v55, v3, s[16:19], s24 offen
    s_mov_b32 s24, 147456
    buffer_load_dword v56, v3, s[16:19], s24 offen
    s_mov_b32 s24, 153600
    buffer_load_dword v57, v3, s[16:19], s24 offen
    s_mov_b32 s24, 159744
    buffer_load_dword v58, v3, s[16:19], s24 offen
    s_mov_b32 s24, 165888
    buffer_load_dword v59, v3, s[16:19], s24 offen
    s_mov_b32 s24, 172032
    buffer_load_dword v60, v3, s[16:19], s24 offen
    s_mov_b32 s24, 178176
    buffer_load_dword v61, v3, s[16:19], s24 offen
    s_mov_b32 s24, 184320
    buffer_load_dword v62, v3, s[16:19], s24 offen
    s_mov_b32 s24, 190464
    buffer_load_dword v63, v3, s[16:19], s24 offen
    s_waitcnt vmcnt(32)
    v_lshlrev_b32 v7, 16, v6
    v_and_b32 v8, 0xffff0000, v6
    v_mul_f32 v9, 0xbfb8aa3b, v7
    v_exp_f32 v9, v9
    s_nop 0
    v_add_f32 v9, 1.0, v9
    v_rcp_f32 v9, v9
    s_nop 0
    v_mul_f32 v7, v7, v9
    v_mul_f32 v9, 0xbfb8aa3b, v8
    v_exp_f32 v9, v9
    s_nop 0
    v_add_f32 v9, 1.0, v9
    v_rcp_f32 v9, v9
    s_nop 0
    v_mul_f32 v8, v8, v9
    v_cvt_pk_bf16_f32 v9, v7, v8
    v_lshlrev_b32 v10, 16, v9
    v_and_b32 v11, 0xffff0000, v9
    v_lshlrev_b32 v12, 3, v0
    ds_write_b64 v12, v[10:11]
    s_waitcnt lgkmcnt(0)
    s_barrier
    v_lshlrev_b32 v12, 7, v2
    ds_read_b128 v[64:67], v12 offset:0
    ds_read_b128 v[68:71], v12 offset:16
    ds_read_b128 v[72:75], v12 offset:32
    ds_read_b128 v[76:79], v12 offset:48
    ds_read_b128 v[80:83], v12 offset:64
    ds_read_b128 v[84:87], v12 offset:80
    ds_read_b128 v[88:91], v12 offset:96
    ds_read_b128 v[92:95], v12 offset:112
    v_mov_b32 v18, 0
    v_mov_b32 v19, 0
    s_waitcnt vmcnt(0) lgkmcnt(0)
    v_lshlrev_b32 v15, 16, v32
    v_and_b32 v16, 0xffff0000, v32
    v_fmac_f32 v18, v64, v15
    v_fmac_f32 v19, v64, v16
    v_lshlrev_b32 v15, 16, v33
    v_and_b32 v16, 0xffff0000, v33
    v_fmac_f32 v18, v65, v15
    v_fmac_f32 v19, v65, v16
    v_lshlrev_b32 v15, 16, v34
    v_and_b32 v16, 0xffff0000, v34
    v_fmac_f32 v18, v66, v15
    v_fmac_f32 v19, v66, v16
    v_lshlrev_b32 v15, 16, v35
    v_and_b32 v16, 0xffff0000, v35
    v_fmac_f32 v18, v67, v15
    v_fmac_f32 v19, v67, v16
    v_lshlrev_b32 v15, 16, v36
    v_and_b32 v16, 0xffff0000, v36
    v_fmac_f32 v18, v68, v15
    v_fmac_f32 v19, v68, v16
    v_lshlrev_b32 v15, 16, v37
    v_and_b32 v16, 0xffff0000, v37
    v_fmac_f32 v18, v69, v15
    v_fmac_f32 v19, v69, v16
    v_lshlrev_b32 v15, 16, v38
    v_and_b32 v16, 0xffff0000, v38
    v_fmac_f32 v18, v70, v15
    v_fmac_f32 v19, v70, v16
    v_lshlrev_b32 v15, 16, v39
    v_and_b32 v16, 0xffff0000, v39
    v_fmac_f32 v18, v71, v15
    v_fmac_f32 v19, v71, v16
    v_lshlrev_b32 v15, 16, v40
    v_and_b32 v16, 0xffff0000, v40
    v_fmac_f32 v18, v72, v15
    v_fmac_f32 v19, v72, v16
    v_lshlrev_b32 v15, 16, v41
    v_and_b32 v16, 0xffff0000, v41
    v_fmac_f32 v18, v73, v15
    v_fmac_f32 v19, v73, v16
    v_lshlrev_b32 v15, 16, v42
    v_and_b32 v16, 0xffff0000, v42
    v_fmac_f32 v18, v74, v15
    v_fmac_f32 v19, v74, v16
    v_lshlrev_b32 v15, 16, v43
    v_and_b32 v16, 0xffff0000, v43
    v_fmac_f32 v18, v75, v15
    v_fmac_f32 v19, v75, v16
    v_lshlrev_b32 v15, 16, v44
    v_and_b32 v16, 0xffff0000, v44
    v_fmac_f32 v18, v76, v15
    v_fmac_f32 v19, v76, v16
    v_lshlrev_b32 v15, 16, v45
    v_and_b32 v16, 0xffff0000, v45
    v_fmac_f32 v18, v77, v15
    v_fmac_f32 v19, v77, v16
    v_lshlrev_b32 v15, 16, v46
    v_and_b32 v16, 0xffff0000, v46
    v_fmac_f32 v18, v78, v15
    v_fmac_f32 v19, v78, v16
    v_lshlrev_b32 v15, 16, v47
    v_and_b32 v16, 0xffff0000, v47
    v_fmac_f32 v18, v79, v15
    v_fmac_f32 v19, v79, v16
    v_lshlrev_b32 v15, 16, v48
    v_and_b32 v16, 0xffff0000, v48
    v_fmac_f32 v18, v80, v15
    v_fmac_f32 v19, v80, v16
    v_lshlrev_b32 v15, 16, v49
    v_and_b32 v16, 0xffff0000, v49
    v_fmac_f32 v18, v81, v15
    v_fmac_f32 v19, v81, v16
    v_lshlrev_b32 v15, 16, v50
    v_and_b32 v16, 0xffff0000, v50
    v_fmac_f32 v18, v82, v15
    v_fmac_f32 v19, v82, v16
    v_lshlrev_b32 v15, 16, v51
    v_and_b32 v16, 0xffff0000, v51
    v_fmac_f32 v18, v83, v15
    v_fmac_f32 v19, v83, v16
    v_lshlrev_b32 v15, 16, v52
    v_and_b32 v16, 0xffff0000, v52
    v_fmac_f32 v18, v84, v15
    v_fmac_f32 v19, v84, v16
    v_lshlrev_b32 v15, 16, v53
    v_and_b32 v16, 0xffff0000, v53
    v_fmac_f32 v18, v85, v15
    v_fmac_f32 v19, v85, v16
    v_lshlrev_b32 v15, 16, v54
    v_and_b32 v16, 0xffff0000, v54
    v_fmac_f32 v18, v86, v15
    v_fmac_f32 v19, v86, v16
    v_lshlrev_b32 v15, 16, v55
    v_and_b32 v16, 0xffff0000, v55
    v_fmac_f32 v18, v87, v15
    v_fmac_f32 v19, v87, v16
    v_lshlrev_b32 v15, 16, v56
    v_and_b32 v16, 0xffff0000, v56
    v_fmac_f32 v18, v88, v15
    v_fmac_f32 v19, v88, v16
    v_lshlrev_b32 v15, 16, v57
    v_and_b32 v16, 0xffff0000, v57
    v_fmac_f32 v18, v89, v15
    v_fmac_f32 v19, v89, v16
    v_lshlrev_b32 v15, 16, v58
    v_and_b32 v16, 0xffff0000, v58
    v_fmac_f32 v18, v90, v15
    v_fmac_f32 v19, v90, v16
    v_lshlrev_b32 v15, 16, v59
    v_and_b32 v16, 0xffff0000, v59
    v_fmac_f32 v18, v91, v15
    v_fmac_f32 v19, v91, v16
    v_lshlrev_b32 v15, 16, v60
    v_and_b32 v16, 0xffff0000, v60
    v_fmac_f32 v18, v92, v15
    v_fmac_f32 v19, v92, v16
    v_lshlrev_b32 v15, 16, v61
    v_and_b32 v16, 0xffff0000, v61
    v_fmac_f32 v18, v93, v15
    v_fmac_f32 v19, v93, v16
    v_lshlrev_b32 v15, 16, v62
    v_and_b32 v16, 0xffff0000, v62
    v_fmac_f32 v18, v94, v15
    v_fmac_f32 v19, v94, v16
    v_lshlrev_b32 v15, 16, v63
    v_and_b32 v16, 0xffff0000, v63
    v_fmac_f32 v18, v95, v15
    v_fmac_f32 v19, v95, v16
    v_lshlrev_b32 v12, 4, v2
    v_add_u32 v12, v12, v1
    v_lshlrev_b32 v12, 3, v12
    ds_write_b64 v12, v[18:19] offset:2048
    s_waitcnt lgkmcnt(0)
    s_barrier
    v_cmp_gt_u32 vcc, 16, v0
    s_and_saveexec_b64 s[26:27], vcc
    s_cbranch_execz k0_end
    v_lshlrev_b32 v12, 3, v0
    ds_read_b64 v[32:33], v12 offset:2048
    ds_read_b64 v[34:35], v12 offset:2176
    ds_read_b64 v[36:37], v12 offset:2304
    ds_read_b64 v[38:39], v12 offset:2432
    ds_read_b64 v[40:41], v12 offset:2560
    ds_read_b64 v[42:43], v12 offset:2688
    ds_read_b64 v[44:45], v12 offset:2816
    ds_read_b64 v[46:47], v12 offset:2944
    ds_read_b64 v[48:49], v12 offset:3072
    ds_read_b64 v[50:51], v12 offset:3200
    ds_read_b64 v[52:53], v12 offset:3328
    ds_read_b64 v[54:55], v12 offset:3456
    ds_read_b64 v[56:57], v12 offset:3584
    ds_read_b64 v[58:59], v12 offset:3712
    ds_read_b64 v[60:61], v12 offset:3840
    ds_read_b64 v[62:63], v12 offset:3968
    s_waitcnt lgkmcnt(0)
    v_add_f32 v32, v32, v34
    v_add_f32 v33, v33, v35
    v_add_f32 v32, v32, v36
    v_add_f32 v33, v33, v37
    v_add_f32 v32, v32, v38
    v_add_f32 v33, v33, v39
    v_add_f32 v32, v32, v40
    v_add_f32 v33, v33, v41
    v_add_f32 v32, v32, v42
    v_add_f32 v33, v33, v43
    v_add_f32 v32, v32, v44
    v_add_f32 v33, v33, v45
    v_add_f32 v32, v32, v46
    v_add_f32 v33, v33, v47
    v_add_f32 v32, v32, v48
    v_add_f32 v33, v33, v49
    v_add_f32 v32, v32, v50
    v_add_f32 v33, v33, v51
    v_add_f32 v32, v32, v52
    v_add_f32 v33, v33, v53
    v_add_f32 v32, v32, v54
    v_add_f32 v33, v33, v55
    v_add_f32 v32, v32, v56
    v_add_f32 v33, v33, v57
    v_add_f32 v32, v32, v58
    v_add_f32 v33, v33, v59
    v_add_f32 v32, v32, v60
    v_add_f32 v33, v33, v61
    v_add_f32 v32, v32, v62
    v_add_f32 v33, v33, v63
    v_cvt_pk_bf16_f32 v9, v32, v33
    v_lshlrev_b32 v10, 16, v9
    v_and_b32 v11, 0xffff0000, v9
    s_lshl_b32 s3, s2, 7
    v_lshlrev_b32 v12, 3, v0
    v_add_u32 v12, s3, v12
    buffer_store_dwordx2 v[10:11], v12, s[20:23], 0 offen
    s_branch k0_end
k0_stats:
    s_load_dwordx2 s[4:5], s[0:1], 0
    s_load_dwordx2 s[8:9], s[0:1], 88
    s_sub_u32 s3, s2, 96
    s_lshl_b32 s3, s3, 5
    v_lshrrev_b32 v1, 3, v0
    v_add_u32 v1, s3, v1
    v_and_b32 v2, 7, v0
    v_lshlrev_b32 v3, 10, v1
    v_lshlrev_b32 v4, 4, v2
    v_add_u32 v3, v3, v4
    s_waitcnt lgkmcnt(0)
    s_mov_b32 s12, s4
    s_mov_b32 s13, s5
    s_mov_b32 s14, 2097152
    s_mov_b32 s15, 0x20000
    s_add_u32 s20, s8, 16384
    s_addc_u32 s21, s9, 0
    s_mov_b32 s22, 16384
    s_mov_b32 s23, 0x20000
    buffer_load_dwordx4 v[16:19], v3, s[12:15], 0 offen offset:0
    buffer_load_dwordx4 v[20:23], v3, s[12:15], 0 offen offset:128
    buffer_load_dwordx4 v[24:27], v3, s[12:15], 0 offen offset:256
    buffer_load_dwordx4 v[28:31], v3, s[12:15], 0 offen offset:384
    buffer_load_dwordx4 v[32:35], v3, s[12:15], 0 offen offset:512
    buffer_load_dwordx4 v[36:39], v3, s[12:15], 0 offen offset:640
    buffer_load_dwordx4 v[40:43], v3, s[12:15], 0 offen offset:768
    buffer_load_dwordx4 v[44:47], v3, s[12:15], 0 offen offset:896
    v_mov_b32 v5, 0
    s_waitcnt vmcnt(0)
    v_lshlrev_b32 v6, 16, v16
    v_and_b32 v7, 0xffff0000, v16
    v_add_f32 v5, v5, v6
    v_add_f32 v5, v5, v7
    v_lshlrev_b32 v6, 16, v17
    v_and_b32 v7, 0xffff0000, v17
    v_add_f32 v5, v5, v6
    v_add_f32 v5, v5, v7
    v_lshlrev_b32 v6, 16, v18
    v_and_b32 v7, 0xffff0000, v18
    v_add_f32 v5, v5, v6
    v_add_f32 v5, v5, v7
    v_lshlrev_b32 v6, 16, v19
    v_and_b32 v7, 0xffff0000, v19
    v_add_f32 v5, v5, v6
    v_add_f32 v5, v5, v7
    v_lshlrev_b32 v6, 16, v20
    v_and_b32 v7, 0xffff0000, v20
    v_add_f32 v5, v5, v6
    v_add_f32 v5, v5, v7
    v_lshlrev_b32 v6, 16, v21
    v_and_b32 v7, 0xffff0000, v21
    v_add_f32 v5, v5, v6
    v_add_f32 v5, v5, v7
    v_lshlrev_b32 v6, 16, v22
    v_and_b32 v7, 0xffff0000, v22
    v_add_f32 v5, v5, v6
    v_add_f32 v5, v5, v7
    v_lshlrev_b32 v6, 16, v23
    v_and_b32 v7, 0xffff0000, v23
    v_add_f32 v5, v5, v6
    v_add_f32 v5, v5, v7
    v_lshlrev_b32 v6, 16, v24
    v_and_b32 v7, 0xffff0000, v24
    v_add_f32 v5, v5, v6
    v_add_f32 v5, v5, v7
    v_lshlrev_b32 v6, 16, v25
    v_and_b32 v7, 0xffff0000, v25
    v_add_f32 v5, v5, v6
    v_add_f32 v5, v5, v7
    v_lshlrev_b32 v6, 16, v26
    v_and_b32 v7, 0xffff0000, v26
    v_add_f32 v5, v5, v6
    v_add_f32 v5, v5, v7
    v_lshlrev_b32 v6, 16, v27
    v_and_b32 v7, 0xffff0000, v27
    v_add_f32 v5, v5, v6
    v_add_f32 v5, v5, v7
    v_lshlrev_b32 v6, 16, v28
    v_and_b32 v7, 0xffff0000, v28
    v_add_f32 v5, v5, v6
    v_add_f32 v5, v5, v7
    v_lshlrev_b32 v6, 16, v29
    v_and_b32 v7, 0xffff0000, v29
    v_add_f32 v5, v5, v6
    v_add_f32 v5, v5, v7
    v_lshlrev_b32 v6, 16, v30
    v_and_b32 v7, 0xffff0000, v30
    v_add_f32 v5, v5, v6
    v_add_f32 v5, v5, v7
    v_lshlrev_b32 v6, 16, v31
    v_and_b32 v7, 0xffff0000, v31
    v_add_f32 v5, v5, v6
    v_add_f32 v5, v5, v7
    v_lshlrev_b32 v6, 16, v32
    v_and_b32 v7, 0xffff0000, v32
    v_add_f32 v5, v5, v6
    v_add_f32 v5, v5, v7
    v_lshlrev_b32 v6, 16, v33
    v_and_b32 v7, 0xffff0000, v33
    v_add_f32 v5, v5, v6
    v_add_f32 v5, v5, v7
    v_lshlrev_b32 v6, 16, v34
    v_and_b32 v7, 0xffff0000, v34
    v_add_f32 v5, v5, v6
    v_add_f32 v5, v5, v7
    v_lshlrev_b32 v6, 16, v35
    v_and_b32 v7, 0xffff0000, v35
    v_add_f32 v5, v5, v6
    v_add_f32 v5, v5, v7
    v_lshlrev_b32 v6, 16, v36
    v_and_b32 v7, 0xffff0000, v36
    v_add_f32 v5, v5, v6
    v_add_f32 v5, v5, v7
    v_lshlrev_b32 v6, 16, v37
    v_and_b32 v7, 0xffff0000, v37
    v_add_f32 v5, v5, v6
    v_add_f32 v5, v5, v7
    v_lshlrev_b32 v6, 16, v38
    v_and_b32 v7, 0xffff0000, v38
    v_add_f32 v5, v5, v6
    v_add_f32 v5, v5, v7
    v_lshlrev_b32 v6, 16, v39
    v_and_b32 v7, 0xffff0000, v39
    v_add_f32 v5, v5, v6
    v_add_f32 v5, v5, v7
    v_lshlrev_b32 v6, 16, v40
    v_and_b32 v7, 0xffff0000, v40
    v_add_f32 v5, v5, v6
    v_add_f32 v5, v5, v7
    v_lshlrev_b32 v6, 16, v41
    v_and_b32 v7, 0xffff0000, v41
    v_add_f32 v5, v5, v6
    v_add_f32 v5, v5, v7
    v_lshlrev_b32 v6, 16, v42
    v_and_b32 v7, 0xffff0000, v42
    v_add_f32 v5, v5, v6
    v_add_f32 v5, v5, v7
    v_lshlrev_b32 v6, 16, v43
    v_and_b32 v7, 0xffff0000, v43
    v_add_f32 v5, v5, v6
    v_add_f32 v5, v5, v7
    v_lshlrev_b32 v6, 16, v44
    v_and_b32 v7, 0xffff0000, v44
    v_add_f32 v5, v5, v6
    v_add_f32 v5, v5, v7
    v_lshlrev_b32 v6, 16, v45
    v_and_b32 v7, 0xffff0000, v45
    v_add_f32 v5, v5, v6
    v_add_f32 v5, v5, v7
    v_lshlrev_b32 v6, 16, v46
    v_and_b32 v7, 0xffff0000, v46
    v_add_f32 v5, v5, v6
    v_add_f32 v5, v5, v7
    v_lshlrev_b32 v6, 16, v47
    v_and_b32 v7, 0xffff0000, v47
    v_add_f32 v5, v5, v6
    v_add_f32 v5, v5, v7
    s_nop 1
    v_add_f32_dpp v5, v5, v5 quad_perm:[1,0,3,2] row_mask:0xf bank_mask:0xf
    s_nop 1
    v_add_f32_dpp v5, v5, v5 quad_perm:[2,3,0,1] row_mask:0xf bank_mask:0xf
    s_nop 1
    v_add_f32_dpp v5, v5, v5 row_half_mirror row_mask:0xf bank_mask:0xf
    v_mul_f32 v5, 0x3b000000, v5
    v_mov_b32 v8, 0
    v_lshlrev_b32 v6, 16, v16
    v_and_b32 v7, 0xffff0000, v16
    v_sub_f32 v6, v6, v5
    v_sub_f32 v7, v7, v5
    v_fmac_f32 v8, v6, v6
    v_fmac_f32 v8, v7, v7
    v_lshlrev_b32 v6, 16, v17
    v_and_b32 v7, 0xffff0000, v17
    v_sub_f32 v6, v6, v5
    v_sub_f32 v7, v7, v5
    v_fmac_f32 v8, v6, v6
    v_fmac_f32 v8, v7, v7
    v_lshlrev_b32 v6, 16, v18
    v_and_b32 v7, 0xffff0000, v18
    v_sub_f32 v6, v6, v5
    v_sub_f32 v7, v7, v5
    v_fmac_f32 v8, v6, v6
    v_fmac_f32 v8, v7, v7
    v_lshlrev_b32 v6, 16, v19
    v_and_b32 v7, 0xffff0000, v19
    v_sub_f32 v6, v6, v5
    v_sub_f32 v7, v7, v5
    v_fmac_f32 v8, v6, v6
    v_fmac_f32 v8, v7, v7
    v_lshlrev_b32 v6, 16, v20
    v_and_b32 v7, 0xffff0000, v20
    v_sub_f32 v6, v6, v5
    v_sub_f32 v7, v7, v5
    v_fmac_f32 v8, v6, v6
    v_fmac_f32 v8, v7, v7
    v_lshlrev_b32 v6, 16, v21
    v_and_b32 v7, 0xffff0000, v21
    v_sub_f32 v6, v6, v5
    v_sub_f32 v7, v7, v5
    v_fmac_f32 v8, v6, v6
    v_fmac_f32 v8, v7, v7
    v_lshlrev_b32 v6, 16, v22
    v_and_b32 v7, 0xffff0000, v22
    v_sub_f32 v6, v6, v5
    v_sub_f32 v7, v7, v5
    v_fmac_f32 v8, v6, v6
    v_fmac_f32 v8, v7, v7
    v_lshlrev_b32 v6, 16, v23
    v_and_b32 v7, 0xffff0000, v23
    v_sub_f32 v6, v6, v5
    v_sub_f32 v7, v7, v5
    v_fmac_f32 v8, v6, v6
    v_fmac_f32 v8, v7, v7
    v_lshlrev_b32 v6, 16, v24
    v_and_b32 v7, 0xffff0000, v24
    v_sub_f32 v6, v6, v5
    v_sub_f32 v7, v7, v5
    v_fmac_f32 v8, v6, v6
    v_fmac_f32 v8, v7, v7
    v_lshlrev_b32 v6, 16, v25
    v_and_b32 v7, 0xffff0000, v25
    v_sub_f32 v6, v6, v5
    v_sub_f32 v7, v7, v5
    v_fmac_f32 v8, v6, v6
    v_fmac_f32 v8, v7, v7
    v_lshlrev_b32 v6, 16, v26
    v_and_b32 v7, 0xffff0000, v26
    v_sub_f32 v6, v6, v5
    v_sub_f32 v7, v7, v5
    v_fmac_f32 v8, v6, v6
    v_fmac_f32 v8, v7, v7
    v_lshlrev_b32 v6, 16, v27
    v_and_b32 v7, 0xffff0000, v27
    v_sub_f32 v6, v6, v5
    v_sub_f32 v7, v7, v5
    v_fmac_f32 v8, v6, v6
    v_fmac_f32 v8, v7, v7
    v_lshlrev_b32 v6, 16, v28
    v_and_b32 v7, 0xffff0000, v28
    v_sub_f32 v6, v6, v5
    v_sub_f32 v7, v7, v5
    v_fmac_f32 v8, v6, v6
    v_fmac_f32 v8, v7, v7
    v_lshlrev_b32 v6, 16, v29
    v_and_b32 v7, 0xffff0000, v29
    v_sub_f32 v6, v6, v5
    v_sub_f32 v7, v7, v5
    v_fmac_f32 v8, v6, v6
    v_fmac_f32 v8, v7, v7
    v_lshlrev_b32 v6, 16, v30
    v_and_b32 v7, 0xffff0000, v30
    v_sub_f32 v6, v6, v5
    v_sub_f32 v7, v7, v5
    v_fmac_f32 v8, v6, v6
    v_fmac_f32 v8, v7, v7
    v_lshlrev_b32 v6, 16, v31
    v_and_b32 v7, 0xffff0000, v31
    v_sub_f32 v6, v6, v5
    v_sub_f32 v7, v7, v5
    v_fmac_f32 v8, v6, v6
    v_fmac_f32 v8, v7, v7
    v_lshlrev_b32 v6, 16, v32
    v_and_b32 v7, 0xffff0000, v32
    v_sub_f32 v6, v6, v5
    v_sub_f32 v7, v7, v5
    v_fmac_f32 v8, v6, v6
    v_fmac_f32 v8, v7, v7
    v_lshlrev_b32 v6, 16, v33
    v_and_b32 v7, 0xffff0000, v33
    v_sub_f32 v6, v6, v5
    v_sub_f32 v7, v7, v5
    v_fmac_f32 v8, v6, v6
    v_fmac_f32 v8, v7, v7
    v_lshlrev_b32 v6, 16, v34
    v_and_b32 v7, 0xffff0000, v34
    v_sub_f32 v6, v6, v5
    v_sub_f32 v7, v7, v5
    v_fmac_f32 v8, v6, v6
    v_fmac_f32 v8, v7, v7
    v_lshlrev_b32 v6, 16, v35
    v_and_b32 v7, 0xffff0000, v35
    v_sub_f32 v6, v6, v5
    v_sub_f32 v7, v7, v5
    v_fmac_f32 v8, v6, v6
    v_fmac_f32 v8, v7, v7
    v_lshlrev_b32 v6, 16, v36
    v_and_b32 v7, 0xffff0000, v36
    v_sub_f32 v6, v6, v5
    v_sub_f32 v7, v7, v5
    v_fmac_f32 v8, v6, v6
    v_fmac_f32 v8, v7, v7
    v_lshlrev_b32 v6, 16, v37
    v_and_b32 v7, 0xffff0000, v37
    v_sub_f32 v6, v6, v5
    v_sub_f32 v7, v7, v5
    v_fmac_f32 v8, v6, v6
    v_fmac_f32 v8, v7, v7
    v_lshlrev_b32 v6, 16, v38
    v_and_b32 v7, 0xffff0000, v38
    v_sub_f32 v6, v6, v5
    v_sub_f32 v7, v7, v5
    v_fmac_f32 v8, v6, v6
    v_fmac_f32 v8, v7, v7
    v_lshlrev_b32 v6, 16, v39
    v_and_b32 v7, 0xffff0000, v39
    v_sub_f32 v6, v6, v5
    v_sub_f32 v7, v7, v5
    v_fmac_f32 v8, v6, v6
    v_fmac_f32 v8, v7, v7
    v_lshlrev_b32 v6, 16, v40
    v_and_b32 v7, 0xffff0000, v40
    v_sub_f32 v6, v6, v5
    v_sub_f32 v7, v7, v5
    v_fmac_f32 v8, v6, v6
    v_fmac_f32 v8, v7, v7
    v_lshlrev_b32 v6, 16, v41
    v_and_b32 v7, 0xffff0000, v41
    v_sub_f32 v6, v6, v5
    v_sub_f32 v7, v7, v5
    v_fmac_f32 v8, v6, v6
    v_fmac_f32 v8, v7, v7
    v_lshlrev_b32 v6, 16, v42
    v_and_b32 v7, 0xffff0000, v42
    v_sub_f32 v6, v6, v5
    v_sub_f32 v7, v7, v5
    v_fmac_f32 v8, v6, v6
    v_fmac_f32 v8, v7, v7
    v_lshlrev_b32 v6, 16, v43
    v_and_b32 v7, 0xffff0000, v43
    v_sub_f32 v6, v6, v5
    v_sub_f32 v7, v7, v5
    v_fmac_f32 v8, v6, v6
    v_fmac_f32 v8, v7, v7
    v_lshlrev_b32 v6, 16, v44
    v_and_b32 v7, 0xffff0000, v44
    v_sub_f32 v6, v6, v5
    v_sub_f32 v7, v7, v5
    v_fmac_f32 v8, v6, v6
    v_fmac_f32 v8, v7, v7
    v_lshlrev_b32 v6, 16, v45
    v_and_b32 v7, 0xffff0000, v45
    v_sub_f32 v6, v6, v5
    v_sub_f32 v7, v7, v5
    v_fmac_f32 v8, v6, v6
    v_fmac_f32 v8, v7, v7
    v_lshlrev_b32 v6, 16, v46
    v_and_b32 v7, 0xffff0000, v46
    v_sub_f32 v6, v6, v5
    v_sub_f32 v7, v7, v5
    v_fmac_f32 v8, v6, v6
    v_fmac_f32 v8, v7, v7
    v_lshlrev_b32 v6, 16, v47
    v_and_b32 v7, 0xffff0000, v47
    v_sub_f32 v6, v6, v5
    v_sub_f32 v7, v7, v5
    v_fmac_f32 v8, v6, v6
    v_fmac_f32 v8, v7, v7
    s_nop 1
    v_add_f32_dpp v8, v8, v8 quad_perm:[1,0,3,2] row_mask:0xf bank_mask:0xf
    s_nop 1
    v_add_f32_dpp v8, v8, v8 quad_perm:[2,3,0,1] row_mask:0xf bank_mask:0xf
    s_nop 1
    v_add_f32_dpp v8, v8, v8 row_half_mirror row_mask:0xf bank_mask:0xf
    v_mul_f32 v8, 0x3b000000, v8
    v_add_f32 v8, 0x3727c5ac, v8
    v_rsq_f32 v6, v8
    v_lshlrev_b32 v3, 3, v1
    v_mov_b32 v4, v5
    v_mov_b32 v5, v6
    buffer_store_dwordx2 v[4:5], v3, s[20:23], 0 offen
    s_branch k0_end
k0_warm:
    s_load_dwordx4 s[4:7], s[0:1], 8
    s_load_dwordx4 s[8:11], s[0:1], 32
    s_load_dwordx2 s[28:29], s[0:1], 48
    s_sub_u32 s3, s2, 160
    s_lshl_b32 s3, s3, 8
    v_add_u32 v1, s3, v0
    v_lshlrev_b32 v1, 6, v1
    s_waitcnt lgkmcnt(0)
    s_mov_b32 s12, s4
    s_mov_b32 s13, s5
    s_mov_b32 s14, 1572864
    s_mov_b32 s15, 0x20000
    s_mov_b32 s24, 0
    buffer_load_dword v8, v1, s[12:15], s24 offen
    s_mov_b32 s12, s6
    s_mov_b32 s13, s7
    s_mov_b32 s14, 524288
    s_mov_b32 s15, 0x20000
    s_mov_b32 s24, 0
    buffer_load_dword v9, v1, s[12:15], s24 offen
    s_mov_b32 s12, s8
    s_mov_b32 s13, s9
    s_mov_b32 s14, 1835008
    s_mov_b32 s15, 0x20000
    s_mov_b32 s24, 0
    buffer_load_dword v10, v1, s[12:15], s24 offen
    s_mov_b32 s24, 1572864
    buffer_load_dword v11, v1, s[12:15], s24 offen
    s_mov_b32 s12, s10
    s_mov_b32 s13, s11
    s_mov_b32 s14, 1835008
    s_mov_b32 s15, 0x20000
    s_mov_b32 s24, 0
    buffer_load_dword v12, v1, s[12:15], s24 offen
    s_mov_b32 s24, 1572864
    buffer_load_dword v13, v1, s[12:15], s24 offen
    s_mov_b32 s12, s28
    s_mov_b32 s13, s29
    s_mov_b32 s14, 1835008
    s_mov_b32 s15, 0x20000
    s_mov_b32 s24, 0
    buffer_load_dword v14, v1, s[12:15], s24 offen
    s_mov_b32 s24, 1572864
    buffer_load_dword v15, v1, s[12:15], s24 offen
    s_waitcnt vmcnt(0)
k0_end:
    s_endpgm
.globl k1_kernel
.type k1_kernel,@function
.p2align 8
k1_kernel:
    s_cmp_ge_u32 s2, 256
    s_cbranch_scc1 k1_end
    s_load_dwordx4 s[4:7], s[0:1], 0
    s_load_dwordx2 s[8:9], s[0:1], 88
    v_lshrrev_b32 v1, 6, v0
    s_nop 0
    v_readfirstlane_b32 s32, v1
    s_lshr_b32 s33, s2, 3
    s_and_b32 s34, s2, 7
    s_lshl_b32 s35, s33, 6
    v_lshrrev_b32 v2, 3, v0
    v_and_b32 v3, 7, v0
    v_and_b32 v4, 63, v0
    v_and_b32 v5, 15, v0
    v_bfe_u32 v6, v0, 4, 2
    s_waitcnt lgkmcnt(0)
    s_mov_b32 s12, s4
    s_mov_b32 s13, s5
    s_mov_b32 s14, 2097152
    s_mov_b32 s15, 0x20000
    s_mov_b32 s16, s6
    s_mov_b32 s17, s7
    s_mov_b32 s18, 1572864
    s_mov_b32 s19, 0x20000
    s_add_u32 s20, s8, 16384
    s_addc_u32 s21, s9, 0
    s_mov_b32 s22, 16384
    s_mov_b32 s23, 0x20000
    s_mov_b32 s24, s8
    s_mov_b32 s25, s9
    s_mov_b32 s26, 12288
    s_mov_b32 s27, 0x20000
    s_add_u32 s28, s8, 1048576
    s_addc_u32 s29, s9, 0
    s_mov_b32 s30, 2097152
    s_mov_b32 s31, 0x20000
    s_sub_u32 s48, s35, 16
    v_add_u32 v7, s48, v2
    v_max_i32 v7, 0, v7
    v_lshlrev_b32 v184, 10, v7
    v_lshl_add_u32 v184, v3, 4, v184
    v_lshlrev_b32 v7, 3, v7
    buffer_load_dwordx2 v[44:45], v7, s[20:23], 0 offen
    v_add_u32 v7, s48, v2
    v_add_u32 v7, 32, v7
    v_max_i32 v7, 0, v7
    v_lshlrev_b32 v185, 10, v7
    v_lshl_add_u32 v185, v3, 4, v185
    v_lshlrev_b32 v7, 3, v7
    buffer_load_dwordx2 v[46:47], v7, s[20:23], 0 offen
    v_add_u32 v7, s48, v2
    v_add_u32 v7, 64, v7
    v_max_i32 v7, 0, v7
    v_lshlrev_b32 v186, 10, v7
    v_lshl_add_u32 v186, v3, 4, v186
    v_lshlrev_b32 v7, 3, v7
    buffer_load_dwordx2 v[48:49], v7, s[20:23], 0 offen
    v_lshlrev_b32 v7, 3, v0
    buffer_load_dwordx2 v[50:51], v7, s[24:27], 0 offen
    buffer_load_dwordx2 v[52:53], v7, s[24:27], 0 offen offset:2048
    s_mul_i32 s49, s32, 6
    s_add_u32 s49, s49, 0
    s_lshr_b32 s50, s49, 3
    s_and_b32 s51, s49, 7
    s_lshl_b32 s52, s50, 10
    s_mul_i32 s53, s51, 24576
    s_add_u32 s52, s52, s53
    s_lshl_b32 s53, s34, 7
    s_add_u32 s36, s52, s53
    s_lshl_b32 s52, s50, 13
    s_lshl_b32 s53, s51, 10
    s_add_u32 s42, s52, s53
    s_mul_i32 s49, s32, 6
    s_add_u32 s49, s49, 1
    s_lshr_b32 s50, s49, 3
    s_and_b32 s51, s49, 7
    s_lshl_b32 s52, s50, 10
    s_mul_i32 s53, s51, 24576
    s_add_u32 s52, s52, s53
    s_lshl_b32 s53, s34, 7
    s_add_u32 s37, s52, s53
    s_lshl_b32 s52, s50, 13
    s_lshl_b32 s53, s51, 10
    s_add_u32 s43, s52, s53
    s_mul_i32 s49, s32, 6
    s_add_u32 s49, s49, 2
    s_lshr_b32 s50, s49, 3
    s_and_b32 s51, s49, 7
    s_lshl_b32 s52, s50, 10
    s_mul_i32 s53, s51, 24576
    s_add_u32 s52, s52, s53
    s_lshl_b32 s53, s34, 7
    s_add_u32 s38, s52, s53
    s_lshl_b32 s52, s50, 13
    s_lshl_b32 s53, s51, 10
    s_add_u32 s44, s52, s53
    s_mul_i32 s49, s32, 6
    s_add_u32 s49, s49, 3
    s_lshr_b32 s50, s49, 3
    s_and_b32 s51, s49, 7
    s_lshl_b32 s52, s50, 10
    s_mul_i32 s53, s51, 24576
    s_add_u32 s52, s52, s53
    s_lshl_b32 s53, s34, 7
    s_add_u32 s39, s52, s53
    s_lshl_b32 s52, s50, 13
    s_lshl_b32 s53, s51, 10
    s_add_u32 s45, s52, s53
    s_mul_i32 s49, s32, 6
    s_add_u32 s49, s49, 4
    s_lshr_b32 s50, s49, 3
    s_and_b32 s51, s49, 7
    s_lshl_b32 s52, s50, 10
    s_mul_i32 s53, s51, 24576
    s_add_u32 s52, s52, s53
    s_lshl_b32 s53, s34, 7
    s_add_u32 s40, s52, s53
    s_lshl_b32 s52, s50, 13
    s_lshl_b32 s53, s51, 10
    s_add_u32 s46, s52, s53
    s_mul_i32 s49, s32, 6
    s_add_u32 s49, s49, 5
    s_lshr_b32 s50, s49, 3
    s_and_b32 s51, s49, 7
    s_lshl_b32 s52, s50, 10
    s_mul_i32 s53, s51, 24576
    s_add_u32 s52, s52, s53
    s_lshl_b32 s53, s34, 7
    s_add_u32 s41, s52, s53
    s_lshl_b32 s52, s50, 13
    s_lshl_b32 s53, s51, 10
    s_add_u32 s47, s52, s53
    v_lshrrev_b32 v7, 3, v4
    v_and_b32 v8, 7, v4
    v_and_b32 v9, 2, v7
    v_mov_b32 v10, v9
    v_xor_b32 v10, v8, v10
    v_lshlrev_b32 v10, 4, v10
    v_mul_u32_u24 v11, 3072, v7
    v_add_u32 v195, v10, v11
    v_or_b32 v10, 4, v9
    v_xor_b32 v10, v8, v10
    v_lshlrev_b32 v10, 4, v10
    v_mul_u32_u24 v11, 3072, v7
    v_add_u32 v196, v10, v11
    v_lshrrev_b32 v7, 2, v5
    v_lshl_add_u32 v7, v6, 3, v7
    v_lshlrev_b32 v7, 7, v7
    v_bfe_u32 v8, v5, 3, 1
    v_lshlrev_b32 v8, 1, v8
    v_and_b32 v9, 1, v6
    v_lshl_or_b32 v8, v9, 2, v8
    v_bfe_u32 v9, v5, 1, 1
    s_lshl_b32 s49, s32, 1
    v_add_u32 v9, s49, v9
    v_xor_b32 v8, v8, v9
    v_lshl_add_u32 v7, v8, 4, v7
    v_and_b32 v9, 1, v5
    v_lshl_add_u32 v7, v9, 3, v7
    v_add_u32 v197, 29696, v7
    v_add_u32 v198, 54272, v7
    v_add_u32 v199, 78848, v7
    v_mul_u32_u24 v7, 160, v5
    v_lshl_add_u32 v7, v6, 4, v7
    v_add_u32 v200, 4096, v7
    v_mul_u32_u24 v7, 160, v2
    v_lshl_add_u32 v7, v3, 4, v7
    v_add_u32 v193, 4096, v7
    v_lshlrev_b32 v194, 5, v3
    v_lshlrev_b32 v7, 2, v6
    v_sub_u32 v7, v5, v7
    v_add_u32 v8, 16, v7
    v_and_b32 v9, 1, v8
    v_cmp_ge_i32 vcc, 14, v8
    v_cmp_eq_u32 s[50:51], 0, v9
    s_and_b64 vcc, vcc, s[50:51]
    v_mov_b32 v9, 0xce6e6b28
    v_cndmask_b32 v202, v9, 0, vcc
    v_subrev_u32 v8, 0, v7
    v_and_b32 v9, 1, v8
    v_cmp_le_i32 vcc, 0, v8
    v_cmp_eq_u32 s[50:51], 0, v9
    s_and_b64 vcc, vcc, s[50:51]
    v_mov_b32 v9, 0xce6e6b28
    v_cndmask_b32 v206, v9, 0, vcc
    v_lshlrev_b32 v7, 2, v6
    v_sub_u32 v7, v5, v7
    v_add_u32 v8, 15, v7
    v_and_b32 v9, 1, v8
    v_cmp_ge_i32 vcc, 14, v8
    v_cmp_eq_u32 s[50:51], 0, v9
    s_and_b64 vcc, vcc, s[50:51]
    v_mov_b32 v9, 0xce6e6b28
    v_cndmask_b32 v203, v9, 0, vcc
    v_subrev_u32 v8, 1, v7
    v_and_b32 v9, 1, v8
    v_cmp_le_i32 vcc, 0, v8
    v_cmp_eq_u32 s[50:51], 0, v9
    s_and_b64 vcc, vcc, s[50:51]
    v_mov_b32 v9, 0xce6e6b28
    v_cndmask_b32 v207, v9, 0, vcc
    v_lshlrev_b32 v7, 2, v6
    v_sub_u32 v7, v5, v7
    v_add_u32 v8, 14, v7
    v_and_b32 v9, 1, v8
    v_cmp_ge_i32 vcc, 14, v8
    v_cmp_eq_u32 s[50:51], 0, v9
    s_and_b64 vcc, vcc, s[50:51]
    v_mov_b32 v9, 0xce6e6b28
    v_cndmask_b32 v204, v9, 0, vcc
    v_subrev_u32 v8, 2, v7
    v_and_b32 v9, 1, v8
    v_cmp_le_i32 vcc, 0, v8
    v_cmp_eq_u32 s[50:51], 0, v9
    s_and_b64 vcc, vcc, s[50:51]
    v_mov_b32 v9, 0xce6e6b28
    v_cndmask_b32 v208, v9, 0, vcc
    v_lshlrev_b32 v7, 2, v6
    v_sub_u32 v7, v5, v7
    v_add_u32 v8, 13, v7
    v_and_b32 v9, 1, v8
    v_cmp_ge_i32 vcc, 14, v8
    v_cmp_eq_u32 s[50:51], 0, v9
    s_and_b64 vcc, vcc, s[50:51]
    v_mov_b32 v9, 0xce6e6b28
    v_cndmask_b32 v205, v9, 0, vcc
    v_subrev_u32 v8, 3, v7
    v_and_b32 v9, 1, v8
    v_cmp_le_i32 vcc, 0, v8
    v_cmp_eq_u32 s[50:51], 0, v9
    s_and_b64 vcc, vcc, s[50:51]
    v_mov_b32 v9, 0xce6e6b28
    v_cndmask_b32 v209, v9, 0, vcc
    s_cmp_eq_u32 s33, 0
    s_cselect_b32 s49, 0xce6e6b28, 0
    v_add_f32 v210, s49, v202
    v_add_f32 v211, s49, v203
    v_add_f32 v212, s49, v204
    v_add_f32 v213, s49, v205
    v_lshlrev_b32 v7, 10, v5
    v_lshl_add_u32 v201, v6, 3, v7
    s_lshl_b32 s54, s34, 2
    s_add_u32 s54, s54, s32
    s_lshl_b32 s54, s54, 5
    s_lshl_b32 s55, s35, 10
    s_add_u32 s54, s54, s55
    s_add_u32 s49, s36, 0
    s_add_u32 m0, s42, 29696
    s_nop 0
    buffer_load_dwordx4 v195, s[16:19], s49 offen lds
    s_add_u32 s49, s37, 0
    s_add_u32 m0, s43, 29696
    s_nop 0
    buffer_load_dwordx4 v196, s[16:19], s49 offen lds
    s_add_u32 s49, s38, 0
    s_add_u32 m0, s44, 29696
    s_nop 0
    buffer_load_dwordx4 v195, s[16:19], s49 offen lds
    s_add_u32 s49, s39, 0
    s_add_u32 m0, s45, 29696
    s_nop 0
    buffer_load_dwordx4 v196, s[16:19], s49 offen lds
    s_add_u32 s49, s40, 0
    s_add_u32 m0, s46, 29696
    s_nop 0
    buffer_load_dwordx4 v195, s[16:19], s49 offen lds
    s_add_u32 s49, s41, 0
    s_add_u32 m0, s47, 29696
    s_nop 0
    buffer_load_dwordx4 v196, s[16:19], s49 offen lds
    s_add_u32 s49, s36, 196608
    s_add_u32 m0, s42, 54272
    s_nop 0
    buffer_load_dwordx4 v195, s[16:19], s49 offen lds
    s_add_u32 s49, s37, 196608
    s_add_u32 m0, s43, 54272
    s_nop 0
    buffer_load_dwordx4 v196, s[16:19], s49 offen lds
    s_add_u32 s49, s38, 196608
    s_add_u32 m0, s44, 54272
    s_nop 0
    buffer_load_dwordx4 v195, s[16:19], s49 offen lds
    s_add_u32 s49, s39, 196608
    s_add_u32 m0, s45, 54272
    s_nop 0
    buffer_load_dwordx4 v196, s[16:19], s49 offen lds
    s_add_u32 s49, s40, 196608
    s_add_u32 m0, s46, 54272
    s_nop 0
    buffer_load_dwordx4 v195, s[16:19], s49 offen lds
    s_add_u32 s49, s41, 196608
    s_add_u32 m0, s47, 54272
    s_nop 0
    buffer_load_dwordx4 v196, s[16:19], s49 offen lds
    buffer_load_dwordx4 v[16:19], v184, s[12:15], 0 offen offset:0
    buffer_load_dwordx4 v[20:23], v185, s[12:15], 0 offen offset:0
    buffer_load_dwordx4 v[24:27], v186, s[12:15], 0 offen offset:0
    s_waitcnt vmcnt(15)
    v_add_f32 v52, 1.0, v52
    v_add_f32 v53, 1.0, v53
    v_cvt_pk_bf16_f32 v54, v52, v53
    v_lshlrev_b32 v52, 16, v54
    v_and_b32 v53, 0xffff0000, v54
    v_lshlrev_b32 v7, 3, v0
    ds_write_b64 v7, v[52:53]
    ds_write_b64 v7, v[50:51] offset:2048
    v_mov_b32 v187, v45
    v_mul_f32 v7, v44, v45
    v_sub_f32 v190, 0, v7
    v_mov_b32 v188, v47
    v_mul_f32 v7, v46, v47
    v_sub_f32 v191, 0, v7
    v_mov_b32 v189, v49
    v_mul_f32 v7, v48, v49
    v_sub_f32 v192, 0, v7
    s_waitcnt lgkmcnt(0)
    s_barrier
    ds_read_b128 v[28:31], v194 offset:0
    ds_read_b128 v[32:35], v194 offset:16
    ds_read_b128 v[36:39], v194 offset:2048
    ds_read_b128 v[40:43], v194 offset:2064
    s_waitcnt vmcnt(0)
    s_waitcnt lgkmcnt(0)
    v_lshlrev_b32 v44, 16, v16
    v_and_b32 v45, 0xffff0000, v16
    v_lshlrev_b32 v46, 16, v17
    v_and_b32 v47, 0xffff0000, v17
    v_lshlrev_b32 v48, 16, v18
    v_and_b32 v49, 0xffff0000, v18
    v_lshlrev_b32 v50, 16, v19
    v_and_b32 v51, 0xffff0000, v19
    v_fma_f32 v44, v44, v187, v190
    v_fma_f32 v45, v45, v187, v190
    v_fma_f32 v46, v46, v187, v190
    v_fma_f32 v47, v47, v187, v190
    v_fma_f32 v48, v48, v187, v190
    v_fma_f32 v49, v49, v187, v190
    v_fma_f32 v50, v50, v187, v190
    v_fma_f32 v51, v51, v187, v190
    v_fma_f32 v44, v44, v28, v36
    v_fma_f32 v45, v45, v29, v37
    v_fma_f32 v46, v46, v30, v38
    v_fma_f32 v47, v47, v31, v39
    v_fma_f32 v48, v48, v32, v40
    v_fma_f32 v49, v49, v33, v41
    v_fma_f32 v50, v50, v34, v42
    v_fma_f32 v51, v51, v35, v43
    v_cvt_pk_bf16_f32 v56, v44, v45
    v_cvt_pk_bf16_f32 v57, v46, v47
    v_cvt_pk_bf16_f32 v58, v48, v49
    v_cvt_pk_bf16_f32 v59, v50, v51
    ds_write_b128 v193, v[56:59] offset:0
    v_lshlrev_b32 v44, 16, v20
    v_and_b32 v45, 0xffff0000, v20
    v_lshlrev_b32 v46, 16, v21
    v_and_b32 v47, 0xffff0000, v21
    v_lshlrev_b32 v48, 16, v22
    v_and_b32 v49, 0xffff0000, v22
    v_lshlrev_b32 v50, 16, v23
    v_and_b32 v51, 0xffff0000, v23
    v_fma_f32 v44, v44, v188, v191
    v_fma_f32 v45, v45, v188, v191
    v_fma_f32 v46, v46, v188, v191
    v_fma_f32 v47, v47, v188, v191
    v_fma_f32 v48, v48, v188, v191
    v_fma_f32 v49, v49, v188, v191
    v_fma_f32 v50, v50, v188, v191
    v_fma_f32 v51, v51, v188, v191
    v_fma_f32 v44, v44, v28, v36
    v_fma_f32 v45, v45, v29, v37
    v_fma_f32 v46, v46, v30, v38
    v_fma_f32 v47, v47, v31, v39
    v_fma_f32 v48, v48, v32, v40
    v_fma_f32 v49, v49, v33, v41
    v_fma_f32 v50, v50, v34, v42
    v_fma_f32 v51, v51, v35, v43
    v_cvt_pk_bf16_f32 v56, v44, v45
    v_cvt_pk_bf16_f32 v57, v46, v47
    v_cvt_pk_bf16_f32 v58, v48, v49
    v_cvt_pk_bf16_f32 v59, v50, v51
    ds_write_b128 v193, v[56:59] offset:5120
    s_cmp_ge_u32 s32, 2
    s_cbranch_scc1 k1_skip1
    v_lshlrev_b32 v44, 16, v24
    v_and_b32 v45, 0xffff0000, v24
    v_lshlrev_b32 v46, 16, v25
    v_and_b32 v47, 0xffff0000, v25
    v_lshlrev_b32 v48, 16, v26
    v_and_b32 v49, 0xffff0000, v26
    v_lshlrev_b32 v50, 16, v27
    v_and_b32 v51, 0xffff0000, v27
    v_fma_f32 v44, v44, v189, v192
    v_fma_f32 v45, v45, v189, v192
    v_fma_f32 v46, v46, v189, v192
    v_fma_f32 v47, v47, v189, v192
    v_fma_f32 v48, v48, v189, v192
    v_fma_f32 v49, v49, v189, v192
    v_fma_f32 v50, v50, v189, v192
    v_fma_f32 v51, v51, v189, v192
    v_fma_f32 v44, v44, v28, v36
    v_fma_f32 v45, v45, v29, v37
    v_fma_f32 v46, v46, v30, v38
    v_fma_f32 v47, v47, v31, v39
    v_fma_f32 v48, v48, v32, v40
    v_fma_f32 v49, v49, v33, v41
    v_fma_f32 v50, v50, v34, v42
    v_fma_f32 v51, v51, v35, v43
    v_cvt_pk_bf16_f32 v56, v44, v45
    v_cvt_pk_bf16_f32 v57, v46, v47
    v_cvt_pk_bf16_f32 v58, v48, v49
    v_cvt_pk_bf16_f32 v59, v50, v51
    ds_write_b128 v193, v[56:59] offset:10240
k1_skip1:
    s_nop 4
    buffer_load_dwordx4 v[16:19], v184, s[12:15], 0 offen offset:128
    buffer_load_dwordx4 v[20:23], v185, s[12:15], 0 offen offset:128
    buffer_load_dwordx4 v[24:27], v186, s[12:15], 0 offen offset:128
    s_waitcnt lgkmcnt(0)
    s_barrier
    s_add_u32 s49, s36, 393216
    s_add_u32 m0, s42, 78848
    s_nop 0
    buffer_load_dwordx4 v195, s[16:19], s49 offen lds
    s_add_u32 s49, s37, 393216
    s_add_u32 m0, s43, 78848
    s_nop 0
    buffer_load_dwordx4 v196, s[16:19], s49 offen lds
    s_add_u32 s49, s38, 393216
    s_add_u32 m0, s44, 78848
    s_nop 0
    buffer_load_dwordx4 v195, s[16:19], s49 offen lds
    s_add_u32 s49, s39, 393216
    s_add_u32 m0, s45, 78848
    s_nop 0
    buffer_load_dwordx4 v196, s[16:19], s49 offen lds
    s_add_u32 s49, s40, 393216
    s_add_u32 m0, s46, 78848
    s_nop 0
    buffer_load_dwordx4 v195, s[16:19], s49 offen lds
    s_add_u32 s49, s41, 393216
    s_add_u32 m0, s47, 78848
    s_nop 0
    buffer_load_dwordx4 v196, s[16:19], s49 offen lds
    ds_read_b128 v[64:67], v200 offset:0
    ds_read_b128 v[68:71], v200 offset:2560
    ds_read_b128 v[72:75], v200 offset:5120
    ds_read_b128 v[76:79], v200 offset:7680
    ds_read_b128 v[80:83], v200 offset:10240
    ds_read_b64_tr_b16 v[84:85], v197 offset:0
    ds_read_b64_tr_b16 v[86:87], v197 offset:512
    ds_read_b64_tr_b16 v[88:89], v197 offset:8192
    ds_read_b64_tr_b16 v[90:91], v197 offset:8704
    ds_read_b64_tr_b16 v[92:93], v197 offset:16384
    ds_read_b64_tr_b16 v[94:95], v197 offset:16896
    ds_read_b128 v[96:99], v200 offset:64
    ds_read_b128 v[100:103], v200 offset:2624
    ds_read_b128 v[104:107], v200 offset:5184
    ds_read_b128 v[108:111], v200 offset:7744
    s_waitcnt lgkmcnt(4)
    v_mfma_f32_16x16x32_bf16 v[128:131], v[84:87], v[68:71], 0
    ds_read_b128 v[112:115], v200 offset:10304
    v_mfma_f32_16x16x32_bf16 v[132:135], v[84:87], v[72:75], 0
    ds_read_b64_tr_b16 v[116:117], v197 offset:4096
    v_mfma_f32_16x16x32_bf16 v[136:139], v[84:87], v[76:79], 0
    ds_read_b64_tr_b16 v[118:119], v197 offset:4608
    v_mfma_f32_16x16x32_bf16 v[140:143], v[84:87], v[80:83], 0
    ds_read_b64_tr_b16 v[120:121], v197 offset:12288
    v_mfma_f32_16x16x32_bf16 v[144:147], v[88:91], v[64:67], 0
    ds_read_b64_tr_b16 v[122:123], v197 offset:12800
    v_mfma_f32_16x16x32_bf16 v[148:151], v[88:91], v[68:71], 0
    ds_read_b64_tr_b16 v[124:125], v197 offset:20480
    v_mfma_f32_16x16x32_bf16 v[152:155], v[88:91], v[72:75], 0
    ds_read_b64_tr_b16 v[126:127], v197 offset:20992
    v_mfma_f32_16x16x32_bf16 v[156:159], v[88:91], v[76:79], 0
    v_mfma_f32_16x16x32_bf16 v[160:163], v[88:91], v[80:83], 0
    v_mfma_f32_16x16x32_bf16 v[164:167], v[64:67], v[92:95], 0
    v_mfma_f32_16x16x32_bf16 v[168:171], v[68:71], v[92:95], 0
    v_mfma_f32_16x16x32_bf16 v[172:175], v[72:75], v[92:95], 0
    v_mfma_f32_16x16x32_bf16 v[176:179], v[76:79], v[92:95], 0
    v_mfma_f32_16x16x32_bf16 v[180:183], v[80:83], v[92:95], 0
    s_waitcnt lgkmcnt(0)
    v_mfma_f32_16x16x32_bf16 v[128:131], v[116:119], v[100:103], v[128:131]
    v_mfma_f32_16x16x32_bf16 v[132:135], v[116:119], v[104:107], v[132:135]
    v_mfma_f32_16x16x32_bf16 v[136:139], v[116:119], v[108:111], v[136:139]
    v_mfma_f32_16x16x32_bf16 v[140:143], v[116:119], v[112:115], v[140:143]
    v_mfma_f32_16x16x32_bf16 v[144:147], v[120:123], v[96:99], v[144:147]
    v_mfma_f32_16x16x32_bf16 v[148:151], v[120:123], v[100:103], v[148:151]
    v_mfma_f32_16x16x32_bf16 v[152:155], v[120:123], v[104:107], v[152:155]
    v_mfma_f32_16x16x32_bf16 v[156:159], v[120:123], v[108:111], v[156:159]
    v_mfma_f32_16x16x32_bf16 v[160:163], v[120:123], v[112:115], v[160:163]
    v_mfma_f32_16x16x32_bf16 v[164:167], v[96:99], v[124:127], v[164:167]
    v_mfma_f32_16x16x32_bf16 v[168:171], v[100:103], v[124:127], v[168:171]
    v_mfma_f32_16x16x32_bf16 v[172:175], v[104:107], v[124:127], v[172:175]
    v_mfma_f32_16x16x32_bf16 v[176:179], v[108:111], v[124:127], v[176:179]
    v_mfma_f32_16x16x32_bf16 v[180:183], v[112:115], v[124:127], v[180:183]
    ds_read_b128 v[28:31], v194 offset:256
    ds_read_b128 v[32:35], v194 offset:272
    ds_read_b128 v[36:39], v194 offset:2304
    ds_read_b128 v[40:43], v194 offset:2320
    s_waitcnt vmcnt(6)
    s_waitcnt lgkmcnt(0)
    v_lshlrev_b32 v44, 16, v16
    v_and_b32 v45, 0xffff0000, v16
    v_lshlrev_b32 v46, 16, v17
    v_and_b32 v47, 0xffff0000, v17
    v_lshlrev_b32 v48, 16, v18
    v_and_b32 v49, 0xffff0000, v18
    v_lshlrev_b32 v50, 16, v19
    v_and_b32 v51, 0xffff0000, v19
    v_fma_f32 v44, v44, v187, v190
    v_fma_f32 v45, v45, v187, v190
    v_fma_f32 v46, v46, v187, v190
    v_fma_f32 v47, v47, v187, v190
    v_fma_f32 v48, v48, v187, v190
    v_fma_f32 v49, v49, v187, v190
    v_fma_f32 v50, v50, v187, v190
    v_fma_f32 v51, v51, v187, v190
    v_fma_f32 v44, v44, v28, v36
    v_fma_f32 v45, v45, v29, v37
    v_fma_f32 v46, v46, v30, v38
    v_fma_f32 v47, v47, v31, v39
    v_fma_f32 v48, v48, v32, v40
    v_fma_f32 v49, v49, v33, v41
    v_fma_f32 v50, v50, v34, v42
    v_fma_f32 v51, v51, v35, v43
    v_cvt_pk_bf16_f32 v56, v44, v45
    v_cvt_pk_bf16_f32 v57, v46, v47
    v_cvt_pk_bf16_f32 v58, v48, v49
    v_cvt_pk_bf16_f32 v59, v50, v51
    ds_write_b128 v193, v[56:59] offset:12800
    v_lshlrev_b32 v44, 16, v20
    v_and_b32 v45, 0xffff0000, v20
    v_lshlrev_b32 v46, 16, v21
    v_and_b32 v47, 0xffff0000, v21
    v_lshlrev_b32 v48, 16, v22
    v_and_b32 v49, 0xffff0000, v22
    v_lshlrev_b32 v50, 16, v23
    v_and_b32 v51, 0xffff0000, v23
    v_fma_f32 v44, v44, v188, v191
    v_fma_f32 v45, v45, v188, v191
    v_fma_f32 v46, v46, v188, v191
    v_fma_f32 v47, v47, v188, v191
    v_fma_f32 v48, v48, v188, v191
    v_fma_f32 v49, v49, v188, v191
    v_fma_f32 v50, v50, v188, v191
    v_fma_f32 v51, v51, v188, v191
    v_fma_f32 v44, v44, v28, v36
    v_fma_f32 v45, v45, v29, v37
    v_fma_f32 v46, v46, v30, v38
    v_fma_f32 v47, v47, v31, v39
    v_fma_f32 v48, v48, v32, v40
    v_fma_f32 v49, v49, v33, v41
    v_fma_f32 v50, v50, v34, v42
    v_fma_f32 v51, v51, v35, v43
    v_cvt_pk_bf16_f32 v56, v44, v45
    v_cvt_pk_bf16_f32 v57, v46, v47
    v_cvt_pk_bf16_f32 v58, v48, v49
    v_cvt_pk_bf16_f32 v59, v50, v51
    ds_write_b128 v193, v[56:59] offset:17920
    s_cmp_ge_u32 s32, 2
    s_cbranch_scc1 k1_skip2
    v_lshlrev_b32 v44, 16, v24
    v_and_b32 v45, 0xffff0000, v24
    v_lshlrev_b32 v46, 16, v25
    v_and_b32 v47, 0xffff0000, v25
    v_lshlrev_b32 v48, 16, v26
    v_and_b32 v49, 0xffff0000, v26
    v_lshlrev_b32 v50, 16, v27
    v_and_b32 v51, 0xffff0000, v27
    v_fma_f32 v44, v44, v189, v192
    v_fma_f32 v45, v45, v189, v192
    v_fma_f32 v46, v46, v189, v192
    v_fma_f32 v47, v47, v189, v192
    v_fma_f32 v48, v48, v189, v192
    v_fma_f32 v49, v49, v189, v192
    v_fma_f32 v50, v50, v189, v192
    v_fma_f32 v51, v51, v189, v192
    v_fma_f32 v44, v44, v28, v36
    v_fma_f32 v45, v45, v29, v37
    v_fma_f32 v46, v46, v30, v38
    v_fma_f32 v47, v47, v31, v39
    v_fma_f32 v48, v48, v32, v40
    v_fma_f32 v49, v49, v33, v41
    v_fma_f32 v50, v50, v34, v42
    v_fma_f32 v51, v51, v35, v43
    v_cvt_pk_bf16_f32 v56, v44, v45
    v_cvt_pk_bf16_f32 v57, v46, v47
    v_cvt_pk_bf16_f32 v58, v48, v49
    v_cvt_pk_bf16_f32 v59, v50, v51
    ds_write_b128 v193, v[56:59] offset:23040
k1_skip2:
    s_nop 4
    buffer_load_dwordx4 v[16:19], v184, s[12:15], 0 offen offset:256
    buffer_load_dwordx4 v[20:23], v185, s[12:15], 0 offen offset:256
    buffer_load_dwordx4 v[24:27], v186, s[12:15], 0 offen offset:256
    s_waitcnt lgkmcnt(0)
    s_barrier
    s_add_u32 s49, s36, 589824
    s_add_u32 m0, s42, 29696
    s_nop 0
    buffer_load_dwordx4 v195, s[16:19], s49 offen lds
    s_add_u32 s49, s37, 589824
    s_add_u32 m0, s43, 29696
    s_nop 0
    buffer_load_dwordx4 v196, s[16:19], s49 offen lds
    s_add_u32 s49, s38, 589824
    s_add_u32 m0, s44, 29696
    s_nop 0
    buffer_load_dwordx4 v195, s[16:19], s49 offen lds
    s_add_u32 s49, s39, 589824
    s_add_u32 m0, s45, 29696
    s_nop 0
    buffer_load_dwordx4 v196, s[16:19], s49 offen lds
    s_add_u32 s49, s40, 589824
    s_add_u32 m0, s46, 29696
    s_nop 0
    buffer_load_dwordx4 v195, s[16:19], s49 offen lds
    s_add_u32 s49, s41, 589824
    s_add_u32 m0, s47, 29696
    s_nop 0
    buffer_load_dwordx4 v196, s[16:19], s49 offen lds
    ds_read_b128 v[64:67], v200 offset:12800
    ds_read_b128 v[68:71], v200 offset:15360
    ds_read_b128 v[72:75], v200 offset:17920
    ds_read_b128 v[76:79], v200 offset:20480
    ds_read_b128 v[80:83], v200 offset:23040
    ds_read_b64_tr_b16 v[84:85], v198 offset:0
    ds_read_b64_tr_b16 v[86:87], v198 offset:512
    ds_read_b64_tr_b16 v[88:89], v198 offset:8192
    ds_read_b64_tr_b16 v[90:91], v198 offset:8704
    ds_read_b64_tr_b16 v[92:93], v198 offset:16384
    ds_read_b64_tr_b16 v[94:95], v198 offset:16896
    ds_read_b128 v[96:99], v200 offset:12864
    ds_read_b128 v[100:103], v200 offset:15424
    ds_read_b128 v[104:107], v200 offset:17984
    ds_read_b128 v[108:111], v200 offset:20544
    s_waitcnt lgkmcnt(4)
    v_mfma_f32_16x16x32_bf16 v[128:131], v[84:87], v[68:71], v[128:131]
    ds_read_b128 v[112:115], v200 offset:23104
    v_mfma_f32_16x16x32_bf16 v[132:135], v[84:87], v[72:75], v[132:135]
    ds_read_b64_tr_b16 v[116:117], v198 offset:4096
    v_mfma_f32_16x16x32_bf16 v[136:139], v[84:87], v[76:79], v[136:139]
    ds_read_b64_tr_b16 v[118:119], v198 offset:4608
    v_mfma_f32_16x16x32_bf16 v[140:143], v[84:87], v[80:83], v[140:143]
    ds_read_b64_tr_b16 v[120:121], v198 offset:12288
    v_mfma_f32_16x16x32_bf16 v[144:147], v[88:91], v[64:67], v[144:147]
    ds_read_b64_tr_b16 v[122:123], v198 offset:12800
    v_mfma_f32_16x16x32_bf16 v[148:151], v[88:91], v[68:71], v[148:151]
    ds_read_b64_tr_b16 v[124:125], v198 offset:20480
    v_mfma_f32_16x16x32_bf16 v[152:155], v[88:91], v[72:75], v[152:155]
    ds_read_b64_tr_b16 v[126:127], v198 offset:20992
    v_mfma_f32_16x16x32_bf16 v[156:159], v[88:91], v[76:79], v[156:159]
    v_mfma_f32_16x16x32_bf16 v[160:163], v[88:91], v[80:83], v[160:163]
    v_mfma_f32_16x16x32_bf16 v[164:167], v[64:67], v[92:95], v[164:167]
    v_mfma_f32_16x16x32_bf16 v[168:171], v[68:71], v[92:95], v[168:171]
    v_mfma_f32_16x16x32_bf16 v[172:175], v[72:75], v[92:95], v[172:175]
    v_mfma_f32_16x16x32_bf16 v[176:179], v[76:79], v[92:95], v[176:179]
    v_mfma_f32_16x16x32_bf16 v[180:183], v[80:83], v[92:95], v[180:183]
    s_waitcnt lgkmcnt(0)
    v_mfma_f32_16x16x32_bf16 v[128:131], v[116:119], v[100:103], v[128:131]
    v_mfma_f32_16x16x32_bf16 v[132:135], v[116:119], v[104:107], v[132:135]
    v_mfma_f32_16x16x32_bf16 v[136:139], v[116:119], v[108:111], v[136:139]
    v_mfma_f32_16x16x32_bf16 v[140:143], v[116:119], v[112:115], v[140:143]
    v_mfma_f32_16x16x32_bf16 v[144:147], v[120:123], v[96:99], v[144:147]
    v_mfma_f32_16x16x32_bf16 v[148:151], v[120:123], v[100:103], v[148:151]
    v_mfma_f32_16x16x32_bf16 v[152:155], v[120:123], v[104:107], v[152:155]
    v_mfma_f32_16x16x32_bf16 v[156:159], v[120:123], v[108:111], v[156:159]
    v_mfma_f32_16x16x32_bf16 v[160:163], v[120:123], v[112:115], v[160:163]
    v_mfma_f32_16x16x32_bf16 v[164:167], v[96:99], v[124:127], v[164:167]
    v_mfma_f32_16x16x32_bf16 v[168:171], v[100:103], v[124:127], v[168:171]
    v_mfma_f32_16x16x32_bf16 v[172:175], v[104:107], v[124:127], v[172:175]
    v_mfma_f32_16x16x32_bf16 v[176:179], v[108:111], v[124:127], v[176:179]
    v_mfma_f32_16x16x32_bf16 v[180:183], v[112:115], v[124:127], v[180:183]
    ds_read_b128 v[28:31], v194 offset:512
    ds_read_b128 v[32:35], v194 offset:528
    ds_read_b128 v[36:39], v194 offset:2560
    ds_read_b128 v[40:43], v194 offset:2576
    s_waitcnt vmcnt(6)
    s_waitcnt lgkmcnt(0)
    v_lshlrev_b32 v44, 16, v16
    v_and_b32 v45, 0xffff0000, v16
    v_lshlrev_b32 v46, 16, v17
    v_and_b32 v47, 0xffff0000, v17
    v_lshlrev_b32 v48, 16, v18
    v_and_b32 v49, 0xffff0000, v18
    v_lshlrev_b32 v50, 16, v19
    v_and_b32 v51, 0xffff0000, v19
    v_fma_f32 v44, v44, v187, v190
    v_fma_f32 v45, v45, v187, v190
    v_fma_f32 v46, v46, v187, v190
    v_fma_f32 v47, v47, v187, v190
    v_fma_f32 v48, v48, v187, v190
    v_fma_f32 v49, v49, v187, v190
    v_fma_f32 v50, v50, v187, v190
    v_fma_f32 v51, v51, v187, v190
    v_fma_f32 v44, v44, v28, v36
    v_fma_f32 v45, v45, v29, v37
    v_fma_f32 v46, v46, v30, v38
    v_fma_f32 v47, v47, v31, v39
    v_fma_f32 v48, v48, v32, v40
    v_fma_f32 v49, v49, v33, v41
    v_fma_f32 v50, v50, v34, v42
    v_fma_f32 v51, v51, v35, v43
    v_cvt_pk_bf16_f32 v56, v44, v45
    v_cvt_pk_bf16_f32 v57, v46, v47
    v_cvt_pk_bf16_f32 v58, v48, v49
    v_cvt_pk_bf16_f32 v59, v50, v51
    ds_write_b128 v193, v[56:59] offset:0
    v_lshlrev_b32 v44, 16, v20
    v_and_b32 v45, 0xffff0000, v20
    v_lshlrev_b32 v46, 16, v21
    v_and_b32 v47, 0xffff0000, v21
    v_lshlrev_b32 v48, 16, v22
    v_and_b32 v49, 0xffff0000, v22
    v_lshlrev_b32 v50, 16, v23
    v_and_b32 v51, 0xffff0000, v23
    v_fma_f32 v44, v44, v188, v191
    v_fma_f32 v45, v45, v188, v191
    v_fma_f32 v46, v46, v188, v191
    v_fma_f32 v47, v47, v188, v191
    v_fma_f32 v48, v48, v188, v191
    v_fma_f32 v49, v49, v188, v191
    v_fma_f32 v50, v50, v188, v191
    v_fma_f32 v51, v51, v188, v191
    v_fma_f32 v44, v44, v28, v36
    v_fma_f32 v45, v45, v29, v37
    v_fma_f32 v46, v46, v30, v38
    v_fma_f32 v47, v47, v31, v39
    v_fma_f32 v48, v48, v32, v40
    v_fma_f32 v49, v49, v33, v41
    v_fma_f32 v50, v50, v34, v42
    v_fma_f32 v51, v51, v35, v43
    v_cvt_pk_bf16_f32 v56, v44, v45
    v_cvt_pk_bf16_f32 v57, v46, v47
    v_cvt_pk_bf16_f32 v58, v48, v49
    v_cvt_pk_bf16_f32 v59, v50, v51
    ds_write_b128 v193, v[56:59] offset:5120
    s_cmp_ge_u32 s32, 2
    s_cbranch_scc1 k1_skip3
    v_lshlrev_b32 v44, 16, v24
    v_and_b32 v45, 0xffff0000, v24
    v_lshlrev_b32 v46, 16, v25
    v_and_b32 v47, 0xffff0000, v25
    v_lshlrev_b32 v48, 16, v26
    v_and_b32 v49, 0xffff0000, v26
    v_lshlrev_b32 v50, 16, v27
    v_and_b32 v51, 0xffff0000, v27
    v_fma_f32 v44, v44, v189, v192
    v_fma_f32 v45, v45, v189, v192
    v_fma_f32 v46, v46, v189, v192
    v_fma_f32 v47, v47, v189, v192
    v_fma_f32 v48, v48, v189, v192
    v_fma_f32 v49, v49, v189, v192
    v_fma_f32 v50, v50, v189, v192
    v_fma_f32 v51, v51, v189, v192
    v_fma_f32 v44, v44, v28, v36
    v_fma_f32 v45, v45, v29, v37
    v_fma_f32 v46, v46, v30, v38
    v_fma_f32 v47, v47, v31, v39
    v_fma_f32 v48, v48, v32, v40
    v_fma_f32 v49, v49, v33, v41
    v_fma_f32 v50, v50, v34, v42
    v_fma_f32 v51, v51, v35, v43
    v_cvt_pk_bf16_f32 v56, v44, v45
    v_cvt_pk_bf16_f32 v57, v46, v47
    v_cvt_pk_bf16_f32 v58, v48, v49
    v_cvt_pk_bf16_f32 v59, v50, v51
    ds_write_b128 v193, v[56:59] offset:10240
k1_skip3:
    s_nop 4
    buffer_load_dwordx4 v[16:19], v184, s[12:15], 0 offen offset:384
    buffer_load_dwordx4 v[20:23], v185, s[12:15], 0 offen offset:384
    buffer_load_dwordx4 v[24:27], v186, s[12:15], 0 offen offset:384
    s_waitcnt lgkmcnt(0)
    s_barrier
    s_add_u32 s49, s36, 786432
    s_add_u32 m0, s42, 54272
    s_nop 0
    buffer_load_dwordx4 v195, s[16:19], s49 offen lds
    s_add_u32 s49, s37, 786432
    s_add_u32 m0, s43, 54272
    s_nop 0
    buffer_load_dwordx4 v196, s[16:19], s49 offen lds
    s_add_u32 s49, s38, 786432
    s_add_u32 m0, s44, 54272
    s_nop 0
    buffer_load_dwordx4 v195, s[16:19], s49 offen lds
    s_add_u32 s49, s39, 786432
    s_add_u32 m0, s45, 54272
    s_nop 0
    buffer_load_dwordx4 v196, s[16:19], s49 offen lds
    s_add_u32 s49, s40, 786432
    s_add_u32 m0, s46, 54272
    s_nop 0
    buffer_load_dwordx4 v195, s[16:19], s49 offen lds
    s_add_u32 s49, s41, 786432
    s_add_u32 m0, s47, 54272
    s_nop 0
    buffer_load_dwordx4 v196, s[16:19], s49 offen lds
    ds_read_b128 v[64:67], v200 offset:0
    ds_read_b128 v[68:71], v200 offset:2560
    ds_read_b128 v[72:75], v200 offset:5120
    ds_read_b128 v[76:79], v200 offset:7680
    ds_read_b128 v[80:83], v200 offset:10240
    ds_read_b64_tr_b16 v[84:85], v199 offset:0
    ds_read_b64_tr_b16 v[86:87], v199 offset:512
    ds_read_b64_tr_b16 v[88:89], v199 offset:8192
    ds_read_b64_tr_b16 v[90:91], v199 offset:8704
    ds_read_b64_tr_b16 v[92:93], v199 offset:16384
    ds_read_b64_tr_b16 v[94:95], v199 offset:16896
    ds_read_b128 v[96:99], v200 offset:64
    ds_read_b128 v[100:103], v200 offset:2624
    ds_read_b128 v[104:107], v200 offset:5184
    ds_read_b128 v[108:111], v200 offset:7744
    s_waitcnt lgkmcnt(4)
    v_mfma_f32_16x16x32_bf16 v[128:131], v[84:87], v[68:71], v[128:131]
    ds_read_b128 v[112:115], v200 offset:10304
    v_mfma_f32_16x16x32_bf16 v[132:135], v[84:87], v[72:75], v[132:135]
    ds_read_b64_tr_b16 v[116:117], v199 offset:4096
    v_mfma_f32_16x16x32_bf16 v[136:139], v[84:87], v[76:79], v[136:139]
    ds_read_b64_tr_b16 v[118:119], v199 offset:4608
    v_mfma_f32_16x16x32_bf16 v[140:143], v[84:87], v[80:83], v[140:143]
    ds_read_b64_tr_b16 v[120:121], v199 offset:12288
    v_mfma_f32_16x16x32_bf16 v[144:147], v[88:91], v[64:67], v[144:147]
    ds_read_b64_tr_b16 v[122:123], v199 offset:12800
    v_mfma_f32_16x16x32_bf16 v[148:151], v[88:91], v[68:71], v[148:151]
    ds_read_b64_tr_b16 v[124:125], v199 offset:20480
    v_mfma_f32_16x16x32_bf16 v[152:155], v[88:91], v[72:75], v[152:155]
    ds_read_b64_tr_b16 v[126:127], v199 offset:20992
    v_mfma_f32_16x16x32_bf16 v[156:159], v[88:91], v[76:79], v[156:159]
    v_mfma_f32_16x16x32_bf16 v[160:163], v[88:91], v[80:83], v[160:163]
    v_mfma_f32_16x16x32_bf16 v[164:167], v[64:67], v[92:95], v[164:167]
    v_mfma_f32_16x16x32_bf16 v[168:171], v[68:71], v[92:95], v[168:171]
    v_mfma_f32_16x16x32_bf16 v[172:175], v[72:75], v[92:95], v[172:175]
    v_mfma_f32_16x16x32_bf16 v[176:179], v[76:79], v[92:95], v[176:179]
    v_mfma_f32_16x16x32_bf16 v[180:183], v[80:83], v[92:95], v[180:183]
    s_waitcnt lgkmcnt(0)
    v_mfma_f32_16x16x32_bf16 v[128:131], v[116:119], v[100:103], v[128:131]
    v_mfma_f32_16x16x32_bf16 v[132:135], v[116:119], v[104:107], v[132:135]
    v_mfma_f32_16x16x32_bf16 v[136:139], v[116:119], v[108:111], v[136:139]
    v_mfma_f32_16x16x32_bf16 v[140:143], v[116:119], v[112:115], v[140:143]
    v_mfma_f32_16x16x32_bf16 v[144:147], v[120:123], v[96:99], v[144:147]
    v_mfma_f32_16x16x32_bf16 v[148:151], v[120:123], v[100:103], v[148:151]
    v_mfma_f32_16x16x32_bf16 v[152:155], v[120:123], v[104:107], v[152:155]
    v_mfma_f32_16x16x32_bf16 v[156:159], v[120:123], v[108:111], v[156:159]
    v_mfma_f32_16x16x32_bf16 v[160:163], v[120:123], v[112:115], v[160:163]
    v_mfma_f32_16x16x32_bf16 v[164:167], v[96:99], v[124:127], v[164:167]
    v_mfma_f32_16x16x32_bf16 v[168:171], v[100:103], v[124:127], v[168:171]
    v_mfma_f32_16x16x32_bf16 v[172:175], v[104:107], v[124:127], v[172:175]
    v_mfma_f32_16x16x32_bf16 v[176:179], v[108:111], v[124:127], v[176:179]
    v_mfma_f32_16x16x32_bf16 v[180:183], v[112:115], v[124:127], v[180:183]
    ds_read_b128 v[28:31], v194 offset:768
    ds_read_b128 v[32:35], v194 offset:784
    ds_read_b128 v[36:39], v194 offset:2816
    ds_read_b128 v[40:43], v194 offset:2832
    s_waitcnt vmcnt(6)
    s_waitcnt lgkmcnt(0)
    v_lshlrev_b32 v44, 16, v16
    v_and_b32 v45, 0xffff0000, v16
    v_lshlrev_b32 v46, 16, v17
    v_and_b32 v47, 0xffff0000, v17
    v_lshlrev_b32 v48, 16, v18
    v_and_b32 v49, 0xffff0000, v18
    v_lshlrev_b32 v50, 16, v19
    v_and_b32 v51, 0xffff0000, v19
    v_fma_f32 v44, v44, v187, v190
    v_fma_f32 v45, v45, v187, v190
    v_fma_f32 v46, v46, v187, v190
    v_fma_f32 v47, v47, v187, v190
    v_fma_f32 v48, v48, v187, v190
    v_fma_f32 v49, v49, v187, v190
    v_fma_f32 v50, v50, v187, v190
    v_fma_f32 v51, v51, v187, v190
    v_fma_f32 v44, v44, v28, v36
    v_fma_f32 v45, v45, v29, v37
    v_fma_f32 v46, v46, v30, v38
    v_fma_f32 v47, v47, v31, v39
    v_fma_f32 v48, v48, v32, v40
    v_fma_f32 v49, v49, v33, v41
    v_fma_f32 v50, v50, v34, v42
    v_fma_f32 v51, v51, v35, v43
    v_cvt_pk_bf16_f32 v56, v44, v45
    v_cvt_pk_bf16_f32 v57, v46, v47
    v_cvt_pk_bf16_f32 v58, v48, v49
    v_cvt_pk_bf16_f32 v59, v50, v51
    ds_write_b128 v193, v[56:59] offset:12800
    v_lshlrev_b32 v44, 16, v20
    v_and_b32 v45, 0xffff0000, v20
    v_lshlrev_b32 v46, 16, v21
    v_and_b32 v47, 0xffff0000, v21
    v_lshlrev_b32 v48, 16, v22
    v_and_b32 v49, 0xffff0000, v22
    v_lshlrev_b32 v50, 16, v23
    v_and_b32 v51, 0xffff0000, v23
    v_fma_f32 v44, v44, v188, v191
    v_fma_f32 v45, v45, v188, v191
    v_fma_f32 v46, v46, v188, v191
    v_fma_f32 v47, v47, v188, v191
    v_fma_f32 v48, v48, v188, v191
    v_fma_f32 v49, v49, v188, v191
    v_fma_f32 v50, v50, v188, v191
    v_fma_f32 v51, v51, v188, v191
    v_fma_f32 v44, v44, v28, v36
    v_fma_f32 v45, v45, v29, v37
    v_fma_f32 v46, v46, v30, v38
    v_fma_f32 v47, v47, v31, v39
    v_fma_f32 v48, v48, v32, v40
    v_fma_f32 v49, v49, v33, v41
    v_fma_f32 v50, v50, v34, v42
    v_fma_f32 v51, v51, v35, v43
    v_cvt_pk_bf16_f32 v56, v44, v45
    v_cvt_pk_bf16_f32 v57, v46, v47
    v_cvt_pk_bf16_f32 v58, v48, v49
    v_cvt_pk_bf16_f32 v59, v50, v51
    ds_write_b128 v193, v[56:59] offset:17920
    s_cmp_ge_u32 s32, 2
    s_cbranch_scc1 k1_skip4
    v_lshlrev_b32 v44, 16, v24
    v_and_b32 v45, 0xffff0000, v24
    v_lshlrev_b32 v46, 16, v25
    v_and_b32 v47, 0xffff0000, v25
    v_lshlrev_b32 v48, 16, v26
    v_and_b32 v49, 0xffff0000, v26
    v_lshlrev_b32 v50, 16, v27
    v_and_b32 v51, 0xffff0000, v27
    v_fma_f32 v44, v44, v189, v192
    v_fma_f32 v45, v45, v189, v192
    v_fma_f32 v46, v46, v189, v192
    v_fma_f32 v47, v47, v189, v192
    v_fma_f32 v48, v48, v189, v192
    v_fma_f32 v49, v49, v189, v192
    v_fma_f32 v50, v50, v189, v192
    v_fma_f32 v51, v51, v189, v192
    v_fma_f32 v44, v44, v28, v36
    v_fma_f32 v45, v45, v29, v37
    v_fma_f32 v46, v46, v30, v38
    v_fma_f32 v47, v47, v31, v39
    v_fma_f32 v48, v48, v32, v40
    v_fma_f32 v49, v49, v33, v41
    v_fma_f32 v50, v50, v34, v42
    v_fma_f32 v51, v51, v35, v43
    v_cvt_pk_bf16_f32 v56, v44, v45
    v_cvt_pk_bf16_f32 v57, v46, v47
    v_cvt_pk_bf16_f32 v58, v48, v49
    v_cvt_pk_bf16_f32 v59, v50, v51
    ds_write_b128 v193, v[56:59] offset:23040
k1_skip4:
    s_nop 4
    buffer_load_dwordx4 v[16:19], v184, s[12:15], 0 offen offset:512
    buffer_load_dwordx4 v[20:23], v185, s[12:15], 0 offen offset:512
    buffer_load_dwordx4 v[24:27], v186, s[12:15], 0 offen offset:512
    s_waitcnt lgkmcnt(0)
    s_barrier
    s_add_u32 s49, s36, 983040
    s_add_u32 m0, s42, 78848
    s_nop 0
    buffer_load_dwordx4 v195, s[16:19], s49 offen lds
    s_add_u32 s49, s37, 983040
    s_add_u32 m0, s43, 78848
    s_nop 0
    buffer_load_dwordx4 v196, s[16:19], s49 offen lds
    s_add_u32 s49, s38, 983040
    s_add_u32 m0, s44, 78848
    s_nop 0
    buffer_load_dwordx4 v195, s[16:19], s49 offen lds
    s_add_u32 s49, s39, 983040
    s_add_u32 m0, s45, 78848
    s_nop 0
    buffer_load_dwordx4 v196, s[16:19], s49 offen lds
    s_add_u32 s49, s40, 983040
    s_add_u32 m0, s46, 78848
    s_nop 0
    buffer_load_dwordx4 v195, s[16:19], s49 offen lds
    s_add_u32 s49, s41, 983040
    s_add_u32 m0, s47, 78848
    s_nop 0
    buffer_load_dwordx4 v196, s[16:19], s49 offen lds
    ds_read_b128 v[64:67], v200 offset:12800
    ds_read_b128 v[68:71], v200 offset:15360
    ds_read_b128 v[72:75], v200 offset:17920
    ds_read_b128 v[76:79], v200 offset:20480
    ds_read_b128 v[80:83], v200 offset:23040
    ds_read_b64_tr_b16 v[84:85], v197 offset:0
    ds_read_b64_tr_b16 v[86:87], v197 offset:512
    ds_read_b64_tr_b16 v[88:89], v197 offset:8192
    ds_read_b64_tr_b16 v[90:91], v197 offset:8704
    ds_read_b64_tr_b16 v[92:93], v197 offset:16384
    ds_read_b64_tr_b16 v[94:95], v197 offset:16896
    ds_read_b128 v[96:99], v200 offset:12864
    ds_read_b128 v[100:103], v200 offset:15424
    ds_read_b128 v[104:107], v200 offset:17984
    ds_read_b128 v[108:111], v200 offset:20544
    s_waitcnt lgkmcnt(4)
    v_mfma_f32_16x16x32_bf16 v[128:131], v[84:87], v[68:71], v[128:131]
    ds_read_b128 v[112:115], v200 offset:23104
    v_mfma_f32_16x16x32_bf16 v[132:135], v[84:87], v[72:75], v[132:135]
    ds_read_b64_tr_b16 v[116:117], v197 offset:4096
    v_mfma_f32_16x16x32_bf16 v[136:139], v[84:87], v[76:79], v[136:139]
    ds_read_b64_tr_b16 v[118:119], v197 offset:4608
    v_mfma_f32_16x16x32_bf16 v[140:143], v[84:87], v[80:83], v[140:143]
    ds_read_b64_tr_b16 v[120:121], v197 offset:12288
    v_mfma_f32_16x16x32_bf16 v[144:147], v[88:91], v[64:67], v[144:147]
    ds_read_b64_tr_b16 v[122:123], v197 offset:12800
    v_mfma_f32_16x16x32_bf16 v[148:151], v[88:91], v[68:71], v[148:151]
    ds_read_b64_tr_b16 v[124:125], v197 offset:20480
    v_mfma_f32_16x16x32_bf16 v[152:155], v[88:91], v[72:75], v[152:155]
    ds_read_b64_tr_b16 v[126:127], v197 offset:20992
    v_mfma_f32_16x16x32_bf16 v[156:159], v[88:91], v[76:79], v[156:159]
    v_mfma_f32_16x16x32_bf16 v[160:163], v[88:91], v[80:83], v[160:163]
    v_mfma_f32_16x16x32_bf16 v[164:167], v[64:67], v[92:95], v[164:167]
    v_mfma_f32_16x16x32_bf16 v[168:171], v[68:71], v[92:95], v[168:171]
    v_mfma_f32_16x16x32_bf16 v[172:175], v[72:75], v[92:95], v[172:175]
    v_mfma_f32_16x16x32_bf16 v[176:179], v[76:79], v[92:95], v[176:179]
    v_mfma_f32_16x16x32_bf16 v[180:183], v[80:83], v[92:95], v[180:183]
    s_waitcnt lgkmcnt(0)
    v_mfma_f32_16x16x32_bf16 v[128:131], v[116:119], v[100:103], v[128:131]
    v_mfma_f32_16x16x32_bf16 v[132:135], v[116:119], v[104:107], v[132:135]
    v_mfma_f32_16x16x32_bf16 v[136:139], v[116:119], v[108:111], v[136:139]
    v_mfma_f32_16x16x32_bf16 v[140:143], v[116:119], v[112:115], v[140:143]
    v_mfma_f32_16x16x32_bf16 v[144:147], v[120:123], v[96:99], v[144:147]
    v_mfma_f32_16x16x32_bf16 v[148:151], v[120:123], v[100:103], v[148:151]
    v_mfma_f32_16x16x32_bf16 v[152:155], v[120:123], v[104:107], v[152:155]
    v_mfma_f32_16x16x32_bf16 v[156:159], v[120:123], v[108:111], v[156:159]
    v_mfma_f32_16x16x32_bf16 v[160:163], v[120:123], v[112:115], v[160:163]
    v_mfma_f32_16x16x32_bf16 v[164:167], v[96:99], v[124:127], v[164:167]
    v_mfma_f32_16x16x32_bf16 v[168:171], v[100:103], v[124:127], v[168:171]
    v_mfma_f32_16x16x32_bf16 v[172:175], v[104:107], v[124:127], v[172:175]
    v_mfma_f32_16x16x32_bf16 v[176:179], v[108:111], v[124:127], v[176:179]
    v_mfma_f32_16x16x32_bf16 v[180:183], v[112:115], v[124:127], v[180:183]
    ds_read_b128 v[28:31], v194 offset:1024
    ds_read_b128 v[32:35], v194 offset:1040
    ds_read_b128 v[36:39], v194 offset:3072
    ds_read_b128 v[40:43], v194 offset:3088
    s_waitcnt vmcnt(6)
    s_waitcnt lgkmcnt(0)
    v_lshlrev_b32 v44, 16, v16
    v_and_b32 v45, 0xffff0000, v16
    v_lshlrev_b32 v46, 16, v17
    v_and_b32 v47, 0xffff0000, v17
    v_lshlrev_b32 v48, 16, v18
    v_and_b32 v49, 0xffff0000, v18
    v_lshlrev_b32 v50, 16, v19
    v_and_b32 v51, 0xffff0000, v19
    v_fma_f32 v44, v44, v187, v190
    v_fma_f32 v45, v45, v187, v190
    v_fma_f32 v46, v46, v187, v190
    v_fma_f32 v47, v47, v187, v190
    v_fma_f32 v48, v48, v187, v190
    v_fma_f32 v49, v49, v187, v190
    v_fma_f32 v50, v50, v187, v190
    v_fma_f32 v51, v51, v187, v190
    v_fma_f32 v44, v44, v28, v36
    v_fma_f32 v45, v45, v29, v37
    v_fma_f32 v46, v46, v30, v38
    v_fma_f32 v47, v47, v31, v39
    v_fma_f32 v48, v48, v32, v40
    v_fma_f32 v49, v49, v33, v41
    v_fma_f32 v50, v50, v34, v42
    v_fma_f32 v51, v51, v35, v43
    v_cvt_pk_bf16_f32 v56, v44, v45
    v_cvt_pk_bf16_f32 v57, v46, v47
    v_cvt_pk_bf16_f32 v58, v48, v49
    v_cvt_pk_bf16_f32 v59, v50, v51
    ds_write_b128 v193, v[56:59] offset:0
    v_lshlrev_b32 v44, 16, v20
    v_and_b32 v45, 0xffff0000, v20
    v_lshlrev_b32 v46, 16, v21
    v_and_b32 v47, 0xffff0000, v21
    v_lshlrev_b32 v48, 16, v22
    v_and_b32 v49, 0xffff0000, v22
    v_lshlrev_b32 v50, 16, v23
    v_and_b32 v51, 0xffff0000, v23
    v_fma_f32 v44, v44, v188, v191
    v_fma_f32 v45, v45, v188, v191
    v_fma_f32 v46, v46, v188, v191
    v_fma_f32 v47, v47, v188, v191
    v_fma_f32 v48, v48, v188, v191
    v_fma_f32 v49, v49, v188, v191
    v_fma_f32 v50, v50, v188, v191
    v_fma_f32 v51, v51, v188, v191
    v_fma_f32 v44, v44, v28, v36
    v_fma_f32 v45, v45, v29, v37
    v_fma_f32 v46, v46, v30, v38
    v_fma_f32 v47, v47, v31, v39
    v_fma_f32 v48, v48, v32, v40
    v_fma_f32 v49, v49, v33, v41
    v_fma_f32 v50, v50, v34, v42
    v_fma_f32 v51, v51, v35, v43
    v_cvt_pk_bf16_f32 v56, v44, v45
    v_cvt_pk_bf16_f32 v57, v46, v47
    v_cvt_pk_bf16_f32 v58, v48, v49
    v_cvt_pk_bf16_f32 v59, v50, v51
    ds_write_b128 v193, v[56:59] offset:5120
    s_cmp_ge_u32 s32, 2
    s_cbranch_scc1 k1_skip5
    v_lshlrev_b32 v44, 16, v24
    v_and_b32 v45, 0xffff0000, v24
    v_lshlrev_b32 v46, 16, v25
    v_and_b32 v47, 0xffff0000, v25
    v_lshlrev_b32 v48, 16, v26
    v_and_b32 v49, 0xffff0000, v26
    v_lshlrev_b32 v50, 16, v27
    v_and_b32 v51, 0xffff0000, v27
    v_fma_f32 v44, v44, v189, v192
    v_fma_f32 v45, v45, v189, v192
    v_fma_f32 v46, v46, v189, v192
    v_fma_f32 v47, v47, v189, v192
    v_fma_f32 v48, v48, v189, v192
    v_fma_f32 v49, v49, v189, v192
    v_fma_f32 v50, v50, v189, v192
    v_fma_f32 v51, v51, v189, v192
    v_fma_f32 v44, v44, v28, v36
    v_fma_f32 v45, v45, v29, v37
    v_fma_f32 v46, v46, v30, v38
    v_fma_f32 v47, v47, v31, v39
    v_fma_f32 v48, v48, v32, v40
    v_fma_f32 v49, v49, v33, v41
    v_fma_f32 v50, v50, v34, v42
    v_fma_f32 v51, v51, v35, v43
    v_cvt_pk_bf16_f32 v56, v44, v45
    v_cvt_pk_bf16_f32 v57, v46, v47
    v_cvt_pk_bf16_f32 v58, v48, v49
    v_cvt_pk_bf16_f32 v59, v50, v51
    ds_write_b128 v193, v[56:59] offset:10240
k1_skip5:
    s_nop 4
    buffer_load_dwordx4 v[16:19], v184, s[12:15], 0 offen offset:640
    buffer_load_dwordx4 v[20:23], v185, s[12:15], 0 offen offset:640
    buffer_load_dwordx4 v[24:27], v186, s[12:15], 0 offen offset:640
    s_waitcnt lgkmcnt(0)
    s_barrier
    s_add_u32 s49, s36, 1179648
    s_add_u32 m0, s42, 29696
    s_nop 0
    buffer_load_dwordx4 v195, s[16:19], s49 offen lds
    s_add_u32 s49, s37, 1179648
    s_add_u32 m0, s43, 29696
    s_nop 0
    buffer_load_dwordx4 v196, s[16:19], s49 offen lds
    s_add_u32 s49, s38, 1179648
    s_add_u32 m0, s44, 29696
    s_nop 0
    buffer_load_dwordx4 v195, s[16:19], s49 offen lds
    s_add_u32 s49, s39, 1179648
    s_add_u32 m0, s45, 29696
    s_nop 0
    buffer_load_dwordx4 v196, s[16:19], s49 offen lds
    s_add_u32 s49, s40, 1179648
    s_add_u32 m0, s46, 29696
    s_nop 0
    buffer_load_dwordx4 v195, s[16:19], s49 offen lds
    s_add_u32 s49, s41, 1179648
    s_add_u32 m0, s47, 29696
    s_nop 0
    buffer_load_dwordx4 v196, s[16:19], s49 offen lds
    ds_read_b128 v[64:67], v200 offset:0
    ds_read_b128 v[68:71], v200 offset:2560
    ds_read_b128 v[72:75], v200 offset:5120
    ds_read_b128 v[76:79], v200 offset:7680
    ds_read_b128 v[80:83], v200 offset:10240
    ds_read_b64_tr_b16 v[84:85], v198 offset:0
    ds_read_b64_tr_b16 v[86:87], v198 offset:512
    ds_read_b64_tr_b16 v[88:89], v198 offset:8192
    ds_read_b64_tr_b16 v[90:91], v198 offset:8704
    ds_read_b64_tr_b16 v[92:93], v198 offset:16384
    ds_read_b64_tr_b16 v[94:95], v198 offset:16896
    ds_read_b128 v[96:99], v200 offset:64
    ds_read_b128 v[100:103], v200 offset:2624
    ds_read_b128 v[104:107], v200 offset:5184
    ds_read_b128 v[108:111], v200 offset:7744
    s_waitcnt lgkmcnt(4)
    v_mfma_f32_16x16x32_bf16 v[128:131], v[84:87], v[68:71], v[128:131]
    ds_read_b128 v[112:115], v200 offset:10304
    v_mfma_f32_16x16x32_bf16 v[132:135], v[84:87], v[72:75], v[132:135]
    ds_read_b64_tr_b16 v[116:117], v198 offset:4096
    v_mfma_f32_16x16x32_bf16 v[136:139], v[84:87], v[76:79], v[136:139]
    ds_read_b64_tr_b16 v[118:119], v198 offset:4608
    v_mfma_f32_16x16x32_bf16 v[140:143], v[84:87], v[80:83], v[140:143]
    ds_read_b64_tr_b16 v[120:121], v198 offset:12288
    v_mfma_f32_16x16x32_bf16 v[144:147], v[88:91], v[64:67], v[144:147]
    ds_read_b64_tr_b16 v[122:123], v198 offset:12800
    v_mfma_f32_16x16x32_bf16 v[148:151], v[88:91], v[68:71], v[148:151]
    ds_read_b64_tr_b16 v[124:125], v198 offset:20480
    v_mfma_f32_16x16x32_bf16 v[152:155], v[88:91], v[72:75], v[152:155]
    ds_read_b64_tr_b16 v[126:127], v198 offset:20992
    v_mfma_f32_16x16x32_bf16 v[156:159], v[88:91], v[76:79], v[156:159]
    v_mfma_f32_16x16x32_bf16 v[160:163], v[88:91], v[80:83], v[160:163]
    v_mfma_f32_16x16x32_bf16 v[164:167], v[64:67], v[92:95], v[164:167]
    v_mfma_f32_16x16x32_bf16 v[168:171], v[68:71], v[92:95], v[168:171]
    v_mfma_f32_16x16x32_bf16 v[172:175], v[72:75], v[92:95], v[172:175]
    v_mfma_f32_16x16x32_bf16 v[176:179], v[76:79], v[92:95], v[176:179]
    v_mfma_f32_16x16x32_bf16 v[180:183], v[80:83], v[92:95], v[180:183]
    s_waitcnt lgkmcnt(0)
    v_mfma_f32_16x16x32_bf16 v[128:131], v[116:119], v[100:103], v[128:131]
    v_mfma_f32_16x16x32_bf16 v[132:135], v[116:119], v[104:107], v[132:135]
    v_mfma_f32_16x16x32_bf16 v[136:139], v[116:119], v[108:111], v[136:139]
    v_mfma_f32_16x16x32_bf16 v[140:143], v[116:119], v[112:115], v[140:143]
    v_mfma_f32_16x16x32_bf16 v[144:147], v[120:123], v[96:99], v[144:147]
    v_mfma_f32_16x16x32_bf16 v[148:151], v[120:123], v[100:103], v[148:151]
    v_mfma_f32_16x16x32_bf16 v[152:155], v[120:123], v[104:107], v[152:155]
    v_mfma_f32_16x16x32_bf16 v[156:159], v[120:123], v[108:111], v[156:159]
    v_mfma_f32_16x16x32_bf16 v[160:163], v[120:123], v[112:115], v[160:163]
    v_mfma_f32_16x16x32_bf16 v[164:167], v[96:99], v[124:127], v[164:167]
    v_mfma_f32_16x16x32_bf16 v[168:171], v[100:103], v[124:127], v[168:171]
    v_mfma_f32_16x16x32_bf16 v[172:175], v[104:107], v[124:127], v[172:175]
    v_mfma_f32_16x16x32_bf16 v[176:179], v[108:111], v[124:127], v[176:179]
    v_mfma_f32_16x16x32_bf16 v[180:183], v[112:115], v[124:127], v[180:183]
    ds_read_b128 v[28:31], v194 offset:1280
    ds_read_b128 v[32:35], v194 offset:1296
    ds_read_b128 v[36:39], v194 offset:3328
    ds_read_b128 v[40:43], v194 offset:3344
    s_waitcnt vmcnt(6)
    s_waitcnt lgkmcnt(0)
    v_lshlrev_b32 v44, 16, v16
    v_and_b32 v45, 0xffff0000, v16
    v_lshlrev_b32 v46, 16, v17
    v_and_b32 v47, 0xffff0000, v17
    v_lshlrev_b32 v48, 16, v18
    v_and_b32 v49, 0xffff0000, v18
    v_lshlrev_b32 v50, 16, v19
    v_and_b32 v51, 0xffff0000, v19
    v_fma_f32 v44, v44, v187, v190
    v_fma_f32 v45, v45, v187, v190
    v_fma_f32 v46, v46, v187, v190
    v_fma_f32 v47, v47, v187, v190
    v_fma_f32 v48, v48, v187, v190
    v_fma_f32 v49, v49, v187, v190
    v_fma_f32 v50, v50, v187, v190
    v_fma_f32 v51, v51, v187, v190
    v_fma_f32 v44, v44, v28, v36
    v_fma_f32 v45, v45, v29, v37
    v_fma_f32 v46, v46, v30, v38
    v_fma_f32 v47, v47, v31, v39
    v_fma_f32 v48, v48, v32, v40
    v_fma_f32 v49, v49, v33, v41
    v_fma_f32 v50, v50, v34, v42
    v_fma_f32 v51, v51, v35, v43
    v_cvt_pk_bf16_f32 v56, v44, v45
    v_cvt_pk_bf16_f32 v57, v46, v47
    v_cvt_pk_bf16_f32 v58, v48, v49
    v_cvt_pk_bf16_f32 v59, v50, v51
    ds_write_b128 v193, v[56:59] offset:12800
    v_lshlrev_b32 v44, 16, v20
    v_and_b32 v45, 0xffff0000, v20
    v_lshlrev_b32 v46, 16, v21
    v_and_b32 v47, 0xffff0000, v21
    v_lshlrev_b32 v48, 16, v22
    v_and_b32 v49, 0xffff0000, v22
    v_lshlrev_b32 v50, 16, v23
    v_and_b32 v51, 0xffff0000, v23
    v_fma_f32 v44, v44, v188, v191
    v_fma_f32 v45, v45, v188, v191
    v_fma_f32 v46, v46, v188, v191
    v_fma_f32 v47, v47, v188, v191
    v_fma_f32 v48, v48, v188, v191
    v_fma_f32 v49, v49, v188, v191
    v_fma_f32 v50, v50, v188, v191
    v_fma_f32 v51, v51, v188, v191
    v_fma_f32 v44, v44, v28, v36
    v_fma_f32 v45, v45, v29, v37
    v_fma_f32 v46, v46, v30, v38
    v_fma_f32 v47, v47, v31, v39
    v_fma_f32 v48, v48, v32, v40
    v_fma_f32 v49, v49, v33, v41
    v_fma_f32 v50, v50, v34, v42
    v_fma_f32 v51, v51, v35, v43
    v_cvt_pk_bf16_f32 v56, v44, v45
    v_cvt_pk_bf16_f32 v57, v46, v47
    v_cvt_pk_bf16_f32 v58, v48, v49
    v_cvt_pk_bf16_f32 v59, v50, v51
    ds_write_b128 v193, v[56:59] offset:17920
    s_cmp_ge_u32 s32, 2
    s_cbranch_scc1 k1_skip6
    v_lshlrev_b32 v44, 16, v24
    v_and_b32 v45, 0xffff0000, v24
    v_lshlrev_b32 v46, 16, v25
    v_and_b32 v47, 0xffff0000, v25
    v_lshlrev_b32 v48, 16, v26
    v_and_b32 v49, 0xffff0000, v26
    v_lshlrev_b32 v50, 16, v27
    v_and_b32 v51, 0xffff0000, v27
    v_fma_f32 v44, v44, v189, v192
    v_fma_f32 v45, v45, v189, v192
    v_fma_f32 v46, v46, v189, v192
    v_fma_f32 v47, v47, v189, v192
    v_fma_f32 v48, v48, v189, v192
    v_fma_f32 v49, v49, v189, v192
    v_fma_f32 v50, v50, v189, v192
    v_fma_f32 v51, v51, v189, v192
    v_fma_f32 v44, v44, v28, v36
    v_fma_f32 v45, v45, v29, v37
    v_fma_f32 v46, v46, v30, v38
    v_fma_f32 v47, v47, v31, v39
    v_fma_f32 v48, v48, v32, v40
    v_fma_f32 v49, v49, v33, v41
    v_fma_f32 v50, v50, v34, v42
    v_fma_f32 v51, v51, v35, v43
    v_cvt_pk_bf16_f32 v56, v44, v45
    v_cvt_pk_bf16_f32 v57, v46, v47
    v_cvt_pk_bf16_f32 v58, v48, v49
    v_cvt_pk_bf16_f32 v59, v50, v51
    ds_write_b128 v193, v[56:59] offset:23040
k1_skip6:
    s_nop 4
    buffer_load_dwordx4 v[16:19], v184, s[12:15], 0 offen offset:768
    buffer_load_dwordx4 v[20:23], v185, s[12:15], 0 offen offset:768
    buffer_load_dwordx4 v[24:27], v186, s[12:15], 0 offen offset:768
    s_waitcnt lgkmcnt(0)
    s_barrier
    s_add_u32 s49, s36, 1376256
    s_add_u32 m0, s42, 54272
    s_nop 0
    buffer_load_dwordx4 v195, s[16:19], s49 offen lds
    s_add_u32 s49, s37, 1376256
    s_add_u32 m0, s43, 54272
    s_nop 0
    buffer_load_dwordx4 v196, s[16:19], s49 offen lds
    s_add_u32 s49, s38, 1376256
    s_add_u32 m0, s44, 54272
    s_nop 0
    buffer_load_dwordx4 v195, s[16:19], s49 offen lds
    s_add_u32 s49, s39, 1376256
    s_add_u32 m0, s45, 54272
    s_nop 0
    buffer_load_dwordx4 v196, s[16:19], s49 offen lds
    s_add_u32 s49, s40, 1376256
    s_add_u32 m0, s46, 54272
    s_nop 0
    buffer_load_dwordx4 v195, s[16:19], s49 offen lds
    s_add_u32 s49, s41, 1376256
    s_add_u32 m0, s47, 54272
    s_nop 0
    buffer_load_dwordx4 v196, s[16:19], s49 offen lds
    ds_read_b128 v[64:67], v200 offset:12800
    ds_read_b128 v[68:71], v200 offset:15360
    ds_read_b128 v[72:75], v200 offset:17920
    ds_read_b128 v[76:79], v200 offset:20480
    ds_read_b128 v[80:83], v200 offset:23040
    ds_read_b64_tr_b16 v[84:85], v199 offset:0
    ds_read_b64_tr_b16 v[86:87], v199 offset:512
    ds_read_b64_tr_b16 v[88:89], v199 offset:8192
    ds_read_b64_tr_b16 v[90:91], v199 offset:8704
    ds_read_b64_tr_b16 v[92:93], v199 offset:16384
    ds_read_b64_tr_b16 v[94:95], v199 offset:16896
    ds_read_b128 v[96:99], v200 offset:12864
    ds_read_b128 v[100:103], v200 offset:15424
    ds_read_b128 v[104:107], v200 offset:17984
    ds_read_b128 v[108:111], v200 offset:20544
    s_waitcnt lgkmcnt(4)
    v_mfma_f32_16x16x32_bf16 v[128:131], v[84:87], v[68:71], v[128:131]
    ds_read_b128 v[112:115], v200 offset:23104
    v_mfma_f32_16x16x32_bf16 v[132:135], v[84:87], v[72:75], v[132:135]
    ds_read_b64_tr_b16 v[116:117], v199 offset:4096
    v_mfma_f32_16x16x32_bf16 v[136:139], v[84:87], v[76:79], v[136:139]
    ds_read_b64_tr_b16 v[118:119], v199 offset:4608
    v_mfma_f32_16x16x32_bf16 v[140:143], v[84:87], v[80:83], v[140:143]
    ds_read_b64_tr_b16 v[120:121], v199 offset:12288
    v_mfma_f32_16x16x32_bf16 v[144:147], v[88:91], v[64:67], v[144:147]
    ds_read_b64_tr_b16 v[122:123], v199 offset:12800
    v_mfma_f32_16x16x32_bf16 v[148:151], v[88:91], v[68:71], v[148:151]
    ds_read_b64_tr_b16 v[124:125], v199 offset:20480
    v_mfma_f32_16x16x32_bf16 v[152:155], v[88:91], v[72:75], v[152:155]
    ds_read_b64_tr_b16 v[126:127], v199 offset:20992
    v_mfma_f32_16x16x32_bf16 v[156:159], v[88:91], v[76:79], v[156:159]
    v_mfma_f32_16x16x32_bf16 v[160:163], v[88:91], v[80:83], v[160:163]
    v_mfma_f32_16x16x32_bf16 v[164:167], v[64:67], v[92:95], v[164:167]
    v_mfma_f32_16x16x32_bf16 v[168:171], v[68:71], v[92:95], v[168:171]
    v_mfma_f32_16x16x32_bf16 v[172:175], v[72:75], v[92:95], v[172:175]
    v_mfma_f32_16x16x32_bf16 v[176:179], v[76:79], v[92:95], v[176:179]
    v_mfma_f32_16x16x32_bf16 v[180:183], v[80:83], v[92:95], v[180:183]
    s_waitcnt lgkmcnt(0)
    v_mfma_f32_16x16x32_bf16 v[128:131], v[116:119], v[100:103], v[128:131]
    v_mfma_f32_16x16x32_bf16 v[132:135], v[116:119], v[104:107], v[132:135]
    v_mfma_f32_16x16x32_bf16 v[136:139], v[116:119], v[108:111], v[136:139]
    v_mfma_f32_16x16x32_bf16 v[140:143], v[116:119], v[112:115], v[140:143]
    v_mfma_f32_16x16x32_bf16 v[144:147], v[120:123], v[96:99], v[144:147]
    v_mfma_f32_16x16x32_bf16 v[148:151], v[120:123], v[100:103], v[148:151]
    v_mfma_f32_16x16x32_bf16 v[152:155], v[120:123], v[104:107], v[152:155]
    v_mfma_f32_16x16x32_bf16 v[156:159], v[120:123], v[108:111], v[156:159]
    v_mfma_f32_16x16x32_bf16 v[160:163], v[120:123], v[112:115], v[160:163]
    v_mfma_f32_16x16x32_bf16 v[164:167], v[96:99], v[124:127], v[164:167]
    v_mfma_f32_16x16x32_bf16 v[168:171], v[100:103], v[124:127], v[168:171]
    v_mfma_f32_16x16x32_bf16 v[172:175], v[104:107], v[124:127], v[172:175]
    v_mfma_f32_16x16x32_bf16 v[176:179], v[108:111], v[124:127], v[176:179]
    v_mfma_f32_16x16x32_bf16 v[180:183], v[112:115], v[124:127], v[180:183]
    ds_read_b128 v[28:31], v194 offset:1536
    ds_read_b128 v[32:35], v194 offset:1552
    ds_read_b128 v[36:39], v194 offset:3584
    ds_read_b128 v[40:43], v194 offset:3600
    s_waitcnt vmcnt(6)
    s_waitcnt lgkmcnt(0)
    v_lshlrev_b32 v44, 16, v16
    v_and_b32 v45, 0xffff0000, v16
    v_lshlrev_b32 v46, 16, v17
    v_and_b32 v47, 0xffff0000, v17
    v_lshlrev_b32 v48, 16, v18
    v_and_b32 v49, 0xffff0000, v18
    v_lshlrev_b32 v50, 16, v19
    v_and_b32 v51, 0xffff0000, v19
    v_fma_f32 v44, v44, v187, v190
    v_fma_f32 v45, v45, v187, v190
    v_fma_f32 v46, v46, v187, v190
    v_fma_f32 v47, v47, v187, v190
    v_fma_f32 v48, v48, v187, v190
    v_fma_f32 v49, v49, v187, v190
    v_fma_f32 v50, v50, v187, v190
    v_fma_f32 v51, v51, v187, v190
    v_fma_f32 v44, v44, v28, v36
    v_fma_f32 v45, v45, v29, v37
    v_fma_f32 v46, v46, v30, v38
    v_fma_f32 v47, v47, v31, v39
    v_fma_f32 v48, v48, v32, v40
    v_fma_f32 v49, v49, v33, v41
    v_fma_f32 v50, v50, v34, v42
    v_fma_f32 v51, v51, v35, v43
    v_cvt_pk_bf16_f32 v56, v44, v45
    v_cvt_pk_bf16_f32 v57, v46, v47
    v_cvt_pk_bf16_f32 v58, v48, v49
    v_cvt_pk_bf16_f32 v59, v50, v51
    ds_write_b128 v193, v[56:59] offset:0
    v_lshlrev_b32 v44, 16, v20
    v_and_b32 v45, 0xffff0000, v20
    v_lshlrev_b32 v46, 16, v21
    v_and_b32 v47, 0xffff0000, v21
    v_lshlrev_b32 v48, 16, v22
    v_and_b32 v49, 0xffff0000, v22
    v_lshlrev_b32 v50, 16, v23
    v_and_b32 v51, 0xffff0000, v23
    v_fma_f32 v44, v44, v188, v191
    v_fma_f32 v45, v45, v188, v191
    v_fma_f32 v46, v46, v188, v191
    v_fma_f32 v47, v47, v188, v191
    v_fma_f32 v48, v48, v188, v191
    v_fma_f32 v49, v49, v188, v191
    v_fma_f32 v50, v50, v188, v191
    v_fma_f32 v51, v51, v188, v191
    v_fma_f32 v44, v44, v28, v36
    v_fma_f32 v45, v45, v29, v37
    v_fma_f32 v46, v46, v30, v38
    v_fma_f32 v47, v47, v31, v39
    v_fma_f32 v48, v48, v32, v40
    v_fma_f32 v49, v49, v33, v41
    v_fma_f32 v50, v50, v34, v42
    v_fma_f32 v51, v51, v35, v43
    v_cvt_pk_bf16_f32 v56, v44, v45
    v_cvt_pk_bf16_f32 v57, v46, v47
    v_cvt_pk_bf16_f32 v58, v48, v49
    v_cvt_pk_bf16_f32 v59, v50, v51
    ds_write_b128 v193, v[56:59] offset:5120
    s_cmp_ge_u32 s32, 2
    s_cbranch_scc1 k1_skip7
    v_lshlrev_b32 v44, 16, v24
    v_and_b32 v45, 0xffff0000, v24
    v_lshlrev_b32 v46, 16, v25
    v_and_b32 v47, 0xffff0000, v25
    v_lshlrev_b32 v48, 16, v26
    v_and_b32 v49, 0xffff0000, v26
    v_lshlrev_b32 v50, 16, v27
    v_and_b32 v51, 0xffff0000, v27
    v_fma_f32 v44, v44, v189, v192
    v_fma_f32 v45, v45, v189, v192
    v_fma_f32 v46, v46, v189, v192
    v_fma_f32 v47, v47, v189, v192
    v_fma_f32 v48, v48, v189, v192
    v_fma_f32 v49, v49, v189, v192
    v_fma_f32 v50, v50, v189, v192
    v_fma_f32 v51, v51, v189, v192
    v_fma_f32 v44, v44, v28, v36
    v_fma_f32 v45, v45, v29, v37
    v_fma_f32 v46, v46, v30, v38
    v_fma_f32 v47, v47, v31, v39
    v_fma_f32 v48, v48, v32, v40
    v_fma_f32 v49, v49, v33, v41
    v_fma_f32 v50, v50, v34, v42
    v_fma_f32 v51, v51, v35, v43
    v_cvt_pk_bf16_f32 v56, v44, v45
    v_cvt_pk_bf16_f32 v57, v46, v47
    v_cvt_pk_bf16_f32 v58, v48, v49
    v_cvt_pk_bf16_f32 v59, v50, v51
    ds_write_b128 v193, v[56:59] offset:10240
k1_skip7:
    s_nop 4
    buffer_load_dwordx4 v[16:19], v184, s[12:15], 0 offen offset:896
    buffer_load_dwordx4 v[20:23], v185, s[12:15], 0 offen offset:896
    buffer_load_dwordx4 v[24:27], v186, s[12:15], 0 offen offset:896
    s_waitcnt lgkmcnt(0)
    s_barrier
    ds_read_b128 v[64:67], v200 offset:0
    ds_read_b128 v[68:71], v200 offset:2560
    ds_read_b128 v[72:75], v200 offset:5120
    ds_read_b128 v[76:79], v200 offset:7680
    ds_read_b128 v[80:83], v200 offset:10240
    ds_read_b64_tr_b16 v[84:85], v197 offset:0
    ds_read_b64_tr_b16 v[86:87], v197 offset:512
    ds_read_b64_tr_b16 v[88:89], v197 offset:8192
    ds_read_b64_tr_b16 v[90:91], v197 offset:8704
    ds_read_b64_tr_b16 v[92:93], v197 offset:16384
    ds_read_b64_tr_b16 v[94:95], v197 offset:16896
    ds_read_b128 v[96:99], v200 offset:64
    ds_read_b128 v[100:103], v200 offset:2624
    ds_read_b128 v[104:107], v200 offset:5184
    ds_read_b128 v[108:111], v200 offset:7744
    s_waitcnt lgkmcnt(4)
    v_mfma_f32_16x16x32_bf16 v[128:131], v[84:87], v[68:71], v[128:131]
    ds_read_b128 v[112:115], v200 offset:10304
    v_mfma_f32_16x16x32_bf16 v[132:135], v[84:87], v[72:75], v[132:135]
    ds_read_b64_tr_b16 v[116:117], v197 offset:4096
    v_mfma_f32_16x16x32_bf16 v[136:139], v[84:87], v[76:79], v[136:139]
    ds_read_b64_tr_b16 v[118:119], v197 offset:4608
    v_mfma_f32_16x16x32_bf16 v[140:143], v[84:87], v[80:83], v[140:143]
    ds_read_b64_tr_b16 v[120:121], v197 offset:12288
    v_mfma_f32_16x16x32_bf16 v[144:147], v[88:91], v[64:67], v[144:147]
    ds_read_b64_tr_b16 v[122:123], v197 offset:12800
    v_mfma_f32_16x16x32_bf16 v[148:151], v[88:91], v[68:71], v[148:151]
    ds_read_b64_tr_b16 v[124:125], v197 offset:20480
    v_mfma_f32_16x16x32_bf16 v[152:155], v[88:91], v[72:75], v[152:155]
    ds_read_b64_tr_b16 v[126:127], v197 offset:20992
    v_mfma_f32_16x16x32_bf16 v[156:159], v[88:91], v[76:79], v[156:159]
    v_mfma_f32_16x16x32_bf16 v[160:163], v[88:91], v[80:83], v[160:163]
    v_mfma_f32_16x16x32_bf16 v[164:167], v[64:67], v[92:95], v[164:167]
    v_mfma_f32_16x16x32_bf16 v[168:171], v[68:71], v[92:95], v[168:171]
    v_mfma_f32_16x16x32_bf16 v[172:175], v[72:75], v[92:95], v[172:175]
    v_mfma_f32_16x16x32_bf16 v[176:179], v[76:79], v[92:95], v[176:179]
    v_mfma_f32_16x16x32_bf16 v[180:183], v[80:83], v[92:95], v[180:183]
    s_waitcnt lgkmcnt(0)
    v_mfma_f32_16x16x32_bf16 v[128:131], v[116:119], v[100:103], v[128:131]
    v_mfma_f32_16x16x32_bf16 v[132:135], v[116:119], v[104:107], v[132:135]
    v_mfma_f32_16x16x32_bf16 v[136:139], v[116:119], v[108:111], v[136:139]
    v_mfma_f32_16x16x32_bf16 v[140:143], v[116:119], v[112:115], v[140:143]
    v_mfma_f32_16x16x32_bf16 v[144:147], v[120:123], v[96:99], v[144:147]
    v_mfma_f32_16x16x32_bf16 v[148:151], v[120:123], v[100:103], v[148:151]
    v_mfma_f32_16x16x32_bf16 v[152:155], v[120:123], v[104:107], v[152:155]
    v_mfma_f32_16x16x32_bf16 v[156:159], v[120:123], v[108:111], v[156:159]
    v_mfma_f32_16x16x32_bf16 v[160:163], v[120:123], v[112:115], v[160:163]
    v_mfma_f32_16x16x32_bf16 v[164:167], v[96:99], v[124:127], v[164:167]
    v_mfma_f32_16x16x32_bf16 v[168:171], v[100:103], v[124:127], v[168:171]
    v_mfma_f32_16x16x32_bf16 v[172:175], v[104:107], v[124:127], v[172:175]
    v_mfma_f32_16x16x32_bf16 v[176:179], v[108:111], v[124:127], v[176:179]
    v_mfma_f32_16x16x32_bf16 v[180:183], v[112:115], v[124:127], v[180:183]
    ds_read_b128 v[28:31], v194 offset:1792
    ds_read_b128 v[32:35], v194 offset:1808
    ds_read_b128 v[36:39], v194 offset:3840
    ds_read_b128 v[40:43], v194 offset:3856
    s_waitcnt vmcnt(0)
    s_waitcnt lgkmcnt(0)
    v_lshlrev_b32 v44, 16, v16
    v_and_b32 v45, 0xffff0000, v16
    v_lshlrev_b32 v46, 16, v17
    v_and_b32 v47, 0xffff0000, v17
    v_lshlrev_b32 v48, 16, v18
    v_and_b32 v49, 0xffff0000, v18
    v_lshlrev_b32 v50, 16, v19
    v_and_b32 v51, 0xffff0000, v19
    v_fma_f32 v44, v44, v187, v190
    v_fma_f32 v45, v45, v187, v190
    v_fma_f32 v46, v46, v187, v190
    v_fma_f32 v47, v47, v187, v190
    v_fma_f32 v48, v48, v187, v190
    v_fma_f32 v49, v49, v187, v190
    v_fma_f32 v50, v50, v187, v190
    v_fma_f32 v51, v51, v187, v190
    v_fma_f32 v44, v44, v28, v36
    v_fma_f32 v45, v45, v29, v37
    v_fma_f32 v46, v46, v30, v38
    v_fma_f32 v47, v47, v31, v39
    v_fma_f32 v48, v48, v32, v40
    v_fma_f32 v49, v49, v33, v41
    v_fma_f32 v50, v50, v34, v42
    v_fma_f32 v51, v51, v35, v43
    v_cvt_pk_bf16_f32 v56, v44, v45
    v_cvt_pk_bf16_f32 v57, v46, v47
    v_cvt_pk_bf16_f32 v58, v48, v49
    v_cvt_pk_bf16_f32 v59, v50, v51
    ds_write_b128 v193, v[56:59] offset:12800
    v_lshlrev_b32 v44, 16, v20
    v_and_b32 v45, 0xffff0000, v20
    v_lshlrev_b32 v46, 16, v21
    v_and_b32 v47, 0xffff0000, v21
    v_lshlrev_b32 v48, 16, v22
    v_and_b32 v49, 0xffff0000, v22
    v_lshlrev_b32 v50, 16, v23
    v_and_b32 v51, 0xffff0000, v23
    v_fma_f32 v44, v44, v188, v191
    v_fma_f32 v45, v45, v188, v191
    v_fma_f32 v46, v46, v188, v191
    v_fma_f32 v47, v47, v188, v191
    v_fma_f32 v48, v48, v188, v191
    v_fma_f32 v49, v49, v188, v191
    v_fma_f32 v50, v50, v188, v191
    v_fma_f32 v51, v51, v188, v191
    v_fma_f32 v44, v44, v28, v36
    v_fma_f32 v45, v45, v29, v37
    v_fma_f32 v46, v46, v30, v38
    v_fma_f32 v47, v47, v31, v39
    v_fma_f32 v48, v48, v32, v40
    v_fma_f32 v49, v49, v33, v41
    v_fma_f32 v50, v50, v34, v42
    v_fma_f32 v51, v51, v35, v43
    v_cvt_pk_bf16_f32 v56, v44, v45
    v_cvt_pk_bf16_f32 v57, v46, v47
    v_cvt_pk_bf16_f32 v58, v48, v49
    v_cvt_pk_bf16_f32 v59, v50, v51
    ds_write_b128 v193, v[56:59] offset:17920
    s_cmp_ge_u32 s32, 2
    s_cbranch_scc1 k1_skip8
    v_lshlrev_b32 v44, 16, v24
    v_and_b32 v45, 0xffff0000, v24
    v_lshlrev_b32 v46, 16, v25
    v_and_b32 v47, 0xffff0000, v25
    v_lshlrev_b32 v48, 16, v26
    v_and_b32 v49, 0xffff0000, v26
    v_lshlrev_b32 v50, 16, v27
    v_and_b32 v51, 0xffff0000, v27
    v_fma_f32 v44, v44, v189, v192
    v_fma_f32 v45, v45, v189, v192
    v_fma_f32 v46, v46, v189, v192
    v_fma_f32 v47, v47, v189, v192
    v_fma_f32 v48, v48, v189, v192
    v_fma_f32 v49, v49, v189, v192
    v_fma_f32 v50, v50, v189, v192
    v_fma_f32 v51, v51, v189, v192
    v_fma_f32 v44, v44, v28, v36
    v_fma_f32 v45, v45, v29, v37
    v_fma_f32 v46, v46, v30, v38
    v_fma_f32 v47, v47, v31, v39
    v_fma_f32 v48, v48, v32, v40
    v_fma_f32 v49, v49, v33, v41
    v_fma_f32 v50, v50, v34, v42
    v_fma_f32 v51, v51, v35, v43
    v_cvt_pk_bf16_f32 v56, v44, v45
    v_cvt_pk_bf16_f32 v57, v46, v47
    v_cvt_pk_bf16_f32 v58, v48, v49
    v_cvt_pk_bf16_f32 v59, v50, v51
    ds_write_b128 v193, v[56:59] offset:23040
k1_skip8:
    s_nop 4
    s_waitcnt lgkmcnt(0)
    s_barrier
    ds_read_b128 v[64:67], v200 offset:12800
    ds_read_b128 v[68:71], v200 offset:15360
    ds_read_b128 v[72:75], v200 offset:17920
    ds_read_b128 v[76:79], v200 offset:20480
    ds_read_b128 v[80:83], v200 offset:23040
    ds_read_b64_tr_b16 v[84:85], v198 offset:0
    ds_read_b64_tr_b16 v[86:87], v198 offset:512
    ds_read_b64_tr_b16 v[88:89], v198 offset:8192
    ds_read_b64_tr_b16 v[90:91], v198 offset:8704
    ds_read_b64_tr_b16 v[92:93], v198 offset:16384
    ds_read_b64_tr_b16 v[94:95], v198 offset:16896
    ds_read_b128 v[96:99], v200 offset:12864
    ds_read_b128 v[100:103], v200 offset:15424
    ds_read_b128 v[104:107], v200 offset:17984
    ds_read_b128 v[108:111], v200 offset:20544
    s_waitcnt lgkmcnt(4)
    v_mfma_f32_16x16x32_bf16 v[128:131], v[84:87], v[68:71], v[128:131]
    ds_read_b128 v[112:115], v200 offset:23104
    v_mfma_f32_16x16x32_bf16 v[132:135], v[84:87], v[72:75], v[132:135]
    ds_read_b64_tr_b16 v[116:117], v198 offset:4096
    v_mfma_f32_16x16x32_bf16 v[136:139], v[84:87], v[76:79], v[136:139]
    ds_read_b64_tr_b16 v[118:119], v198 offset:4608
    v_mfma_f32_16x16x32_bf16 v[140:143], v[84:87], v[80:83], v[140:143]
    ds_read_b64_tr_b16 v[120:121], v198 offset:12288
    v_mfma_f32_16x16x32_bf16 v[144:147], v[88:91], v[64:67], v[144:147]
    ds_read_b64_tr_b16 v[122:123], v198 offset:12800
    v_mfma_f32_16x16x32_bf16 v[148:151], v[88:91], v[68:71], v[148:151]
    ds_read_b64_tr_b16 v[124:125], v198 offset:20480
    v_mfma_f32_16x16x32_bf16 v[152:155], v[88:91], v[72:75], v[152:155]
    ds_read_b64_tr_b16 v[126:127], v198 offset:20992
    v_mfma_f32_16x16x32_bf16 v[156:159], v[88:91], v[76:79], v[156:159]
    v_mfma_f32_16x16x32_bf16 v[160:163], v[88:91], v[80:83], v[160:163]
    v_mfma_f32_16x16x32_bf16 v[164:167], v[64:67], v[92:95], v[164:167]
    v_mfma_f32_16x16x32_bf16 v[168:171], v[68:71], v[92:95], v[168:171]
    v_mfma_f32_16x16x32_bf16 v[172:175], v[72:75], v[92:95], v[172:175]
    v_mfma_f32_16x16x32_bf16 v[176:179], v[76:79], v[92:95], v[176:179]
    v_mfma_f32_16x16x32_bf16 v[180:183], v[80:83], v[92:95], v[180:183]
    s_waitcnt lgkmcnt(0)
    v_mfma_f32_16x16x32_bf16 v[128:131], v[116:119], v[100:103], v[128:131]
    v_mfma_f32_16x16x32_bf16 v[132:135], v[116:119], v[104:107], v[132:135]
    v_mfma_f32_16x16x32_bf16 v[136:139], v[116:119], v[108:111], v[136:139]
    v_mfma_f32_16x16x32_bf16 v[140:143], v[116:119], v[112:115], v[140:143]
    v_mfma_f32_16x16x32_bf16 v[144:147], v[120:123], v[96:99], v[144:147]
    v_mfma_f32_16x16x32_bf16 v[148:151], v[120:123], v[100:103], v[148:151]
    v_mfma_f32_16x16x32_bf16 v[152:155], v[120:123], v[104:107], v[152:155]
    v_mfma_f32_16x16x32_bf16 v[156:159], v[120:123], v[108:111], v[156:159]
    v_mfma_f32_16x16x32_bf16 v[160:163], v[120:123], v[112:115], v[160:163]
    v_mfma_f32_16x16x32_bf16 v[164:167], v[96:99], v[124:127], v[164:167]
    v_mfma_f32_16x16x32_bf16 v[168:171], v[100:103], v[124:127], v[168:171]
    v_mfma_f32_16x16x32_bf16 v[172:175], v[104:107], v[124:127], v[172:175]
    v_mfma_f32_16x16x32_bf16 v[176:179], v[108:111], v[124:127], v[176:179]
    v_mfma_f32_16x16x32_bf16 v[180:183], v[112:115], v[124:127], v[180:183]
    v_cvt_pk_bf16_f32 v64, v128, v129
    v_cvt_pk_bf16_f32 v65, v130, v131
    v_cvt_pk_bf16_f32 v66, v132, v133
    v_cvt_pk_bf16_f32 v67, v134, v135
    v_cvt_pk_bf16_f32 v68, v136, v137
    v_cvt_pk_bf16_f32 v69, v138, v139
    v_cvt_pk_bf16_f32 v70, v140, v141
    v_cvt_pk_bf16_f32 v71, v142, v143
    v_cvt_pk_bf16_f32 v72, v144, v145
    v_cvt_pk_bf16_f32 v73, v146, v147
    v_cvt_pk_bf16_f32 v82, v164, v165
    v_cvt_pk_bf16_f32 v83, v166, v167
    v_cvt_pk_bf16_f32 v74, v148, v149
    v_cvt_pk_bf16_f32 v75, v150, v151
    v_cvt_pk_bf16_f32 v84, v168, v169
    v_cvt_pk_bf16_f32 v85, v170, v171
    v_cvt_pk_bf16_f32 v76, v152, v153
    v_cvt_pk_bf16_f32 v77, v154, v155
    v_cvt_pk_bf16_f32 v86, v172, v173
    v_cvt_pk_bf16_f32 v87, v174, v175
    v_cvt_pk_bf16_f32 v78, v156, v157
    v_cvt_pk_bf16_f32 v79, v158, v159
    v_cvt_pk_bf16_f32 v88, v176, v177
    v_cvt_pk_bf16_f32 v89, v178, v179
    v_cvt_pk_bf16_f32 v80, v160, v161
    v_cvt_pk_bf16_f32 v81, v162, v163
    v_cvt_pk_bf16_f32 v90, v180, v181
    v_cvt_pk_bf16_f32 v91, v182, v183
    s_mov_b32 s56, 0x3eb8aa3b
    v_mfma_f32_16x16x16_bf16 v[92:95], v[72:73], v[64:65], 0
    v_mfma_f32_16x16x16_bf16 v[96:99], v[74:75], v[64:65], 0
    s_nop 6
    v_fma_f32 v108, v92, s56, v210
    v_fma_f32 v109, v93, s56, v211
    v_fma_f32 v110, v94, s56, v212
    v_fma_f32 v111, v95, s56, v213
    v_fma_f32 v112, v96, s56, v206
    v_fma_f32 v113, v97, s56, v207
    v_fma_f32 v114, v98, s56, v208
    v_fma_f32 v115, v99, s56, v209
    v_max3_f32 v116, v108, v109, v110
    v_max3_f32 v116, v116, v111, v112
    v_max3_f32 v116, v116, v113, v114
    v_max_f32 v116, v116, v115
    v_mov_b32 v117, v116
    s_nop 1
    v_permlane16_swap_b32 v116, v117
    v_max_f32 v116, v116, v117
    v_mov_b32 v117, v116
    s_nop 1
    v_permlane32_swap_b32 v116, v117
    v_max_f32 v116, v116, v117
    v_sub_f32 v108, v108, v116
    v_sub_f32 v109, v109, v116
    v_sub_f32 v110, v110, v116
    v_sub_f32 v111, v111, v116
    v_sub_f32 v112, v112, v116
    v_sub_f32 v113, v113, v116
    v_sub_f32 v114, v114, v116
    v_sub_f32 v115, v115, v116
    v_exp_f32 v108, v108
    v_exp_f32 v109, v109
    v_exp_f32 v110, v110
    v_exp_f32 v111, v111
    v_exp_f32 v112, v112
    v_exp_f32 v113, v113
    v_exp_f32 v114, v114
    v_exp_f32 v115, v115
    v_add_f32 v118, v108, v109
    v_add_f32 v118, v118, v110
    v_add_f32 v118, v118, v111
    v_add_f32 v118, v118, v112
    v_add_f32 v118, v118, v113
    v_add_f32 v118, v118, v114
    v_add_f32 v118, v118, v115
    v_mov_b32 v117, v118
    s_nop 1
    v_permlane16_swap_b32 v118, v117
    v_add_f32 v118, v118, v117
    v_mov_b32 v117, v118
    s_nop 1
    v_permlane32_swap_b32 v118, v117
    v_add_f32 v118, v118, v117
    v_rcp_f32 v118, v118
    s_nop 0
    v_mul_f32 v108, v108, v118
    v_mul_f32 v109, v109, v118
    v_mul_f32 v110, v110, v118
    v_mul_f32 v111, v111, v118
    v_mul_f32 v112, v112, v118
    v_mul_f32 v113, v113, v118
    v_mul_f32 v114, v114, v118
    v_mul_f32 v115, v115, v118
    v_cvt_pk_bf16_f32 v100, v108, v109
    v_cvt_pk_bf16_f32 v101, v110, v111
    v_cvt_pk_bf16_f32 v102, v112, v113
    v_cvt_pk_bf16_f32 v103, v114, v115
    s_nop 1
    v_mfma_f32_16x16x32_bf16 v[104:107], v[82:85], v[100:103], 0
    s_nop 7
    v_cvt_pk_bf16_f32 v100, v104, v105
    v_cvt_pk_bf16_f32 v101, v106, v107
    s_add_u32 s49, s54, 0
    buffer_store_dwordx2 v[100:101], v201, s[28:31], s49 offen
    v_mfma_f32_16x16x16_bf16 v[92:95], v[74:75], v[66:67], 0
    v_mfma_f32_16x16x16_bf16 v[96:99], v[76:77], v[66:67], 0
    s_nop 6
    v_fma_f32 v108, v92, s56, v202
    v_fma_f32 v109, v93, s56, v203
    v_fma_f32 v110, v94, s56, v204
    v_fma_f32 v111, v95, s56, v205
    v_fma_f32 v112, v96, s56, v206
    v_fma_f32 v113, v97, s56, v207
    v_fma_f32 v114, v98, s56, v208
    v_fma_f32 v115, v99, s56, v209
    v_max3_f32 v116, v108, v109, v110
    v_max3_f32 v116, v116, v111, v112
    v_max3_f32 v116, v116, v113, v114
    v_max_f32 v116, v116, v115
    v_mov_b32 v117, v116
    s_nop 1
    v_permlane16_swap_b32 v116, v117
    v_max_f32 v116, v116, v117
    v_mov_b32 v117, v116
    s_nop 1
    v_permlane32_swap_b32 v116, v117
    v_max_f32 v116, v116, v117
    v_sub_f32 v108, v108, v116
    v_sub_f32 v109, v109, v116
    v_sub_f32 v110, v110, v116
    v_sub_f32 v111, v111, v116
    v_sub_f32 v112, v112, v116
    v_sub_f32 v113, v113, v116
    v_sub_f32 v114, v114, v116
    v_sub_f32 v115, v115, v116
    v_exp_f32 v108, v108
    v_exp_f32 v109, v109
    v_exp_f32 v110, v110
    v_exp_f32 v111, v111
    v_exp_f32 v112, v112
    v_exp_f32 v113, v113
    v_exp_f32 v114, v114
    v_exp_f32 v115, v115
    v_add_f32 v118, v108, v109
    v_add_f32 v118, v118, v110
    v_add_f32 v118, v118, v111
    v_add_f32 v118, v118, v112
    v_add_f32 v118, v118, v113
    v_add_f32 v118, v118, v114
    v_add_f32 v118, v118, v115
    v_mov_b32 v117, v118
    s_nop 1
    v_permlane16_swap_b32 v118, v117
    v_add_f32 v118, v118, v117
    v_mov_b32 v117, v118
    s_nop 1
    v_permlane32_swap_b32 v118, v117
    v_add_f32 v118, v118, v117
    v_rcp_f32 v118, v118
    s_nop 0
    v_mul_f32 v108, v108, v118
    v_mul_f32 v109, v109, v118
    v_mul_f32 v110, v110, v118
    v_mul_f32 v111, v111, v118
    v_mul_f32 v112, v112, v118
    v_mul_f32 v113, v113, v118
    v_mul_f32 v114, v114, v118
    v_mul_f32 v115, v115, v118
    v_cvt_pk_bf16_f32 v100, v108, v109
    v_cvt_pk_bf16_f32 v101, v110, v111
    v_cvt_pk_bf16_f32 v102, v112, v113
    v_cvt_pk_bf16_f32 v103, v114, v115
    s_nop 1
    v_mfma_f32_16x16x32_bf16 v[104:107], v[84:87], v[100:103], 0
    s_nop 7
    v_cvt_pk_bf16_f32 v100, v104, v105
    v_cvt_pk_bf16_f32 v101, v106, v107
    s_add_u32 s49, s54, 16384
    buffer_store_dwordx2 v[100:101], v201, s[28:31], s49 offen
    v_mfma_f32_16x16x16_bf16 v[92:95], v[76:77], v[68:69], 0
    v_mfma_f32_16x16x16_bf16 v[96:99], v[78:79], v[68:69], 0
    s_nop 6
    v_fma_f32 v108, v92, s56, v202
    v_fma_f32 v109, v93, s56, v203
    v_fma_f32 v110, v94, s56, v204
    v_fma_f32 v111, v95, s56, v205
    v_fma_f32 v112, v96, s56, v206
    v_fma_f32 v113, v97, s56, v207
    v_fma_f32 v114, v98, s56, v208
    v_fma_f32 v115, v99, s56, v209
    v_max3_f32 v116, v108, v109, v110
    v_max3_f32 v116, v116, v111, v112
    v_max3_f32 v116, v116, v113, v114
    v_max_f32 v116, v116, v115
    v_mov_b32 v117, v116
    s_nop 1
    v_permlane16_swap_b32 v116, v117
    v_max_f32 v116, v116, v117
    v_mov_b32 v117, v116
    s_nop 1
    v_permlane32_swap_b32 v116, v117
    v_max_f32 v116, v116, v117
    v_sub_f32 v108, v108, v116
    v_sub_f32 v109, v109, v116
    v_sub_f32 v110, v110, v116
    v_sub_f32 v111, v111, v116
    v_sub_f32 v112, v112, v116
    v_sub_f32 v113, v113, v116
    v_sub_f32 v114, v114, v116
    v_sub_f32 v115, v115, v116
    v_exp_f32 v108, v108
    v_exp_f32 v109, v109
    v_exp_f32 v110, v110
    v_exp_f32 v111, v111
    v_exp_f32 v112, v112
    v_exp_f32 v113, v113
    v_exp_f32 v114, v114
    v_exp_f32 v115, v115
    v_add_f32 v118, v108, v109
    v_add_f32 v118, v118, v110
    v_add_f32 v118, v118, v111
    v_add_f32 v118, v118, v112
    v_add_f32 v118, v118, v113
    v_add_f32 v118, v118, v114
    v_add_f32 v118, v118, v115
    v_mov_b32 v117, v118
    s_nop 1
    v_permlane16_swap_b32 v118, v117
    v_add_f32 v118, v118, v117
    v_mov_b32 v117, v118
    s_nop 1
    v_permlane32_swap_b32 v118, v117
    v_add_f32 v118, v118, v117
    v_rcp_f32 v118, v118
    s_nop 0
    v_mul_f32 v108, v108, v118
    v_mul_f32 v109, v109, v118
    v_mul_f32 v110, v110, v118
    v_mul_f32 v111, v111, v118
    v_mul_f32 v112, v112, v118
    v_mul_f32 v113, v113, v118
    v_mul_f32 v114, v114, v118
    v_mul_f32 v115, v115, v118
    v_cvt_pk_bf16_f32 v100, v108, v109
    v_cvt_pk_bf16_f32 v101, v110, v111
    v_cvt_pk_bf16_f32 v102, v112, v113
    v_cvt_pk_bf16_f32 v103, v114, v115
    s_nop 1
    v_mfma_f32_16x16x32_bf16 v[104:107], v[86:89], v[100:103], 0
    s_nop 7
    v_cvt_pk_bf16_f32 v100, v104, v105
    v_cvt_pk_bf16_f32 v101, v106, v107
    s_add_u32 s49, s54, 32768
    buffer_store_dwordx2 v[100:101], v201, s[28:31], s49 offen
    v_mfma_f32_16x16x16_bf16 v[92:95], v[78:79], v[70:71], 0
    v_mfma_f32_16x16x16_bf16 v[96:99], v[80:81], v[70:71], 0
    s_nop 6
    v_fma_f32 v108, v92, s56, v202
    v_fma_f32 v109, v93, s56, v203
    v_fma_f32 v110, v94, s56, v204
    v_fma_f32 v111, v95, s56, v205
    v_fma_f32 v112, v96, s56, v206
    v_fma_f32 v113, v97, s56, v207
    v_fma_f32 v114, v98, s56, v208
    v_fma_f32 v115, v99, s56, v209
    v_max3_f32 v116, v108, v109, v110
    v_max3_f32 v116, v116, v111, v112
    v_max3_f32 v116, v116, v113, v114
    v_max_f32 v116, v116, v115
    v_mov_b32 v117, v116
    s_nop 1
    v_permlane16_swap_b32 v116, v117
    v_max_f32 v116, v116, v117
    v_mov_b32 v117, v116
    s_nop 1
    v_permlane32_swap_b32 v116, v117
    v_max_f32 v116, v116, v117
    v_sub_f32 v108, v108, v116
    v_sub_f32 v109, v109, v116
    v_sub_f32 v110, v110, v116
    v_sub_f32 v111, v111, v116
    v_sub_f32 v112, v112, v116
    v_sub_f32 v113, v113, v116
    v_sub_f32 v114, v114, v116
    v_sub_f32 v115, v115, v116
    v_exp_f32 v108, v108
    v_exp_f32 v109, v109
    v_exp_f32 v110, v110
    v_exp_f32 v111, v111
    v_exp_f32 v112, v112
    v_exp_f32 v113, v113
    v_exp_f32 v114, v114
    v_exp_f32 v115, v115
    v_add_f32 v118, v108, v109
    v_add_f32 v118, v118, v110
    v_add_f32 v118, v118, v111
    v_add_f32 v118, v118, v112
    v_add_f32 v118, v118, v113
    v_add_f32 v118, v118, v114
    v_add_f32 v118, v118, v115
    v_mov_b32 v117, v118
    s_nop 1
    v_permlane16_swap_b32 v118, v117
    v_add_f32 v118, v118, v117
    v_mov_b32 v117, v118
    s_nop 1
    v_permlane32_swap_b32 v118, v117
    v_add_f32 v118, v118, v117
    v_rcp_f32 v118, v118
    s_nop 0
    v_mul_f32 v108, v108, v118
    v_mul_f32 v109, v109, v118
    v_mul_f32 v110, v110, v118
    v_mul_f32 v111, v111, v118
    v_mul_f32 v112, v112, v118
    v_mul_f32 v113, v113, v118
    v_mul_f32 v114, v114, v118
    v_mul_f32 v115, v115, v118
    v_cvt_pk_bf16_f32 v100, v108, v109
    v_cvt_pk_bf16_f32 v101, v110, v111
    v_cvt_pk_bf16_f32 v102, v112, v113
    v_cvt_pk_bf16_f32 v103, v114, v115
    s_nop 1
    v_mfma_f32_16x16x32_bf16 v[104:107], v[88:91], v[100:103], 0
    s_nop 7
    v_cvt_pk_bf16_f32 v100, v104, v105
    v_cvt_pk_bf16_f32 v101, v106, v107
    s_add_u32 s49, s54, 49152
    buffer_store_dwordx2 v[100:101], v201, s[28:31], s49 offen
k1_end:
    s_endpgm
.globl k2_kernel
.type k2_kernel,@function
.p2align 8
k2_kernel:
    s_cmp_ge_u32 s2, 256
    s_cbranch_scc1 k2_kernel_end
    s_load_dwordx2 s[8:9], s[0:1], 88
    s_load_dwordx2 s[4:5], s[0:1], 16
    s_load_dwordx2 s[6:7], s[0:1], 0
    v_lshrrev_b32 v1, 6, v0
    s_nop 0
    v_readfirstlane_b32 s32, v1
    s_and_b32 s33, s2, 7
    s_lshr_b32 s34, s2, 3
    s_and_b32 s34, s34, 3
    s_lshl_b32 s34, s34, 3
    s_add_u32 s33, s33, s34
    s_lshr_b32 s34, s2, 5
    s_lshl_b32 s35, s33, 6
    v_and_b32 v4, 63, v0
    v_and_b32 v5, 15, v0
    v_bfe_u32 v6, v0, 4, 2
    s_waitcnt lgkmcnt(0)
    s_add_u32 s16, s8, 1048576
    s_addc_u32 s17, s9, 0
    s_mov_b32 s18, 2097152
    s_mov_b32 s19, 0x20000
    s_mov_b32 s20, s4
    s_mov_b32 s21, s5
    s_mov_b32 s22, 524288
    s_mov_b32 s23, 0x20000
    s_mov_b32 s24, s6
    s_mov_b32 s25, s7
    s_mov_b32 s26, 2097152
    s_mov_b32 s27, 0x20000
    s_add_u32 s28, s8, 4194304
    s_addc_u32 s29, s9, 0
    s_mov_b32 s30, 2097152
    s_mov_b32 s31, 0x20000
    s_add_u32 s36, s8, 65536
    s_addc_u32 s37, s9, 0
    s_mov_b32 s38, 262144
    s_mov_b32 s39, 0x20000
    s_mov_b32 s40, s8
    s_mov_b32 s41, s9
    s_mov_b32 s42, 12288
    s_mov_b32 s43, 0x20000
    s_cmp_lt_u32 s32, 2
    s_cselect_b32 s12, s16, s20
    s_cselect_b32 s13, s17, s21
    s_cselect_b32 s14, s18, s22
    s_mov_b32 s15, 0x20000
    s_and_b32 s44, s32, 1
    s_lshl_b32 s44, s44, 2
    s_cmp_lt_u32 s32, 2
    s_movk_i32 s45, 128
    s_cselect_b32 s45, s45, 65536
    s_cselect_b32 s46, 0, 8192
    s_add_u32 s47, s44, 0
    s_lshl_b32 s48, s47, 3
    s_add_u32 s49, s48, s35
    s_mul_i32 s49, s49, 1024
    s_lshl_b32 s50, s48, 10
    s_lshl_b32 s51, s34, 7
    s_add_u32 s50, s50, s51
    s_cmp_lt_u32 s32, 2
    s_cselect_b32 s52, s49, s50
    s_lshl_b32 s47, s47, 10
    s_add_u32 s56, s47, s46
    s_add_u32 s47, s44, 1
    s_lshl_b32 s48, s47, 3
    s_add_u32 s49, s48, s35
    s_mul_i32 s49, s49, 1024
    s_lshl_b32 s50, s48, 10
    s_lshl_b32 s51, s34, 7
    s_add_u32 s50, s50, s51
    s_cmp_lt_u32 s32, 2
    s_cselect_b32 s53, s49, s50
    s_lshl_b32 s47, s47, 10
    s_add_u32 s57, s47, s46
    s_add_u32 s47, s44, 2
    s_lshl_b32 s48, s47, 3
    s_add_u32 s49, s48, s35
    s_mul_i32 s49, s49, 1024
    s_lshl_b32 s50, s48, 10
    s_lshl_b32 s51, s34, 7
    s_add_u32 s50, s50, s51
    s_cmp_lt_u32 s32, 2
    s_cselect_b32 s54, s49, s50
    s_lshl_b32 s47, s47, 10
    s_add_u32 s58, s47, s46
    s_add_u32 s47, s44, 3
    s_lshl_b32 s48, s47, 3
    s_add_u32 s49, s48, s35
    s_mul_i32 s49, s49, 1024
    s_lshl_b32 s50, s48, 10
    s_lshl_b32 s51, s34, 7
    s_add_u32 s50, s50, s51
    s_cmp_lt_u32 s32, 2
    s_cselect_b32 s55, s49, s50
    s_lshl_b32 s47, s47, 10
    s_add_u32 s59, s47, s46
    v_lshrrev_b32 v7, 3, v4
    v_and_b32 v8, 7, v4
    v_lshrrev_b32 v9, 4, v4
    v_and_b32 v9, 7, v9
    v_xor_b32 v9, v8, v9
    v_lshlrev_b32 v9, 4, v9
    v_mul_u32_u24 v10, 1024, v7
    v_add_u32 v9, v9, v10
    v_and_b32 v10, 2, v7
    v_xor_b32 v10, v8, v10
    v_lshlrev_b32 v10, 4, v10
    v_lshl_add_u32 v10, v7, 10, v10
    s_cmp_lt_u32 s32, 2
    s_cselect_b64 vcc, -1, 0
    v_cndmask_b32 v112, v10, v9, vcc
    v_lshrrev_b32 v9, 4, v4
    v_add_u32 v9, 4, v9
    v_and_b32 v9, 7, v9
    v_xor_b32 v9, v8, v9
    v_lshlrev_b32 v9, 4, v9
    v_mul_u32_u24 v10, 1024, v7
    v_add_u32 v9, v9, v10
    v_and_b32 v10, 2, v7
    v_or_b32 v10, 4, v10
    v_xor_b32 v10, v8, v10
    v_lshlrev_b32 v10, 4, v10
    v_lshl_add_u32 v10, v7, 10, v10
    s_cmp_lt_u32 s32, 2
    s_cselect_b64 vcc, -1, 0
    v_cndmask_b32 v113, v10, v9, vcc
    s_lshr_b32 s47, s32, 1
    s_lshl_b32 s47, s47, 5
    v_add_u32 v7, s47, v5
    v_lshlrev_b32 v7, 7, v7
    v_lshrrev_b32 v8, 1, v5
    v_and_b32 v8, 7, v8
    v_xor_b32 v8, v6, v8
    v_lshl_add_u32 v114, v8, 4, v7
    v_xor_b32 v115, 64, v114
    v_lshrrev_b32 v7, 2, v5
    v_lshl_add_u32 v7, v6, 3, v7
    v_lshlrev_b32 v7, 7, v7
    v_bfe_u32 v8, v5, 3, 1
    v_lshlrev_b32 v8, 1, v8
    v_and_b32 v9, 1, v6
    v_lshl_or_b32 v8, v9, 2, v8
    v_bfe_u32 v9, v5, 1, 1
    s_and_b32 s47, s32, 1
    s_lshl_b32 s47, s47, 2
    v_add_u32 v9, s47, v9
    v_xor_b32 v8, v8, v9
    v_lshl_add_u32 v7, v8, 4, v7
    v_and_b32 v9, 1, v5
    v_lshl_add_u32 v7, v9, 3, v7
    v_add_u32 v116, 8192, v7
    v_xor_b32 v117, 32, v116
    v_add_u32 v120, 0x10000, v114
    v_add_u32 v122, 0x10000, v116
    v_add_u32 v121, 0x10000, v115
    v_add_u32 v123, 0x10000, v117
    s_lshr_b32 s47, s32, 1
    s_lshl_b32 s47, s47, 5
    s_add_u32 s47, s47, s35
    v_add_u32 v7, s47, v5
    v_lshlrev_b32 v8, 10, v7
    s_and_b32 s48, s32, 1
    s_lshl_b32 s48, s48, 5
    s_lshl_b32 s49, s34, 6
    s_add_u32 s48, s48, s49
    v_lshl_add_u32 v9, v6, 2, s48
    v_lshl_add_u32 v118, v9, 1, v8
    s_lshl_b32 s48, s34, 1
    s_and_b32 s49, s32, 1
    s_add_u32 s48, s48, s49
    v_lshl_add_u32 v10, v7, 4, s48
    v_lshlrev_b32 v119, 3, v10
    v_lshlrev_b32 v10, 2, v9
    s_mov_b32 s47, 4096
    buffer_load_dwordx4 v[88:91], v10, s[40:43], s47 offen
    buffer_load_dwordx4 v[92:95], v10, s[40:43], s47 offen offset:64
    s_mov_b32 s47, 0
    buffer_load_dwordx2 v[80:81], v118, s[24:27], s47 offen offset:0
    s_mov_b32 s47, 16384
    buffer_load_dwordx2 v[82:83], v118, s[24:27], s47 offen offset:0
    s_mov_b32 s47, 0
    buffer_load_dwordx2 v[84:85], v118, s[24:27], s47 offen offset:32
    s_mov_b32 s47, 16384
    buffer_load_dwordx2 v[86:87], v118, s[24:27], s47 offen offset:32
    s_add_u32 m0, s56, 0
    s_nop 0
    buffer_load_dwordx4 v112, s[12:15], s52 offen lds
    s_add_u32 s52, s52, s45
    s_add_u32 m0, s57, 0
    s_nop 0
    buffer_load_dwordx4 v113, s[12:15], s53 offen lds
    s_add_u32 s53, s53, s45
    s_add_u32 m0, s58, 0
    s_nop 0
    buffer_load_dwordx4 v112, s[12:15], s54 offen lds
    s_add_u32 s54, s54, s45
    s_add_u32 m0, s59, 0
    s_nop 0
    buffer_load_dwordx4 v113, s[12:15], s55 offen lds
    s_add_u32 s55, s55, s45
    s_add_u32 m0, s56, 16384
    s_nop 0
    buffer_load_dwordx4 v112, s[12:15], s52 offen lds
    s_add_u32 s52, s52, s45
    s_add_u32 m0, s57, 16384
    s_nop 0
    buffer_load_dwordx4 v113, s[12:15], s53 offen lds
    s_add_u32 s53, s53, s45
    s_add_u32 m0, s58, 16384
    s_nop 0
    buffer_load_dwordx4 v112, s[12:15], s54 offen lds
    s_add_u32 s54, s54, s45
    s_add_u32 m0, s59, 16384
    s_nop 0
    buffer_load_dwordx4 v113, s[12:15], s55 offen lds
    s_add_u32 s55, s55, s45
    s_add_u32 m0, s56, 32768
    s_nop 0
    buffer_load_dwordx4 v112, s[12:15], s52 offen lds
    s_add_u32 s52, s52, s45
    s_add_u32 m0, s57, 32768
    s_nop 0
    buffer_load_dwordx4 v113, s[12:15], s53 offen lds
    s_add_u32 s53, s53, s45
    s_add_u32 m0, s58, 32768
    s_nop 0
    buffer_load_dwordx4 v112, s[12:15], s54 offen lds
    s_add_u32 s54, s54, s45
    s_add_u32 m0, s59, 32768
    s_nop 0
    buffer_load_dwordx4 v113, s[12:15], s55 offen lds
    s_add_u32 s55, s55, s45
    s_add_u32 m0, s56, 49152
    s_nop 0
    buffer_load_dwordx4 v112, s[12:15], s52 offen lds
    s_add_u32 s52, s52, s45
    s_add_u32 m0, s57, 49152
    s_nop 0
    buffer_load_dwordx4 v113, s[12:15], s53 offen lds
    s_add_u32 s53, s53, s45
    s_add_u32 m0, s58, 49152
    s_nop 0
    buffer_load_dwordx4 v112, s[12:15], s54 offen lds
    s_add_u32 s54, s54, s45
    s_add_u32 m0, s59, 49152
    s_nop 0
    buffer_load_dwordx4 v113, s[12:15], s55 offen lds
    s_add_u32 s55, s55, s45
    s_add_u32 m0, s56, 65536
    s_nop 0
    buffer_load_dwordx4 v112, s[12:15], s52 offen lds
    s_add_u32 s52, s52, s45
    s_add_u32 m0, s57, 65536
    s_nop 0
    buffer_load_dwordx4 v113, s[12:15], s53 offen lds
    s_add_u32 s53, s53, s45
    s_add_u32 m0, s58, 65536
    s_nop 0
    buffer_load_dwordx4 v112, s[12:15], s54 offen lds
    s_add_u32 s54, s54, s45
    s_add_u32 m0, s59, 65536
    s_nop 0
    buffer_load_dwordx4 v113, s[12:15], s55 offen lds
    s_add_u32 s55, s55, s45
    s_add_u32 m0, s56, 81920
    s_nop 0
    buffer_load_dwordx4 v112, s[12:15], s52 offen lds
    s_add_u32 s52, s52, s45
    s_add_u32 m0, s57, 81920
    s_nop 0
    buffer_load_dwordx4 v113, s[12:15], s53 offen lds
    s_add_u32 s53, s53, s45
    s_add_u32 m0, s58, 81920
    s_nop 0
    buffer_load_dwordx4 v112, s[12:15], s54 offen lds
    s_add_u32 s54, s54, s45
    s_add_u32 m0, s59, 81920
    s_nop 0
    buffer_load_dwordx4 v113, s[12:15], s55 offen lds
    s_add_u32 s55, s55, s45
    s_waitcnt vmcnt(16)
    s_barrier
    ds_read_b128 v[16:19], v114 offset:0
    ds_read_b128 v[20:23], v114 offset:2048
    ds_read_b64_tr_b16 v[24:25], v116 offset:0
    ds_read_b64_tr_b16 v[26:27], v116 offset:512
    ds_read_b64_tr_b16 v[28:29], v117 offset:0
    ds_read_b64_tr_b16 v[30:31], v117 offset:512
    ds_read_b128 v[40:43], v115 offset:0
    ds_read_b128 v[44:47], v115 offset:2048
    ds_read_b64_tr_b16 v[48:49], v116 offset:4096
    ds_read_b64_tr_b16 v[50:51], v116 offset:4608
    ds_read_b64_tr_b16 v[52:53], v117 offset:4096
    ds_read_b64_tr_b16 v[54:55], v117 offset:4608
    s_waitcnt lgkmcnt(6)
    v_mfma_f32_16x16x32_bf16 v[64:67], v[24:27], v[16:19], 0
    v_mfma_f32_16x16x32_bf16 v[68:71], v[24:27], v[20:23], 0
    v_mfma_f32_16x16x32_bf16 v[72:75], v[28:31], v[16:19], 0
    v_mfma_f32_16x16x32_bf16 v[76:79], v[28:31], v[20:23], 0
    ds_read_b128 v[16:19], v114 offset:16384
    ds_read_b128 v[20:23], v114 offset:18432
    ds_read_b64_tr_b16 v[24:25], v116 offset:16384
    ds_read_b64_tr_b16 v[26:27], v116 offset:16896
    ds_read_b64_tr_b16 v[28:29], v117 offset:16384
    ds_read_b64_tr_b16 v[30:31], v117 offset:16896
    s_waitcnt lgkmcnt(6)
    v_mfma_f32_16x16x32_bf16 v[64:67], v[48:51], v[40:43], v[64:67]
    v_mfma_f32_16x16x32_bf16 v[68:71], v[48:51], v[44:47], v[68:71]
    v_mfma_f32_16x16x32_bf16 v[72:75], v[52:55], v[40:43], v[72:75]
    v_mfma_f32_16x16x32_bf16 v[76:79], v[52:55], v[44:47], v[76:79]
    ds_read_b128 v[40:43], v115 offset:16384
    ds_read_b128 v[44:47], v115 offset:18432
    ds_read_b64_tr_b16 v[48:49], v116 offset:20480
    ds_read_b64_tr_b16 v[50:51], v116 offset:20992
    ds_read_b64_tr_b16 v[52:53], v117 offset:20480
    ds_read_b64_tr_b16 v[54:55], v117 offset:20992
    s_waitcnt lgkmcnt(6)
    v_mfma_f32_16x16x32_bf16 v[64:67], v[24:27], v[16:19], v[64:67]
    v_mfma_f32_16x16x32_bf16 v[68:71], v[24:27], v[20:23], v[68:71]
    v_mfma_f32_16x16x32_bf16 v[72:75], v[28:31], v[16:19], v[72:75]
    v_mfma_f32_16x16x32_bf16 v[76:79], v[28:31], v[20:23], v[76:79]
    s_waitcnt vmcnt(8)
    s_barrier
    s_add_u32 m0, s56, 98304
    s_nop 0
    buffer_load_dwordx4 v112, s[12:15], s52 offen lds
    s_add_u32 s52, s52, s45
    s_add_u32 m0, s57, 98304
    s_nop 0
    buffer_load_dwordx4 v113, s[12:15], s53 offen lds
    s_add_u32 s53, s53, s45
    s_add_u32 m0, s58, 98304
    s_nop 0
    buffer_load_dwordx4 v112, s[12:15], s54 offen lds
    s_add_u32 s54, s54, s45
    s_add_u32 m0, s59, 98304
    s_nop 0
    buffer_load_dwordx4 v113, s[12:15], s55 offen lds
    s_add_u32 s55, s55, s45
    s_add_u32 m0, s56, 114688
    s_nop 0
    buffer_load_dwordx4 v112, s[12:15], s52 offen lds
    s_add_u32 s52, s52, s45
    s_add_u32 m0, s57, 114688
    s_nop 0
    buffer_load_dwordx4 v113, s[12:15], s53 offen lds
    s_add_u32 s53, s53, s45
    s_add_u32 m0, s58, 114688
    s_nop 0
    buffer_load_dwordx4 v112, s[12:15], s54 offen lds
    s_add_u32 s54, s54, s45
    s_add_u32 m0, s59, 114688
    s_nop 0
    buffer_load_dwordx4 v113, s[12:15], s55 offen lds
    s_add_u32 s55, s55, s45
    ds_read_b128 v[16:19], v114 offset:32768
    ds_read_b128 v[20:23], v114 offset:34816
    ds_read_b64_tr_b16 v[24:25], v116 offset:32768
    ds_read_b64_tr_b16 v[26:27], v116 offset:33280
    ds_read_b64_tr_b16 v[28:29], v117 offset:32768
    ds_read_b64_tr_b16 v[30:31], v117 offset:33280
    s_waitcnt lgkmcnt(6)
    v_mfma_f32_16x16x32_bf16 v[64:67], v[48:51], v[40:43], v[64:67]
    v_mfma_f32_16x16x32_bf16 v[68:71], v[48:51], v[44:47], v[68:71]
    v_mfma_f32_16x16x32_bf16 v[72:75], v[52:55], v[40:43], v[72:75]
    v_mfma_f32_16x16x32_bf16 v[76:79], v[52:55], v[44:47], v[76:79]
    ds_read_b128 v[40:43], v115 offset:32768
    ds_read_b128 v[44:47], v115 offset:34816
    ds_read_b64_tr_b16 v[48:49], v116 offset:36864
    ds_read_b64_tr_b16 v[50:51], v116 offset:37376
    ds_read_b64_tr_b16 v[52:53], v117 offset:36864
    ds_read_b64_tr_b16 v[54:55], v117 offset:37376
    s_waitcnt lgkmcnt(6)
    v_mfma_f32_16x16x32_bf16 v[64:67], v[24:27], v[16:19], v[64:67]
    v_mfma_f32_16x16x32_bf16 v[68:71], v[24:27], v[20:23], v[68:71]
    v_mfma_f32_16x16x32_bf16 v[72:75], v[28:31], v[16:19], v[72:75]
    v_mfma_f32_16x16x32_bf16 v[76:79], v[28:31], v[20:23], v[76:79]
    ds_read_b128 v[16:19], v114 offset:49152
    ds_read_b128 v[20:23], v114 offset:51200
    ds_read_b64_tr_b16 v[24:25], v116 offset:49152
    ds_read_b64_tr_b16 v[26:27], v116 offset:49664
    ds_read_b64_tr_b16 v[28:29], v117 offset:49152
    ds_read_b64_tr_b16 v[30:31], v117 offset:49664
    s_waitcnt lgkmcnt(6)
    v_mfma_f32_16x16x32_bf16 v[64:67], v[48:51], v[40:43], v[64:67]
    v_mfma_f32_16x16x32_bf16 v[68:71], v[48:51], v[44:47], v[68:71]
    v_mfma_f32_16x16x32_bf16 v[72:75], v[52:55], v[40:43], v[72:75]
    v_mfma_f32_16x16x32_bf16 v[76:79], v[52:55], v[44:47], v[76:79]
    ds_read_b128 v[40:43], v115 offset:49152
    ds_read_b128 v[44:47], v115 offset:51200
    ds_read_b64_tr_b16 v[48:49], v116 offset:53248
    ds_read_b64_tr_b16 v[50:51], v116 offset:53760
    ds_read_b64_tr_b16 v[52:53], v117 offset:53248
    ds_read_b64_tr_b16 v[54:55], v117 offset:53760
    s_waitcnt lgkmcnt(6)
    v_mfma_f32_16x16x32_bf16 v[64:67], v[24:27], v[16:19], v[64:67]
    v_mfma_f32_16x16x32_bf16 v[68:71], v[24:27], v[20:23], v[68:71]
    v_mfma_f32_16x16x32_bf16 v[72:75], v[28:31], v[16:19], v[72:75]
    v_mfma_f32_16x16x32_bf16 v[76:79], v[28:31], v[20:23], v[76:79]
    s_waitcnt vmcnt(8)
    s_barrier
    ds_read_b128 v[16:19], v120 offset:0
    ds_read_b128 v[20:23], v120 offset:2048
    ds_read_b64_tr_b16 v[24:25], v122 offset:0
    ds_read_b64_tr_b16 v[26:27], v122 offset:512
    ds_read_b64_tr_b16 v[28:29], v123 offset:0
    ds_read_b64_tr_b16 v[30:31], v123 offset:512
    s_waitcnt lgkmcnt(6)
    v_mfma_f32_16x16x32_bf16 v[64:67], v[48:51], v[40:43], v[64:67]
    v_mfma_f32_16x16x32_bf16 v[68:71], v[48:51], v[44:47], v[68:71]
    v_mfma_f32_16x16x32_bf16 v[72:75], v[52:55], v[40:43], v[72:75]
    v_mfma_f32_16x16x32_bf16 v[76:79], v[52:55], v[44:47], v[76:79]
    ds_read_b128 v[40:43], v121 offset:0
    ds_read_b128 v[44:47], v121 offset:2048
    ds_read_b64_tr_b16 v[48:49], v122 offset:4096
    ds_read_b64_tr_b16 v[50:51], v122 offset:4608
    ds_read_b64_tr_b16 v[52:53], v123 offset:4096
    ds_read_b64_tr_b16 v[54:55], v123 offset:4608
    s_waitcnt lgkmcnt(6)
    v_mfma_f32_16x16x32_bf16 v[64:67], v[24:27], v[16:19], v[64:67]
    v_mfma_f32_16x16x32_bf16 v[68:71], v[24:27], v[20:23], v[68:71]
    v_mfma_f32_16x16x32_bf16 v[72:75], v[28:31], v[16:19], v[72:75]
    v_mfma_f32_16x16x32_bf16 v[76:79], v[28:31], v[20:23], v[76:79]
    ds_read_b128 v[16:19], v120 offset:16384
    ds_read_b128 v[20:23], v120 offset:18432
    ds_read_b64_tr_b16 v[24:25], v122 offset:16384
    ds_read_b64_tr_b16 v[26:27], v122 offset:16896
    ds_read_b64_tr_b16 v[28:29], v123 offset:16384
    ds_read_b64_tr_b16 v[30:31], v123 offset:16896
    s_waitcnt lgkmcnt(6)
    v_mfma_f32_16x16x32_bf16 v[64:67], v[48:51], v[40:43], v[64:67]
    v_mfma_f32_16x16x32_bf16 v[68:71], v[48:51], v[44:47], v[68:71]
    v_mfma_f32_16x16x32_bf16 v[72:75], v[52:55], v[40:43], v[72:75]
    v_mfma_f32_16x16x32_bf16 v[76:79], v[52:55], v[44:47], v[76:79]
    ds_read_b128 v[40:43], v121 offset:16384
    ds_read_b128 v[44:47], v121 offset:18432
    ds_read_b64_tr_b16 v[48:49], v122 offset:20480
    ds_read_b64_tr_b16 v[50:51], v122 offset:20992
    ds_read_b64_tr_b16 v[52:53], v123 offset:20480
    ds_read_b64_tr_b16 v[54:55], v123 offset:20992
    s_waitcnt lgkmcnt(6)
    v_mfma_f32_16x16x32_bf16 v[64:67], v[24:27], v[16:19], v[64:67]
    v_mfma_f32_16x16x32_bf16 v[68:71], v[24:27], v[20:23], v[68:71]
    v_mfma_f32_16x16x32_bf16 v[72:75], v[28:31], v[16:19], v[72:75]
    v_mfma_f32_16x16x32_bf16 v[76:79], v[28:31], v[20:23], v[76:79]
    s_waitcnt vmcnt(0)
    s_barrier
    ds_read_b128 v[16:19], v120 offset:32768
    ds_read_b128 v[20:23], v120 offset:34816
    ds_read_b64_tr_b16 v[24:25], v122 offset:32768
    ds_read_b64_tr_b16 v[26:27], v122 offset:33280
    ds_read_b64_tr_b16 v[28:29], v123 offset:32768
    ds_read_b64_tr_b16 v[30:31], v123 offset:33280
    s_waitcnt lgkmcnt(6)
    v_mfma_f32_16x16x32_bf16 v[64:67], v[48:51], v[40:43], v[64:67]
    v_mfma_f32_16x16x32_bf16 v[68:71], v[48:51], v[44:47], v[68:71]
    v_mfma_f32_16x16x32_bf16 v[72:75], v[52:55], v[40:43], v[72:75]
    v_mfma_f32_16x16x32_bf16 v[76:79], v[52:55], v[44:47], v[76:79]
    ds_read_b128 v[40:43], v121 offset:32768
    ds_read_b128 v[44:47], v121 offset:34816
    ds_read_b64_tr_b16 v[48:49], v122 offset:36864
    ds_read_b64_tr_b16 v[50:51], v122 offset:37376
    ds_read_b64_tr_b16 v[52:53], v123 offset:36864
    ds_read_b64_tr_b16 v[54:55], v123 offset:37376
    s_waitcnt lgkmcnt(6)
    v_mfma_f32_16x16x32_bf16 v[64:67], v[24:27], v[16:19], v[64:67]
    v_mfma_f32_16x16x32_bf16 v[68:71], v[24:27], v[20:23], v[68:71]
    v_mfma_f32_16x16x32_bf16 v[72:75], v[28:31], v[16:19], v[72:75]
    v_mfma_f32_16x16x32_bf16 v[76:79], v[28:31], v[20:23], v[76:79]
    ds_read_b128 v[16:19], v120 offset:49152
    ds_read_b128 v[20:23], v120 offset:51200
    ds_read_b64_tr_b16 v[24:25], v122 offset:49152
    ds_read_b64_tr_b16 v[26:27], v122 offset:49664
    ds_read_b64_tr_b16 v[28:29], v123 offset:49152
    ds_read_b64_tr_b16 v[30:31], v123 offset:49664
    s_waitcnt lgkmcnt(6)
    v_mfma_f32_16x16x32_bf16 v[64:67], v[48:51], v[40:43], v[64:67]
    v_mfma_f32_16x16x32_bf16 v[68:71], v[48:51], v[44:47], v[68:71]
    v_mfma_f32_16x16x32_bf16 v[72:75], v[52:55], v[40:43], v[72:75]
    v_mfma_f32_16x16x32_bf16 v[76:79], v[52:55], v[44:47], v[76:79]
    ds_read_b128 v[40:43], v121 offset:49152
    ds_read_b128 v[44:47], v121 offset:51200
    ds_read_b64_tr_b16 v[48:49], v122 offset:53248
    ds_read_b64_tr_b16 v[50:51], v122 offset:53760
    ds_read_b64_tr_b16 v[52:53], v123 offset:53248
    ds_read_b64_tr_b16 v[54:55], v123 offset:53760
    s_waitcnt lgkmcnt(6)
    v_mfma_f32_16x16x32_bf16 v[64:67], v[24:27], v[16:19], v[64:67]
    v_mfma_f32_16x16x32_bf16 v[68:71], v[24:27], v[20:23], v[68:71]
    v_mfma_f32_16x16x32_bf16 v[72:75], v[28:31], v[16:19], v[72:75]
    v_mfma_f32_16x16x32_bf16 v[76:79], v[28:31], v[20:23], v[76:79]
    s_waitcnt lgkmcnt(0)
    v_mfma_f32_16x16x32_bf16 v[64:67], v[48:51], v[40:43], v[64:67]
    v_mfma_f32_16x16x32_bf16 v[68:71], v[48:51], v[44:47], v[68:71]
    v_mfma_f32_16x16x32_bf16 v[72:75], v[52:55], v[40:43], v[72:75]
    v_mfma_f32_16x16x32_bf16 v[76:79], v[52:55], v[44:47], v[76:79]
    s_waitcnt vmcnt(0)
    v_lshlrev_b32 v96, 16, v80
    v_and_b32 v97, 0xffff0000, v80
    v_lshlrev_b32 v98, 16, v81
    v_and_b32 v99, 0xffff0000, v81
    v_fma_f32 v96, v88, v64, v96
    v_fma_f32 v97, v89, v65, v97
    v_fma_f32 v98, v90, v66, v98
    v_fma_f32 v99, v91, v67, v99
    v_cvt_pk_bf16_f32 v80, v96, v97
    v_cvt_pk_bf16_f32 v81, v98, v99
    s_mov_b32 s47, 0
    buffer_store_dwordx2 v[80:81], v118, s[28:31], s47 offen offset:0
    v_lshlrev_b32 v96, 16, v80
    v_and_b32 v97, 0xffff0000, v80
    v_lshlrev_b32 v98, 16, v81
    v_and_b32 v99, 0xffff0000, v81
    v_lshlrev_b32 v100, 16, v84
    v_and_b32 v101, 0xffff0000, v84
    v_lshlrev_b32 v102, 16, v85
    v_and_b32 v103, 0xffff0000, v85
    v_fma_f32 v100, v92, v72, v100
    v_fma_f32 v101, v93, v73, v101
    v_fma_f32 v102, v94, v74, v102
    v_fma_f32 v103, v95, v75, v103
    v_cvt_pk_bf16_f32 v84, v100, v101
    v_cvt_pk_bf16_f32 v85, v102, v103
    s_mov_b32 s47, 0
    buffer_store_dwordx2 v[84:85], v118, s[28:31], s47 offen offset:32
    v_lshlrev_b32 v100, 16, v84
    v_and_b32 v101, 0xffff0000, v84
    v_lshlrev_b32 v102, 16, v85
    v_and_b32 v103, 0xffff0000, v85
    v_add_f32 v104, v96, v97
    v_add_f32 v104, v104, v98
    v_add_f32 v104, v104, v99
    v_add_f32 v104, v104, v100
    v_add_f32 v104, v104, v101
    v_add_f32 v104, v104, v102
    v_add_f32 v104, v104, v103
    v_mov_b32 v106, v104
    s_nop 1
    v_permlane16_swap_b32 v104, v106
    v_add_f32 v104, v104, v106
    v_mov_b32 v106, v104
    s_nop 1
    v_permlane32_swap_b32 v104, v106
    v_add_f32 v104, v104, v106
    v_mul_f32 v104, 0x3d000000, v104
    v_mov_b32 v105, 0
    v_sub_f32 v106, v96, v104
    v_fmac_f32 v105, v106, v106
    v_sub_f32 v106, v97, v104
    v_fmac_f32 v105, v106, v106
    v_sub_f32 v106, v98, v104
    v_fmac_f32 v105, v106, v106
    v_sub_f32 v106, v99, v104
    v_fmac_f32 v105, v106, v106
    v_sub_f32 v106, v100, v104
    v_fmac_f32 v105, v106, v106
    v_sub_f32 v106, v101, v104
    v_fmac_f32 v105, v106, v106
    v_sub_f32 v106, v102, v104
    v_fmac_f32 v105, v106, v106
    v_sub_f32 v106, v103, v104
    v_fmac_f32 v105, v106, v106
    v_mov_b32 v106, v105
    s_nop 1
    v_permlane16_swap_b32 v105, v106
    v_add_f32 v105, v105, v106
    v_mov_b32 v106, v105
    s_nop 1
    v_permlane32_swap_b32 v105, v106
    v_add_f32 v105, v105, v106
    v_mov_b32 v108, v104
    v_mov_b32 v109, v105
    s_mov_b32 s47, 0
    buffer_store_dwordx2 v[108:109], v119, s[36:39], s47 offen
    v_lshlrev_b32 v96, 16, v82
    v_and_b32 v97, 0xffff0000, v82
    v_lshlrev_b32 v98, 16, v83
    v_and_b32 v99, 0xffff0000, v83
    v_fma_f32 v96, v88, v68, v96
    v_fma_f32 v97, v89, v69, v97
    v_fma_f32 v98, v90, v70, v98
    v_fma_f32 v99, v91, v71, v99
    v_cvt_pk_bf16_f32 v82, v96, v97
    v_cvt_pk_bf16_f32 v83, v98, v99
    s_mov_b32 s47, 16384
    buffer_store_dwordx2 v[82:83], v118, s[28:31], s47 offen offset:0
    v_lshlrev_b32 v96, 16, v82
    v_and_b32 v97, 0xffff0000, v82
    v_lshlrev_b32 v98, 16, v83
    v_and_b32 v99, 0xffff0000, v83
    v_lshlrev_b32 v100, 16, v86
    v_and_b32 v101, 0xffff0000, v86
    v_lshlrev_b32 v102, 16, v87
    v_and_b32 v103, 0xffff0000, v87
    v_fma_f32 v100, v92, v76, v100
    v_fma_f32 v101, v93, v77, v101
    v_fma_f32 v102, v94, v78, v102
    v_fma_f32 v103, v95, v79, v103
    v_cvt_pk_bf16_f32 v86, v100, v101
    v_cvt_pk_bf16_f32 v87, v102, v103
    s_mov_b32 s47, 16384
    buffer_store_dwordx2 v[86:87], v118, s[28:31], s47 offen offset:32
    v_lshlrev_b32 v100, 16, v86
    v_and_b32 v101, 0xffff0000, v86
    v_lshlrev_b32 v102, 16, v87
    v_and_b32 v103, 0xffff0000, v87
    v_add_f32 v104, v96, v97
    v_add_f32 v104, v104, v98
    v_add_f32 v104, v104, v99
    v_add_f32 v104, v104, v100
    v_add_f32 v104, v104, v101
    v_add_f32 v104, v104, v102
    v_add_f32 v104, v104, v103
    v_mov_b32 v106, v104
    s_nop 1
    v_permlane16_swap_b32 v104, v106
    v_add_f32 v104, v104, v106
    v_mov_b32 v106, v104
    s_nop 1
    v_permlane32_swap_b32 v104, v106
    v_add_f32 v104, v104, v106
    v_mul_f32 v104, 0x3d000000, v104
    v_mov_b32 v105, 0
    v_sub_f32 v106, v96, v104
    v_fmac_f32 v105, v106, v106
    v_sub_f32 v106, v97, v104
    v_fmac_f32 v105, v106, v106
    v_sub_f32 v106, v98, v104
    v_fmac_f32 v105, v106, v106
    v_sub_f32 v106, v99, v104
    v_fmac_f32 v105, v106, v106
    v_sub_f32 v106, v100, v104
    v_fmac_f32 v105, v106, v106
    v_sub_f32 v106, v101, v104
    v_fmac_f32 v105, v106, v106
    v_sub_f32 v106, v102, v104
    v_fmac_f32 v105, v106, v106
    v_sub_f32 v106, v103, v104
    v_fmac_f32 v105, v106, v106
    v_mov_b32 v106, v105
    s_nop 1
    v_permlane16_swap_b32 v105, v106
    v_add_f32 v105, v105, v106
    v_mov_b32 v106, v105
    s_nop 1
    v_permlane32_swap_b32 v105, v106
    v_add_f32 v105, v105, v106
    v_mov_b32 v108, v104
    v_mov_b32 v109, v105
    s_mov_b32 s47, 2048
    buffer_store_dwordx2 v[108:109], v119, s[36:39], s47 offen
k2_kernel_end:
    s_endpgm
.globl k3_kernel
.type k3_kernel,@function
.p2align 8
k3_kernel:
    s_cmp_ge_u32 s2, 256
    s_cbranch_scc1 k3_end
    s_load_dwordx4 s[4:7], s[0:1], 32
    s_load_dwordx2 s[8:9], s[0:1], 88
    v_lshrrev_b32 v1, 6, v0
    s_nop 0
    v_readfirstlane_b32 s32, v1
    s_lshr_b32 s33, s2, 4
    s_and_b32 s34, s2, 15
    s_lshl_b32 s35, s33, 7
    v_lshrrev_b32 v2, 3, v0
    v_and_b32 v3, 7, v0
    v_and_b32 v4, 63, v0
    v_and_b32 v5, 15, v0
    v_bfe_u32 v6, v0, 4, 2
    s_waitcnt lgkmcnt(0)
    s_add_u32 s12, s8, 4194304
    s_addc_u32 s13, s9, 0
    s_mov_b32 s14, 2097152
    s_mov_b32 s15, 0x20000
    s_mov_b32 s16, s4
    s_mov_b32 s17, s5
    s_mov_b32 s18, 1835008
    s_mov_b32 s19, 0x20000
    s_mov_b32 s40, s6
    s_mov_b32 s41, s7
    s_mov_b32 s42, 1835008
    s_mov_b32 s43, 0x20000
    s_add_u32 s20, s8, 65536
    s_addc_u32 s21, s9, 0
    s_mov_b32 s22, 262144
    s_mov_b32 s23, 0x20000
    s_mov_b32 s24, s8
    s_mov_b32 s25, s9
    s_mov_b32 s26, 12288
    s_mov_b32 s27, 0x20000
    s_add_u32 s28, s8, 8388608
    s_addc_u32 s29, s9, 0
    s_mov_b32 s30, 7340032
    s_mov_b32 s31, 0x20000
    s_cmp_lt_u32 s32, 2
    s_cselect_b32 s16, s16, s40
    s_cselect_b32 s17, s17, s41
    v_add_u32 v7, s35, v2
    v_lshlrev_b32 v220, 10, v7
    v_lshl_add_u32 v220, v3, 4, v220
    v_lshlrev_b32 v7, 7, v7
    v_lshl_add_u32 v7, v3, 4, v7
    buffer_load_dwordx4 v[16:19], v7, s[20:23], 0 offen
    v_add_u32 v7, s35, v2
    v_add_u32 v7, 32, v7
    v_lshlrev_b32 v221, 10, v7
    v_lshl_add_u32 v221, v3, 4, v221
    v_lshlrev_b32 v7, 7, v7
    v_lshl_add_u32 v7, v3, 4, v7
    buffer_load_dwordx4 v[20:23], v7, s[20:23], 0 offen
    v_add_u32 v7, s35, v2
    v_add_u32 v7, 64, v7
    v_lshlrev_b32 v222, 10, v7
    v_lshl_add_u32 v222, v3, 4, v222
    v_lshlrev_b32 v7, 7, v7
    v_lshl_add_u32 v7, v3, 4, v7
    buffer_load_dwordx4 v[24:27], v7, s[20:23], 0 offen
    v_add_u32 v7, s35, v2
    v_add_u32 v7, 96, v7
    v_lshlrev_b32 v223, 10, v7
    v_lshl_add_u32 v223, v3, 4, v223
    v_lshlrev_b32 v7, 7, v7
    v_lshl_add_u32 v7, v3, 4, v7
    buffer_load_dwordx4 v[28:31], v7, s[20:23], 0 offen
    v_lshlrev_b32 v7, 3, v0
    s_movk_i32 s47, 6144
    buffer_load_dwordx2 v[50:51], v7, s[24:27], s47 offen
    buffer_load_dwordx2 v[52:53], v7, s[24:27], s47 offen offset:2048
    s_mul_i32 s48, s34, 224
    s_and_b32 s49, s32, 1
    s_lshl_b32 s49, s49, 3
    s_add_u32 s49, s49, 0
    s_mul_i32 s50, s49, 14336
    s_add_u32 s56, s50, s48
    s_lshr_b32 s50, s32, 1
    s_lshl_b32 s50, s50, 14
    s_lshl_b32 s49, s49, 10
    s_add_u32 s64, s50, s49
    s_and_b32 s49, s32, 1
    s_lshl_b32 s49, s49, 3
    s_add_u32 s49, s49, 1
    s_mul_i32 s50, s49, 14336
    s_add_u32 s57, s50, s48
    s_lshr_b32 s50, s32, 1
    s_lshl_b32 s50, s50, 14
    s_lshl_b32 s49, s49, 10
    s_add_u32 s65, s50, s49
    s_and_b32 s49, s32, 1
    s_lshl_b32 s49, s49, 3
    s_add_u32 s49, s49, 2
    s_mul_i32 s50, s49, 14336
    s_add_u32 s58, s50, s48
    s_lshr_b32 s50, s32, 1
    s_lshl_b32 s50, s50, 14
    s_lshl_b32 s49, s49, 10
    s_add_u32 s66, s50, s49
    s_and_b32 s49, s32, 1
    s_lshl_b32 s49, s49, 3
    s_add_u32 s49, s49, 3
    s_mul_i32 s50, s49, 14336
    s_add_u32 s59, s50, s48
    s_lshr_b32 s50, s32, 1
    s_lshl_b32 s50, s50, 14
    s_lshl_b32 s49, s49, 10
    s_add_u32 s67, s50, s49
    s_and_b32 s49, s32, 1
    s_lshl_b32 s49, s49, 3
    s_add_u32 s49, s49, 4
    s_mul_i32 s50, s49, 14336
    s_add_u32 s60, s50, s48
    s_lshr_b32 s50, s32, 1
    s_lshl_b32 s50, s50, 14
    s_lshl_b32 s49, s49, 10
    s_add_u32 s68, s50, s49
    s_and_b32 s49, s32, 1
    s_lshl_b32 s49, s49, 3
    s_add_u32 s49, s49, 5
    s_mul_i32 s50, s49, 14336
    s_add_u32 s61, s50, s48
    s_lshr_b32 s50, s32, 1
    s_lshl_b32 s50, s50, 14
    s_lshl_b32 s49, s49, 10
    s_add_u32 s69, s50, s49
    s_and_b32 s49, s32, 1
    s_lshl_b32 s49, s49, 3
    s_add_u32 s49, s49, 6
    s_mul_i32 s50, s49, 14336
    s_add_u32 s62, s50, s48
    s_lshr_b32 s50, s32, 1
    s_lshl_b32 s50, s50, 14
    s_lshl_b32 s49, s49, 10
    s_add_u32 s70, s50, s49
    s_and_b32 s49, s32, 1
    s_lshl_b32 s49, s49, 3
    s_add_u32 s49, s49, 7
    s_mul_i32 s50, s49, 14336
    s_add_u32 s63, s50, s48
    s_lshr_b32 s50, s32, 1
    s_lshl_b32 s50, s50, 14
    s_lshl_b32 s49, s49, 10
    s_add_u32 s71, s50, s49
    v_lshrrev_b32 v7, 4, v4
    v_and_b32 v8, 15, v4
    v_mov_b32 v9, v7
    v_lshlrev_b32 v9, 1, v9
    v_xor_b32 v9, v8, v9
    v_lshlrev_b32 v9, 4, v9
    v_mul_u32_u24 v10, 3584, v7
    v_add_u32 v234, v9, v10
    v_or_b32 v9, 4, v7
    v_lshlrev_b32 v9, 1, v9
    v_xor_b32 v9, v8, v9
    v_lshlrev_b32 v9, 4, v9
    v_mul_u32_u24 v10, 3584, v7
    v_add_u32 v235, v9, v10
    v_lshrrev_b32 v7, 2, v5
    v_lshl_add_u32 v8, v6, 3, v7
    v_lshlrev_b32 v8, 8, v8
    v_and_b32 v9, 1, v6
    v_lshl_or_b32 v9, v9, 2, v7
    v_lshlrev_b32 v9, 1, v9
    v_bfe_u32 v10, v5, 1, 1
    v_xor_b32 v9, v9, v10
    v_lshl_add_u32 v8, v9, 4, v8
    v_and_b32 v9, 1, v5
    v_lshl_add_u32 v8, v9, 3, v8
    v_add_u32 v236, 45056, v8
    v_add_u32 v237, 77824, v8
    v_add_u32 v238, 110592, v8
    s_lshl_b32 s49, s32, 5
    v_add_u32 v7, s49, v5
    v_mul_u32_u24 v7, 160, v7
    v_lshl_add_u32 v7, v6, 4, v7
    v_add_u32 v239, 4096, v7
    v_mul_u32_u24 v7, 160, v2
    v_lshl_add_u32 v7, v3, 4, v7
    v_add_u32 v232, 4096, v7
    v_lshlrev_b32 v233, 5, v3
    s_add_u32 s49, s49, s35
    v_add_u32 v7, s49, v5
    v_mul_u32_u24 v7, 3584, v7
    v_lshl_add_u32 v7, v6, 3, v7
    v_add_u32 v240, s48, v7
    s_add_u32 s49, s56, 0
    s_add_u32 m0, s64, 45056
    s_nop 0
    buffer_load_dwordx4 v234, s[16:19], s49 offen lds
    s_add_u32 s49, s57, 0
    s_add_u32 m0, s65, 45056
    s_nop 0
    buffer_load_dwordx4 v234, s[16:19], s49 offen lds
    s_add_u32 s49, s58, 0
    s_add_u32 m0, s66, 45056
    s_nop 0
    buffer_load_dwordx4 v235, s[16:19], s49 offen lds
    s_add_u32 s49, s59, 0
    s_add_u32 m0, s67, 45056
    s_nop 0
    buffer_load_dwordx4 v235, s[16:19], s49 offen lds
    s_add_u32 s49, s60, 0
    s_add_u32 m0, s68, 45056
    s_nop 0
    buffer_load_dwordx4 v234, s[16:19], s49 offen lds
    s_add_u32 s49, s61, 0
    s_add_u32 m0, s69, 45056
    s_nop 0
    buffer_load_dwordx4 v234, s[16:19], s49 offen lds
    s_add_u32 s49, s62, 0
    s_add_u32 m0, s70, 45056
    s_nop 0
    buffer_load_dwordx4 v235, s[16:19], s49 offen lds
    s_add_u32 s49, s63, 0
    s_add_u32 m0, s71, 45056
    s_nop 0
    buffer_load_dwordx4 v235, s[16:19], s49 offen lds
    s_add_u32 s49, s56, 229376
    s_add_u32 m0, s64, 77824
    s_nop 0
    buffer_load_dwordx4 v234, s[16:19], s49 offen lds
    s_add_u32 s49, s57, 229376
    s_add_u32 m0, s65, 77824
    s_nop 0
    buffer_load_dwordx4 v234, s[16:19], s49 offen lds
    s_add_u32 s49, s58, 229376
    s_add_u32 m0, s66, 77824
    s_nop 0
    buffer_load_dwordx4 v235, s[16:19], s49 offen lds
    s_add_u32 s49, s59, 229376
    s_add_u32 m0, s67, 77824
    s_nop 0
    buffer_load_dwordx4 v235, s[16:19], s49 offen lds
    s_add_u32 s49, s60, 229376
    s_add_u32 m0, s68, 77824
    s_nop 0
    buffer_load_dwordx4 v234, s[16:19], s49 offen lds
    s_add_u32 s49, s61, 229376
    s_add_u32 m0, s69, 77824
    s_nop 0
    buffer_load_dwordx4 v234, s[16:19], s49 offen lds
    s_add_u32 s49, s62, 229376
    s_add_u32 m0, s70, 77824
    s_nop 0
    buffer_load_dwordx4 v235, s[16:19], s49 offen lds
    s_add_u32 s49, s63, 229376
    s_add_u32 m0, s71, 77824
    s_nop 0
    buffer_load_dwordx4 v235, s[16:19], s49 offen lds
    s_waitcnt vmcnt(16)
    v_add_f32 v52, 1.0, v52
    v_add_f32 v53, 1.0, v53
    v_cvt_pk_bf16_f32 v54, v52, v53
    v_lshlrev_b32 v52, 16, v54
    v_and_b32 v53, 0xffff0000, v54
    v_lshlrev_b32 v7, 3, v0
    ds_write_b64 v7, v[52:53]
    ds_write_b64 v7, v[50:51] offset:2048
    v_add_f32 v7, v16, v18
    s_nop 1
    v_add_f32_dpp v7, v7, v7 quad_perm:[1,0,3,2] row_mask:0xf bank_mask:0xf
    s_nop 1
    v_add_f32_dpp v7, v7, v7 quad_perm:[2,3,0,1] row_mask:0xf bank_mask:0xf
    s_nop 1
    v_add_f32_dpp v7, v7, v7 row_half_mirror row_mask:0xf bank_mask:0xf
    v_mul_f32 v7, 0x3d800000, v7
    v_sub_f32 v8, v16, v7
    v_sub_f32 v9, v18, v7
    v_mul_f32 v8, v8, v8
    v_fmac_f32 v8, v9, v9
    v_add_f32 v9, v17, v19
    v_fmac_f32 v9, 0x42000000, v8
    s_nop 1
    v_add_f32_dpp v9, v9, v9 quad_perm:[1,0,3,2] row_mask:0xf bank_mask:0xf
    s_nop 1
    v_add_f32_dpp v9, v9, v9 quad_perm:[2,3,0,1] row_mask:0xf bank_mask:0xf
    s_nop 1
    v_add_f32_dpp v9, v9, v9 row_half_mirror row_mask:0xf bank_mask:0xf
    v_mul_f32 v9, 0x3b000000, v9
    v_add_f32 v9, 0x3727c5ac, v9
    v_rsq_f32 v224, v9
    s_nop 0
    v_mul_f32 v8, v7, v224
    v_sub_f32 v228, 0, v8
    v_add_f32 v7, v20, v22
    s_nop 1
    v_add_f32_dpp v7, v7, v7 quad_perm:[1,0,3,2] row_mask:0xf bank_mask:0xf
    s_nop 1
    v_add_f32_dpp v7, v7, v7 quad_perm:[2,3,0,1] row_mask:0xf bank_mask:0xf
    s_nop 1
    v_add_f32_dpp v7, v7, v7 row_half_mirror row_mask:0xf bank_mask:0xf
    v_mul_f32 v7, 0x3d800000, v7
    v_sub_f32 v8, v20, v7
    v_sub_f32 v9, v22, v7
    v_mul_f32 v8, v8, v8
    v_fmac_f32 v8, v9, v9
    v_add_f32 v9, v21, v23
    v_fmac_f32 v9, 0x42000000, v8
    s_nop 1
    v_add_f32_dpp v9, v9, v9 quad_perm:[1,0,3,2] row_mask:0xf bank_mask:0xf
    s_nop 1
    v_add_f32_dpp v9, v9, v9 quad_perm:[2,3,0,1] row_mask:0xf bank_mask:0xf
    s_nop 1
    v_add_f32_dpp v9, v9, v9 row_half_mirror row_mask:0xf bank_mask:0xf
    v_mul_f32 v9, 0x3b000000, v9
    v_add_f32 v9, 0x3727c5ac, v9
    v_rsq_f32 v225, v9
    s_nop 0
    v_mul_f32 v8, v7, v225
    v_sub_f32 v229, 0, v8
    v_add_f32 v7, v24, v26
    s_nop 1
    v_add_f32_dpp v7, v7, v7 quad_perm:[1,0,3,2] row_mask:0xf bank_mask:0xf
    s_nop 1
    v_add_f32_dpp v7, v7, v7 quad_perm:[2,3,0,1] row_mask:0xf bank_mask:0xf
    s_nop 1
    v_add_f32_dpp v7, v7, v7 row_half_mirror row_mask:0xf bank_mask:0xf
    v_mul_f32 v7, 0x3d800000, v7
    v_sub_f32 v8, v24, v7
    v_sub_f32 v9, v26, v7
    v_mul_f32 v8, v8, v8
    v_fmac_f32 v8, v9, v9
    v_add_f32 v9, v25, v27
    v_fmac_f32 v9, 0x42000000, v8
    s_nop 1
    v_add_f32_dpp v9, v9, v9 quad_perm:[1,0,3,2] row_mask:0xf bank_mask:0xf
    s_nop 1
    v_add_f32_dpp v9, v9, v9 quad_perm:[2,3,0,1] row_mask:0xf bank_mask:0xf
    s_nop 1
    v_add_f32_dpp v9, v9, v9 row_half_mirror row_mask:0xf bank_mask:0xf
    v_mul_f32 v9, 0x3b000000, v9
    v_add_f32 v9, 0x3727c5ac, v9
    v_rsq_f32 v226, v9
    s_nop 0
    v_mul_f32 v8, v7, v226
    v_sub_f32 v230, 0, v8
    v_add_f32 v7, v28, v30
    s_nop 1
    v_add_f32_dpp v7, v7, v7 quad_perm:[1,0,3,2] row_mask:0xf bank_mask:0xf
    s_nop 1
    v_add_f32_dpp v7, v7, v7 quad_perm:[2,3,0,1] row_mask:0xf bank_mask:0xf
    s_nop 1
    v_add_f32_dpp v7, v7, v7 row_half_mirror row_mask:0xf bank_mask:0xf
    v_mul_f32 v7, 0x3d800000, v7
    v_sub_f32 v8, v28, v7
    v_sub_f32 v9, v30, v7
    v_mul_f32 v8, v8, v8
    v_fmac_f32 v8, v9, v9
    v_add_f32 v9, v29, v31
    v_fmac_f32 v9, 0x42000000, v8
    s_nop 1
    v_add_f32_dpp v9, v9, v9 quad_perm:[1,0,3,2] row_mask:0xf bank_mask:0xf
    s_nop 1
    v_add_f32_dpp v9, v9, v9 quad_perm:[2,3,0,1] row_mask:0xf bank_mask:0xf
    s_nop 1
    v_add_f32_dpp v9, v9, v9 row_half_mirror row_mask:0xf bank_mask:0xf
    v_mul_f32 v9, 0x3b000000, v9
    v_add_f32 v9, 0x3727c5ac, v9
    v_rsq_f32 v227, v9
    s_nop 0
    v_mul_f32 v8, v7, v227
    v_sub_f32 v231, 0, v8
    buffer_load_dwordx4 v[16:19], v220, s[12:15], 0 offen offset:0
    buffer_load_dwordx4 v[20:23], v221, s[12:15], 0 offen offset:0
    buffer_load_dwordx4 v[24:27], v222, s[12:15], 0 offen offset:0
    buffer_load_dwordx4 v[28:31], v223, s[12:15], 0 offen offset:0
    s_waitcnt lgkmcnt(0)
    s_barrier
    ds_read_b128 v[32:35], v233 offset:0
    ds_read_b128 v[36:39], v233 offset:16
    ds_read_b128 v[40:43], v233 offset:2048
    ds_read_b128 v[44:47], v233 offset:2064
    s_waitcnt vmcnt(0)
    s_waitcnt lgkmcnt(0)
    v_lshlrev_b32 v48, 16, v16
    v_and_b32 v49, 0xffff0000, v16
    v_lshlrev_b32 v50, 16, v17
    v_and_b32 v51, 0xffff0000, v17
    v_lshlrev_b32 v52, 16, v18
    v_and_b32 v53, 0xffff0000, v18
    v_lshlrev_b32 v54, 16, v19
    v_and_b32 v55, 0xffff0000, v19
    v_fma_f32 v48, v48, v224, v228
    v_fma_f32 v49, v49, v224, v228
    v_fma_f32 v50, v50, v224, v228
    v_fma_f32 v51, v51, v224, v228
    v_fma_f32 v52, v52, v224, v228
    v_fma_f32 v53, v53, v224, v228
    v_fma_f32 v54, v54, v224, v228
    v_fma_f32 v55, v55, v224, v228
    v_fma_f32 v48, v48, v32, v40
    v_fma_f32 v49, v49, v33, v41
    v_fma_f32 v50, v50, v34, v42
    v_fma_f32 v51, v51, v35, v43
    v_fma_f32 v52, v52, v36, v44
    v_fma_f32 v53, v53, v37, v45
    v_fma_f32 v54, v54, v38, v46
    v_fma_f32 v55, v55, v39, v47
    v_cvt_pk_bf16_f32 v56, v48, v49
    v_cvt_pk_bf16_f32 v57, v50, v51
    v_cvt_pk_bf16_f32 v58, v52, v53
    v_cvt_pk_bf16_f32 v59, v54, v55
    ds_write_b128 v232, v[56:59] offset:0
    v_lshlrev_b32 v48, 16, v20
    v_and_b32 v49, 0xffff0000, v20
    v_lshlrev_b32 v50, 16, v21
    v_and_b32 v51, 0xffff0000, v21
    v_lshlrev_b32 v52, 16, v22
    v_and_b32 v53, 0xffff0000, v22
    v_lshlrev_b32 v54, 16, v23
    v_and_b32 v55, 0xffff0000, v23
    v_fma_f32 v48, v48, v225, v229
    v_fma_f32 v49, v49, v225, v229
    v_fma_f32 v50, v50, v225, v229
    v_fma_f32 v51, v51, v225, v229
    v_fma_f32 v52, v52, v225, v229
    v_fma_f32 v53, v53, v225, v229
    v_fma_f32 v54, v54, v225, v229
    v_fma_f32 v55, v55, v225, v229
    v_fma_f32 v48, v48, v32, v40
    v_fma_f32 v49, v49, v33, v41
    v_fma_f32 v50, v50, v34, v42
    v_fma_f32 v51, v51, v35, v43
    v_fma_f32 v52, v52, v36, v44
    v_fma_f32 v53, v53, v37, v45
    v_fma_f32 v54, v54, v38, v46
    v_fma_f32 v55, v55, v39, v47
    v_cvt_pk_bf16_f32 v56, v48, v49
    v_cvt_pk_bf16_f32 v57, v50, v51
    v_cvt_pk_bf16_f32 v58, v52, v53
    v_cvt_pk_bf16_f32 v59, v54, v55
    ds_write_b128 v232, v[56:59] offset:5120
    v_lshlrev_b32 v48, 16, v24
    v_and_b32 v49, 0xffff0000, v24
    v_lshlrev_b32 v50, 16, v25
    v_and_b32 v51, 0xffff0000, v25
    v_lshlrev_b32 v52, 16, v26
    v_and_b32 v53, 0xffff0000, v26
    v_lshlrev_b32 v54, 16, v27
    v_and_b32 v55, 0xffff0000, v27
    v_fma_f32 v48, v48, v226, v230
    v_fma_f32 v49, v49, v226, v230
    v_fma_f32 v50, v50, v226, v230
    v_fma_f32 v51, v51, v226, v230
    v_fma_f32 v52, v52, v226, v230
    v_fma_f32 v53, v53, v226, v230
    v_fma_f32 v54, v54, v226, v230
    v_fma_f32 v55, v55, v226, v230
    v_fma_f32 v48, v48, v32, v40
    v_fma_f32 v49, v49, v33, v41
    v_fma_f32 v50, v50, v34, v42
    v_fma_f32 v51, v51, v35, v43
    v_fma_f32 v52, v52, v36, v44
    v_fma_f32 v53, v53, v37, v45
    v_fma_f32 v54, v54, v38, v46
    v_fma_f32 v55, v55, v39, v47
    v_cvt_pk_bf16_f32 v56, v48, v49
    v_cvt_pk_bf16_f32 v57, v50, v51
    v_cvt_pk_bf16_f32 v58, v52, v53
    v_cvt_pk_bf16_f32 v59, v54, v55
    ds_write_b128 v232, v[56:59] offset:10240
    v_lshlrev_b32 v48, 16, v28
    v_and_b32 v49, 0xffff0000, v28
    v_lshlrev_b32 v50, 16, v29
    v_and_b32 v51, 0xffff0000, v29
    v_lshlrev_b32 v52, 16, v30
    v_and_b32 v53, 0xffff0000, v30
    v_lshlrev_b32 v54, 16, v31
    v_and_b32 v55, 0xffff0000, v31
    v_fma_f32 v48, v48, v227, v231
    v_fma_f32 v49, v49, v227, v231
    v_fma_f32 v50, v50, v227, v231
    v_fma_f32 v51, v51, v227, v231
    v_fma_f32 v52, v52, v227, v231
    v_fma_f32 v53, v53, v227, v231
    v_fma_f32 v54, v54, v227, v231
    v_fma_f32 v55, v55, v227, v231
    v_fma_f32 v48, v48, v32, v40
    v_fma_f32 v49, v49, v33, v41
    v_fma_f32 v50, v50, v34, v42
    v_fma_f32 v51, v51, v35, v43
    v_fma_f32 v52, v52, v36, v44
    v_fma_f32 v53, v53, v37, v45
    v_fma_f32 v54, v54, v38, v46
    v_fma_f32 v55, v55, v39, v47
    v_cvt_pk_bf16_f32 v56, v48, v49
    v_cvt_pk_bf16_f32 v57, v50, v51
    v_cvt_pk_bf16_f32 v58, v52, v53
    v_cvt_pk_bf16_f32 v59, v54, v55
    ds_write_b128 v232, v[56:59] offset:15360
    buffer_load_dwordx4 v[16:19], v220, s[12:15], 0 offen offset:128
    buffer_load_dwordx4 v[20:23], v221, s[12:15], 0 offen offset:128
    buffer_load_dwordx4 v[24:27], v222, s[12:15], 0 offen offset:128
    buffer_load_dwordx4 v[28:31], v223, s[12:15], 0 offen offset:128
    s_waitcnt lgkmcnt(0)
    s_barrier
    s_add_u32 s49, s56, 458752
    s_add_u32 m0, s64, 110592
    s_nop 0
    buffer_load_dwordx4 v234, s[16:19], s49 offen lds
    s_add_u32 s49, s57, 458752
    s_add_u32 m0, s65, 110592
    s_nop 0
    buffer_load_dwordx4 v234, s[16:19], s49 offen lds
    s_add_u32 s49, s58, 458752
    s_add_u32 m0, s66, 110592
    s_nop 0
    buffer_load_dwordx4 v235, s[16:19], s49 offen lds
    s_add_u32 s49, s59, 458752
    s_add_u32 m0, s67, 110592
    s_nop 0
    buffer_load_dwordx4 v235, s[16:19], s49 offen lds
    s_add_u32 s49, s60, 458752
    s_add_u32 m0, s68, 110592
    s_nop 0
    buffer_load_dwordx4 v234, s[16:19], s49 offen lds
    s_add_u32 s49, s61, 458752
    s_add_u32 m0, s69, 110592
    s_nop 0
    buffer_load_dwordx4 v234, s[16:19], s49 offen lds
    s_add_u32 s49, s62, 458752
    s_add_u32 m0, s70, 110592
    s_nop 0
    buffer_load_dwordx4 v235, s[16:19], s49 offen lds
    s_add_u32 s49, s63, 458752
    s_add_u32 m0, s71, 110592
    s_nop 0
    buffer_load_dwordx4 v235, s[16:19], s49 offen lds
    ds_read_b128 v[60:63], v239 offset:0
    ds_read_b128 v[64:67], v239 offset:2560
    v_xor_b32 v241, 0, v236
    ds_read_b64_tr_b16 v[76:77], v241 offset:0
    ds_read_b64_tr_b16 v[78:79], v241 offset:1024
    ds_read_b64_tr_b16 v[80:81], v241 offset:16384
    ds_read_b64_tr_b16 v[82:83], v241 offset:17408
    v_xor_b32 v242, 32, v236
    ds_read_b64_tr_b16 v[84:85], v242 offset:0
    ds_read_b64_tr_b16 v[86:87], v242 offset:1024
    ds_read_b64_tr_b16 v[88:89], v242 offset:16384
    ds_read_b64_tr_b16 v[90:91], v242 offset:17408
    s_waitcnt lgkmcnt(6)
    v_mfma_f32_16x16x32_bf16 v[108:111], v[76:79], v[60:63], 0
    v_mfma_f32_16x16x32_bf16 v[112:115], v[76:79], v[64:67], 0
    v_xor_b32 v243, 64, v236
    ds_read_b64_tr_b16 v[92:93], v243 offset:0
    ds_read_b64_tr_b16 v[94:95], v243 offset:1024
    s_waitcnt lgkmcnt(6)
    v_mfma_f32_16x16x32_bf16 v[164:167], v[80:83], v[60:63], 0
    v_mfma_f32_16x16x32_bf16 v[168:171], v[80:83], v[64:67], 0
    ds_read_b64_tr_b16 v[96:97], v243 offset:16384
    ds_read_b64_tr_b16 v[98:99], v243 offset:17408
    s_waitcnt lgkmcnt(6)
    v_mfma_f32_16x16x32_bf16 v[116:119], v[84:87], v[60:63], 0
    v_mfma_f32_16x16x32_bf16 v[120:123], v[84:87], v[64:67], 0
    v_xor_b32 v244, 96, v236
    ds_read_b64_tr_b16 v[100:101], v244 offset:0
    ds_read_b64_tr_b16 v[102:103], v244 offset:1024
    ds_read_b128 v[32:35], v233 offset:256
    ds_read_b128 v[36:39], v233 offset:272
    ds_read_b128 v[40:43], v233 offset:2304
    ds_read_b128 v[44:47], v233 offset:2320
    s_waitcnt vmcnt(8)
    s_waitcnt lgkmcnt(0)
    v_lshlrev_b32 v48, 16, v16
    v_mfma_f32_16x16x32_bf16 v[172:175], v[88:91], v[60:63], 0
    v_mfma_f32_16x16x32_bf16 v[176:179], v[88:91], v[64:67], 0
    ds_read_b64_tr_b16 v[104:105], v244 offset:16384
    ds_read_b64_tr_b16 v[106:107], v244 offset:17408
    v_and_b32 v49, 0xffff0000, v16
    v_lshlrev_b32 v50, 16, v17
    v_and_b32 v51, 0xffff0000, v17
    v_lshlrev_b32 v52, 16, v18
    v_and_b32 v53, 0xffff0000, v18
    v_lshlrev_b32 v54, 16, v19
    v_mfma_f32_16x16x32_bf16 v[124:127], v[92:95], v[60:63], 0
    v_mfma_f32_16x16x32_bf16 v[128:131], v[92:95], v[64:67], 0
    v_xor_b32 v245, 128, v236
    ds_read_b64_tr_b16 v[76:77], v245 offset:0
    ds_read_b64_tr_b16 v[78:79], v245 offset:1024
    v_and_b32 v55, 0xffff0000, v19
    v_fma_f32 v48, v48, v224, v228
    v_fma_f32 v49, v49, v224, v228
    v_fma_f32 v50, v50, v224, v228
    v_fma_f32 v51, v51, v224, v228
    v_fma_f32 v52, v52, v224, v228
    v_mfma_f32_16x16x32_bf16 v[180:183], v[96:99], v[60:63], 0
    v_mfma_f32_16x16x32_bf16 v[184:187], v[96:99], v[64:67], 0
    ds_read_b64_tr_b16 v[80:81], v245 offset:16384
    ds_read_b64_tr_b16 v[82:83], v245 offset:17408
    v_fma_f32 v53, v53, v224, v228
    v_fma_f32 v54, v54, v224, v228
    v_fma_f32 v55, v55, v224, v228
    v_fma_f32 v48, v48, v32, v40
    v_fma_f32 v49, v49, v33, v41
    v_fma_f32 v50, v50, v34, v42
    ds_read_b128 v[68:71], v239 offset:64
    ds_read_b128 v[72:75], v239 offset:2624
    v_mfma_f32_16x16x32_bf16 v[132:135], v[100:103], v[60:63], 0
    v_mfma_f32_16x16x32_bf16 v[136:139], v[100:103], v[64:67], 0
    v_xor_b32 v246, 160, v236
    ds_read_b64_tr_b16 v[84:85], v246 offset:0
    ds_read_b64_tr_b16 v[86:87], v246 offset:1024
    v_fma_f32 v51, v51, v35, v43
    v_fma_f32 v52, v52, v36, v44
    v_fma_f32 v53, v53, v37, v45
    v_fma_f32 v54, v54, v38, v46
    v_fma_f32 v55, v55, v39, v47
    v_cvt_pk_bf16_f32 v56, v48, v49
    s_waitcnt lgkmcnt(8)
    v_mfma_f32_16x16x32_bf16 v[188:191], v[104:107], v[60:63], 0
    v_mfma_f32_16x16x32_bf16 v[192:195], v[104:107], v[64:67], 0
    ds_read_b64_tr_b16 v[88:89], v246 offset:16384
    ds_read_b64_tr_b16 v[90:91], v246 offset:17408
    v_cvt_pk_bf16_f32 v57, v50, v51
    v_cvt_pk_bf16_f32 v58, v52, v53
    v_cvt_pk_bf16_f32 v59, v54, v55
    ds_write_b128 v232, v[56:59] offset:20480
    v_lshlrev_b32 v48, 16, v20
    v_and_b32 v49, 0xffff0000, v20
    s_waitcnt lgkmcnt(9)
    v_mfma_f32_16x16x32_bf16 v[140:143], v[76:79], v[60:63], 0
    v_mfma_f32_16x16x32_bf16 v[144:147], v[76:79], v[64:67], 0
    v_xor_b32 v247, 192, v236
    ds_read_b64_tr_b16 v[92:93], v247 offset:0
    ds_read_b64_tr_b16 v[94:95], v247 offset:1024
    v_lshlrev_b32 v50, 16, v21
    v_and_b32 v51, 0xffff0000, v21
    v_lshlrev_b32 v52, 16, v22
    v_and_b32 v53, 0xffff0000, v22
    v_lshlrev_b32 v54, 16, v23
    v_and_b32 v55, 0xffff0000, v23
    s_waitcnt lgkmcnt(9)
    v_mfma_f32_16x16x32_bf16 v[196:199], v[80:83], v[60:63], 0
    v_mfma_f32_16x16x32_bf16 v[200:203], v[80:83], v[64:67], 0
    ds_read_b64_tr_b16 v[96:97], v247 offset:16384
    ds_read_b64_tr_b16 v[98:99], v247 offset:17408
    v_fma_f32 v48, v48, v225, v229
    v_fma_f32 v49, v49, v225, v229
    v_fma_f32 v50, v50, v225, v229
    v_fma_f32 v51, v51, v225, v229
    v_fma_f32 v52, v52, v225, v229
    v_fma_f32 v53, v53, v225, v229
    s_waitcnt lgkmcnt(7)
    v_mfma_f32_16x16x32_bf16 v[148:151], v[84:87], v[60:63], 0
    v_mfma_f32_16x16x32_bf16 v[152:155], v[84:87], v[64:67], 0
    v_xor_b32 v241, 0, v236
    ds_read_b64_tr_b16 v[100:101], v241 offset:8192
    ds_read_b64_tr_b16 v[102:103], v241 offset:9216
    v_fma_f32 v54, v54, v225, v229
    v_fma_f32 v55, v55, v225, v229
    v_fma_f32 v48, v48, v32, v40
    v_fma_f32 v49, v49, v33, v41
    v_fma_f32 v50, v50, v34, v42
    v_fma_f32 v51, v51, v35, v43
    s_waitcnt lgkmcnt(7)
    v_mfma_f32_16x16x32_bf16 v[204:207], v[88:91], v[60:63], 0
    v_mfma_f32_16x16x32_bf16 v[208:211], v[88:91], v[64:67], 0
    ds_read_b64_tr_b16 v[104:105], v241 offset:24576
    ds_read_b64_tr_b16 v[106:107], v241 offset:25600
    v_fma_f32 v52, v52, v36, v44
    v_fma_f32 v53, v53, v37, v45
    v_fma_f32 v54, v54, v38, v46
    v_fma_f32 v55, v55, v39, v47
    v_cvt_pk_bf16_f32 v56, v48, v49
    v_cvt_pk_bf16_f32 v57, v50, v51
    s_waitcnt lgkmcnt(6)
    v_mfma_f32_16x16x32_bf16 v[156:159], v[92:95], v[60:63], 0
    v_mfma_f32_16x16x32_bf16 v[160:163], v[92:95], v[64:67], 0
    v_xor_b32 v242, 32, v236
    ds_read_b64_tr_b16 v[76:77], v242 offset:8192
    ds_read_b64_tr_b16 v[78:79], v242 offset:9216
    v_cvt_pk_bf16_f32 v58, v52, v53
    v_cvt_pk_bf16_f32 v59, v54, v55
    ds_write_b128 v232, v[56:59] offset:25600
    v_lshlrev_b32 v48, 16, v24
    v_and_b32 v49, 0xffff0000, v24
    v_lshlrev_b32 v50, 16, v25
    s_waitcnt lgkmcnt(7)
    v_mfma_f32_16x16x32_bf16 v[212:215], v[96:99], v[60:63], 0
    v_mfma_f32_16x16x32_bf16 v[216:219], v[96:99], v[64:67], 0
    ds_read_b64_tr_b16 v[80:81], v242 offset:24576
    ds_read_b64_tr_b16 v[82:83], v242 offset:25600
    v_and_b32 v51, 0xffff0000, v25
    v_lshlrev_b32 v52, 16, v26
    v_and_b32 v53, 0xffff0000, v26
    v_lshlrev_b32 v54, 16, v27
    v_and_b32 v55, 0xffff0000, v27
    v_fma_f32 v48, v48, v226, v230
    s_waitcnt lgkmcnt(7)
    v_mfma_f32_16x16x32_bf16 v[108:111], v[100:103], v[68:71], v[108:111]
    v_mfma_f32_16x16x32_bf16 v[112:115], v[100:103], v[72:75], v[112:115]
    v_xor_b32 v243, 64, v236
    ds_read_b64_tr_b16 v[84:85], v243 offset:8192
    ds_read_b64_tr_b16 v[86:87], v243 offset:9216
    v_fma_f32 v49, v49, v226, v230
    v_fma_f32 v50, v50, v226, v230
    v_fma_f32 v51, v51, v226, v230
    v_fma_f32 v52, v52, v226, v230
    v_fma_f32 v53, v53, v226, v230
    v_fma_f32 v54, v54, v226, v230
    s_waitcnt lgkmcnt(7)
    v_mfma_f32_16x16x32_bf16 v[164:167], v[104:107], v[68:71], v[164:167]
    v_mfma_f32_16x16x32_bf16 v[168:171], v[104:107], v[72:75], v[168:171]
    ds_read_b64_tr_b16 v[88:89], v243 offset:24576
    ds_read_b64_tr_b16 v[90:91], v243 offset:25600
    v_fma_f32 v55, v55, v226, v230
    v_fma_f32 v48, v48, v32, v40
    v_fma_f32 v49, v49, v33, v41
    v_fma_f32 v50, v50, v34, v42
    v_fma_f32 v51, v51, v35, v43
    v_fma_f32 v52, v52, v36, v44
    s_waitcnt lgkmcnt(7)
    v_mfma_f32_16x16x32_bf16 v[116:119], v[76:79], v[68:71], v[116:119]
    v_mfma_f32_16x16x32_bf16 v[120:123], v[76:79], v[72:75], v[120:123]
    v_xor_b32 v244, 96, v236
    ds_read_b64_tr_b16 v[92:93], v244 offset:8192
    ds_read_b64_tr_b16 v[94:95], v244 offset:9216
    v_fma_f32 v53, v53, v37, v45
    v_fma_f32 v54, v54, v38, v46
    v_fma_f32 v55, v55, v39, v47
    v_cvt_pk_bf16_f32 v56, v48, v49
    v_cvt_pk_bf16_f32 v57, v50, v51
    v_cvt_pk_bf16_f32 v58, v52, v53
    s_waitcnt lgkmcnt(6)
    v_mfma_f32_16x16x32_bf16 v[172:175], v[80:83], v[68:71], v[172:175]
    v_mfma_f32_16x16x32_bf16 v[176:179], v[80:83], v[72:75], v[176:179]
    ds_read_b64_tr_b16 v[96:97], v244 offset:24576
    ds_read_b64_tr_b16 v[98:99], v244 offset:25600
    v_cvt_pk_bf16_f32 v59, v54, v55
    ds_write_b128 v232, v[56:59] offset:30720
    v_lshlrev_b32 v48, 16, v28
    v_and_b32 v49, 0xffff0000, v28
    v_lshlrev_b32 v50, 16, v29
    v_and_b32 v51, 0xffff0000, v29
    s_waitcnt lgkmcnt(7)
    v_mfma_f32_16x16x32_bf16 v[124:127], v[84:87], v[68:71], v[124:127]
    v_mfma_f32_16x16x32_bf16 v[128:131], v[84:87], v[72:75], v[128:131]
    v_xor_b32 v245, 128, v236
    ds_read_b64_tr_b16 v[100:101], v245 offset:8192
    ds_read_b64_tr_b16 v[102:103], v245 offset:9216
    v_lshlrev_b32 v52, 16, v30
    v_and_b32 v53, 0xffff0000, v30
    v_lshlrev_b32 v54, 16, v31
    v_and_b32 v55, 0xffff0000, v31
    v_fma_f32 v48, v48, v227, v231
    v_fma_f32 v49, v49, v227, v231
    s_waitcnt lgkmcnt(7)
    v_mfma_f32_16x16x32_bf16 v[180:183], v[88:91], v[68:71], v[180:183]
    v_mfma_f32_16x16x32_bf16 v[184:187], v[88:91], v[72:75], v[184:187]
    ds_read_b64_tr_b16 v[104:105], v245 offset:24576
    ds_read_b64_tr_b16 v[106:107], v245 offset:25600
    v_fma_f32 v50, v50, v227, v231
    v_fma_f32 v51, v51, v227, v231
    v_fma_f32 v52, v52, v227, v231
    v_fma_f32 v53, v53, v227, v231
    v_fma_f32 v54, v54, v227, v231
    v_fma_f32 v55, v55, v227, v231
    s_waitcnt lgkmcnt(7)
    v_mfma_f32_16x16x32_bf16 v[132:135], v[92:95], v[68:71], v[132:135]
    v_mfma_f32_16x16x32_bf16 v[136:139], v[92:95], v[72:75], v[136:139]
    v_xor_b32 v246, 160, v236
    ds_read_b64_tr_b16 v[76:77], v246 offset:8192
    ds_read_b64_tr_b16 v[78:79], v246 offset:9216
    v_fma_f32 v48, v48, v32, v40
    v_fma_f32 v49, v49, v33, v41
    v_fma_f32 v50, v50, v34, v42
    v_fma_f32 v51, v51, v35, v43
    v_fma_f32 v52, v52, v36, v44
    v_fma_f32 v53, v53, v37, v45
    s_waitcnt lgkmcnt(7)
    v_mfma_f32_16x16x32_bf16 v[188:191], v[96:99], v[68:71], v[188:191]
    v_mfma_f32_16x16x32_bf16 v[192:195], v[96:99], v[72:75], v[192:195]
    ds_read_b64_tr_b16 v[80:81], v246 offset:24576
    ds_read_b64_tr_b16 v[82:83], v246 offset:25600
    v_fma_f32 v54, v54, v38, v46
    v_fma_f32 v55, v55, v39, v47
    v_cvt_pk_bf16_f32 v56, v48, v49
    v_cvt_pk_bf16_f32 v57, v50, v51
    v_cvt_pk_bf16_f32 v58, v52, v53
    v_cvt_pk_bf16_f32 v59, v54, v55
    s_waitcnt lgkmcnt(6)
    v_mfma_f32_16x16x32_bf16 v[140:143], v[100:103], v[68:71], v[140:143]
    v_mfma_f32_16x16x32_bf16 v[144:147], v[100:103], v[72:75], v[144:147]
    v_xor_b32 v247, 192, v236
    ds_read_b64_tr_b16 v[84:85], v247 offset:8192
    ds_read_b64_tr_b16 v[86:87], v247 offset:9216
    ds_write_b128 v232, v[56:59] offset:35840
    s_waitcnt lgkmcnt(7)
    v_mfma_f32_16x16x32_bf16 v[196:199], v[104:107], v[68:71], v[196:199]
    v_mfma_f32_16x16x32_bf16 v[200:203], v[104:107], v[72:75], v[200:203]
    ds_read_b64_tr_b16 v[88:89], v247 offset:24576
    ds_read_b64_tr_b16 v[90:91], v247 offset:25600
    s_waitcnt lgkmcnt(7)
    v_mfma_f32_16x16x32_bf16 v[148:151], v[76:79], v[68:71], v[148:151]
    v_mfma_f32_16x16x32_bf16 v[152:155], v[76:79], v[72:75], v[152:155]
    s_waitcnt lgkmcnt(5)
    v_mfma_f32_16x16x32_bf16 v[204:207], v[80:83], v[68:71], v[204:207]
    v_mfma_f32_16x16x32_bf16 v[208:211], v[80:83], v[72:75], v[208:211]
    s_waitcnt lgkmcnt(3)
    v_mfma_f32_16x16x32_bf16 v[156:159], v[84:87], v[68:71], v[156:159]
    v_mfma_f32_16x16x32_bf16 v[160:163], v[84:87], v[72:75], v[160:163]
    s_waitcnt lgkmcnt(0)
    v_mfma_f32_16x16x32_bf16 v[212:215], v[88:91], v[68:71], v[212:215]
    v_mfma_f32_16x16x32_bf16 v[216:219], v[88:91], v[72:75], v[216:219]
    buffer_load_dwordx4 v[16:19], v220, s[12:15], 0 offen offset:256
    buffer_load_dwordx4 v[20:23], v221, s[12:15], 0 offen offset:256
    buffer_load_dwordx4 v[24:27], v222, s[12:15], 0 offen offset:256
    buffer_load_dwordx4 v[28:31], v223, s[12:15], 0 offen offset:256
    s_waitcnt lgkmcnt(0)
    s_barrier
    s_add_u32 s49, s56, 688128
    s_add_u32 m0, s64, 45056
    s_nop 0
    buffer_load_dwordx4 v234, s[16:19], s49 offen lds
    s_add_u32 s49, s57, 688128
    s_add_u32 m0, s65, 45056
    s_nop 0
    buffer_load_dwordx4 v234, s[16:19], s49 offen lds
    s_add_u32 s49, s58, 688128
    s_add_u32 m0, s66, 45056
    s_nop 0
    buffer_load_dwordx4 v235, s[16:19], s49 offen lds
    s_add_u32 s49, s59, 688128
    s_add_u32 m0, s67, 45056
    s_nop 0
    buffer_load_dwordx4 v235, s[16:19], s49 offen lds
    s_add_u32 s49, s60, 688128
    s_add_u32 m0, s68, 45056
    s_nop 0
    buffer_load_dwordx4 v234, s[16:19], s49 offen lds
    s_add_u32 s49, s61, 688128
    s_add_u32 m0, s69, 45056
    s_nop 0
    buffer_load_dwordx4 v234, s[16:19], s49 offen lds
    s_add_u32 s49, s62, 688128
    s_add_u32 m0, s70, 45056
    s_nop 0
    buffer_load_dwordx4 v235, s[16:19], s49 offen lds
    s_add_u32 s49, s63, 688128
    s_add_u32 m0, s71, 45056
    s_nop 0
    buffer_load_dwordx4 v235, s[16:19], s49 offen lds
    ds_read_b128 v[60:63], v239 offset:20480
    ds_read_b128 v[64:67], v239 offset:23040
    v_xor_b32 v241, 0, v237
    ds_read_b64_tr_b16 v[76:77], v241 offset:0
    ds_read_b64_tr_b16 v[78:79], v241 offset:1024
    ds_read_b64_tr_b16 v[80:81], v241 offset:16384
    ds_read_b64_tr_b16 v[82:83], v241 offset:17408
    v_xor_b32 v242, 32, v237
    ds_read_b64_tr_b16 v[84:85], v242 offset:0
    ds_read_b64_tr_b16 v[86:87], v242 offset:1024
    ds_read_b64_tr_b16 v[88:89], v242 offset:16384
    ds_read_b64_tr_b16 v[90:91], v242 offset:17408
    s_waitcnt lgkmcnt(6)
    v_mfma_f32_16x16x32_bf16 v[108:111], v[76:79], v[60:63], v[108:111]
    v_mfma_f32_16x16x32_bf16 v[112:115], v[76:79], v[64:67], v[112:115]
    v_xor_b32 v243, 64, v237
    ds_read_b64_tr_b16 v[92:93], v243 offset:0
    ds_read_b64_tr_b16 v[94:95], v243 offset:1024
    s_waitcnt lgkmcnt(6)
    v_mfma_f32_16x16x32_bf16 v[164:167], v[80:83], v[60:63], v[164:167]
    v_mfma_f32_16x16x32_bf16 v[168:171], v[80:83], v[64:67], v[168:171]
    ds_read_b64_tr_b16 v[96:97], v243 offset:16384
    ds_read_b64_tr_b16 v[98:99], v243 offset:17408
    s_waitcnt lgkmcnt(6)
    v_mfma_f32_16x16x32_bf16 v[116:119], v[84:87], v[60:63], v[116:119]
    v_mfma_f32_16x16x32_bf16 v[120:123], v[84:87], v[64:67], v[120:123]
    v_xor_b32 v244, 96, v237
    ds_read_b64_tr_b16 v[100:101], v244 offset:0
    ds_read_b64_tr_b16 v[102:103], v244 offset:1024
    ds_read_b128 v[32:35], v233 offset:512
    ds_read_b128 v[36:39], v233 offset:528
    ds_read_b128 v[40:43], v233 offset:2560
    ds_read_b128 v[44:47], v233 offset:2576
    s_waitcnt vmcnt(8)
    s_waitcnt lgkmcnt(0)
    v_lshlrev_b32 v48, 16, v16
    v_mfma_f32_16x16x32_bf16 v[172:175], v[88:91], v[60:63], v[172:175]
    v_mfma_f32_16x16x32_bf16 v[176:179], v[88:91], v[64:67], v[176:179]
    ds_read_b64_tr_b16 v[104:105], v244 offset:16384
    ds_read_b64_tr_b16 v[106:107], v244 offset:17408
    v_and_b32 v49, 0xffff0000, v16
    v_lshlrev_b32 v50, 16, v17
    v_and_b32 v51, 0xffff0000, v17
    v_lshlrev_b32 v52, 16, v18
    v_and_b32 v53, 0xffff0000, v18
    v_lshlrev_b32 v54, 16, v19
    v_mfma_f32_16x16x32_bf16 v[124:127], v[92:95], v[60:63], v[124:127]
    v_mfma_f32_16x16x32_bf16 v[128:131], v[92:95], v[64:67], v[128:131]
    v_xor_b32 v245, 128, v237
    ds_read_b64_tr_b16 v[76:77], v245 offset:0
    ds_read_b64_tr_b16 v[78:79], v245 offset:1024
    v_and_b32 v55, 0xffff0000, v19
    v_fma_f32 v48, v48, v224, v228
    v_fma_f32 v49, v49, v224, v228
    v_fma_f32 v50, v50, v224, v228
    v_fma_f32 v51, v51, v224, v228
    v_fma_f32 v52, v52, v224, v228
    v_mfma_f32_16x16x32_bf16 v[180:183], v[96:99], v[60:63], v[180:183]
    v_mfma_f32_16x16x32_bf16 v[184:187], v[96:99], v[64:67], v[184:187]
    ds_read_b64_tr_b16 v[80:81], v245 offset:16384
    ds_read_b64_tr_b16 v[82:83], v245 offset:17408
    v_fma_f32 v53, v53, v224, v228
    v_fma_f32 v54, v54, v224, v228
    v_fma_f32 v55, v55, v224, v228
    v_fma_f32 v48, v48, v32, v40
    v_fma_f32 v49, v49, v33, v41
    v_fma_f32 v50, v50, v34, v42
    ds_read_b128 v[68:71], v239 offset:20544
    ds_read_b128 v[72:75], v239 offset:23104
    v_mfma_f32_16x16x32_bf16 v[132:135], v[100:103], v[60:63], v[132:135]
    v_mfma_f32_16x16x32_bf16 v[136:139], v[100:103], v[64:67], v[136:139]
    v_xor_b32 v246, 160, v237
    ds_read_b64_tr_b16 v[84:85], v246 offset:0
    ds_read_b64_tr_b16 v[86:87], v246 offset:1024
    v_fma_f32 v51, v51, v35, v43
    v_fma_f32 v52, v52, v36, v44
    v_fma_f32 v53, v53, v37, v45
    v_fma_f32 v54, v54, v38, v46
    v_fma_f32 v55, v55, v39, v47
    v_cvt_pk_bf16_f32 v56, v48, v49
    s_waitcnt lgkmcnt(8)
    v_mfma_f32_16x16x32_bf16 v[188:191], v[104:107], v[60:63], v[188:191]
    v_mfma_f32_16x16x32_bf16 v[192:195], v[104:107], v[64:67], v[192:195]
    ds_read_b64_tr_b16 v[88:89], v246 offset:16384
    ds_read_b64_tr_b16 v[90:91], v246 offset:17408
    v_cvt_pk_bf16_f32 v57, v50, v51
    v_cvt_pk_bf16_f32 v58, v52, v53
    v_cvt_pk_bf16_f32 v59, v54, v55
    ds_write_b128 v232, v[56:59] offset:0
    v_lshlrev_b32 v48, 16, v20
    v_and_b32 v49, 0xffff0000, v20
    s_waitcnt lgkmcnt(9)
    v_mfma_f32_16x16x32_bf16 v[140:143], v[76:79], v[60:63], v[140:143]
    v_mfma_f32_16x16x32_bf16 v[144:147], v[76:79], v[64:67], v[144:147]
    v_xor_b32 v247, 192, v237
    ds_read_b64_tr_b16 v[92:93], v247 offset:0
    ds_read_b64_tr_b16 v[94:95], v247 offset:1024
    v_lshlrev_b32 v50, 16, v21
    v_and_b32 v51, 0xffff0000, v21
    v_lshlrev_b32 v52, 16, v22
    v_and_b32 v53, 0xffff0000, v22
    v_lshlrev_b32 v54, 16, v23
    v_and_b32 v55, 0xffff0000, v23
    s_waitcnt lgkmcnt(9)
    v_mfma_f32_16x16x32_bf16 v[196:199], v[80:83], v[60:63], v[196:199]
    v_mfma_f32_16x16x32_bf16 v[200:203], v[80:83], v[64:67], v[200:203]
    ds_read_b64_tr_b16 v[96:97], v247 offset:16384
    ds_read_b64_tr_b16 v[98:99], v247 offset:17408
    v_fma_f32 v48, v48, v225, v229
    v_fma_f32 v49, v49, v225, v229
    v_fma_f32 v50, v50, v225, v229
    v_fma_f32 v51, v51, v225, v229
    v_fma_f32 v52, v52, v225, v229
    v_fma_f32 v53, v53, v225, v229
    s_waitcnt lgkmcnt(7)
    v_mfma_f32_16x16x32_bf16 v[148:151], v[84:87], v[60:63], v[148:151]
    v_mfma_f32_16x16x32_bf16 v[152:155], v[84:87], v[64:67], v[152:155]
    v_xor_b32 v241, 0, v237
    ds_read_b64_tr_b16 v[100:101], v241 offset:8192
    ds_read_b64_tr_b16 v[102:103], v241 offset:9216
    v_fma_f32 v54, v54, v225, v229
    v_fma_f32 v55, v55, v225, v229
    v_fma_f32 v48, v48, v32, v40
    v_fma_f32 v49, v49, v33, v41
    v_fma_f32 v50, v50, v34, v42
    v_fma_f32 v51, v51, v35, v43
    s_waitcnt lgkmcnt(7)
    v_mfma_f32_16x16x32_bf16 v[204:207], v[88:91], v[60:63], v[204:207]
    v_mfma_f32_16x16x32_bf16 v[208:211], v[88:91], v[64:67], v[208:211]
    ds_read_b64_tr_b16 v[104:105], v241 offset:24576
    ds_read_b64_tr_b16 v[106:107], v241 offset:25600
    v_fma_f32 v52, v52, v36, v44
    v_fma_f32 v53, v53, v37, v45
    v_fma_f32 v54, v54, v38, v46
    v_fma_f32 v55, v55, v39, v47
    v_cvt_pk_bf16_f32 v56, v48, v49
    v_cvt_pk_bf16_f32 v57, v50, v51
    s_waitcnt lgkmcnt(6)
    v_mfma_f32_16x16x32_bf16 v[156:159], v[92:95], v[60:63], v[156:159]
    v_mfma_f32_16x16x32_bf16 v[160:163], v[92:95], v[64:67], v[160:163]
    v_xor_b32 v242, 32, v237
    ds_read_b64_tr_b16 v[76:77], v242 offset:8192
    ds_read_b64_tr_b16 v[78:79], v242 offset:9216
    v_cvt_pk_bf16_f32 v58, v52, v53
    v_cvt_pk_bf16_f32 v59, v54, v55
    ds_write_b128 v232, v[56:59] offset:5120
    v_lshlrev_b32 v48, 16, v24
    v_and_b32 v49, 0xffff0000, v24
    v_lshlrev_b32 v50, 16, v25
    s_waitcnt lgkmcnt(7)
    v_mfma_f32_16x16x32_bf16 v[212:215], v[96:99], v[60:63], v[212:215]
    v_mfma_f32_16x16x32_bf16 v[216:219], v[96:99], v[64:67], v[216:219]
    ds_read_b64_tr_b16 v[80:81], v242 offset:24576
    ds_read_b64_tr_b16 v[82:83], v242 offset:25600
    v_and_b32 v51, 0xffff0000, v25
    v_lshlrev_b32 v52, 16, v26
    v_and_b32 v53, 0xffff0000, v26
    v_lshlrev_b32 v54, 16, v27
    v_and_b32 v55, 0xffff0000, v27
    v_fma_f32 v48, v48, v226, v230
    s_waitcnt lgkmcnt(7)
    v_mfma_f32_16x16x32_bf16 v[108:111], v[100:103], v[68:71], v[108:111]
    v_mfma_f32_16x16x32_bf16 v[112:115], v[100:103], v[72:75], v[112:115]
    v_xor_b32 v243, 64, v237
    ds_read_b64_tr_b16 v[84:85], v243 offset:8192
    ds_read_b64_tr_b16 v[86:87], v243 offset:9216
    v_fma_f32 v49, v49, v226, v230
    v_fma_f32 v50, v50, v226, v230
    v_fma_f32 v51, v51, v226, v230
    v_fma_f32 v52, v52, v226, v230
    v_fma_f32 v53, v53, v226, v230
    v_fma_f32 v54, v54, v226, v230
    s_waitcnt lgkmcnt(7)
    v_mfma_f32_16x16x32_bf16 v[164:167], v[104:107], v[68:71], v[164:167]
    v_mfma_f32_16x16x32_bf16 v[168:171], v[104:107], v[72:75], v[168:171]
    ds_read_b64_tr_b16 v[88:89], v243 offset:24576
    ds_read_b64_tr_b16 v[90:91], v243 offset:25600
    v_fma_f32 v55, v55, v226, v230
    v_fma_f32 v48, v48, v32, v40
    v_fma_f32 v49, v49, v33, v41
    v_fma_f32 v50, v50, v34, v42
    v_fma_f32 v51, v51, v35, v43
    v_fma_f32 v52, v52, v36, v44
    s_waitcnt lgkmcnt(7)
    v_mfma_f32_16x16x32_bf16 v[116:119], v[76:79], v[68:71], v[116:119]
    v_mfma_f32_16x16x32_bf16 v[120:123], v[76:79], v[72:75], v[120:123]
    v_xor_b32 v244, 96, v237
    ds_read_b64_tr_b16 v[92:93], v244 offset:8192
    ds_read_b64_tr_b16 v[94:95], v244 offset:9216
    v_fma_f32 v53, v53, v37, v45
    v_fma_f32 v54, v54, v38, v46
    v_fma_f32 v55, v55, v39, v47
    v_cvt_pk_bf16_f32 v56, v48, v49
    v_cvt_pk_bf16_f32 v57, v50, v51
    v_cvt_pk_bf16_f32 v58, v52, v53
    s_waitcnt lgkmcnt(6)
    v_mfma_f32_16x16x32_bf16 v[172:175], v[80:83], v[68:71], v[172:175]
    v_mfma_f32_16x16x32_bf16 v[176:179], v[80:83], v[72:75], v[176:179]
    ds_read_b64_tr_b16 v[96:97], v244 offset:24576
    ds_read_b64_tr_b16 v[98:99], v244 offset:25600
    v_cvt_pk_bf16_f32 v59, v54, v55
    ds_write_b128 v232, v[56:59] offset:10240
    v_lshlrev_b32 v48, 16, v28
    v_and_b32 v49, 0xffff0000, v28
    v_lshlrev_b32 v50, 16, v29
    v_and_b32 v51, 0xffff0000, v29
    s_waitcnt lgkmcnt(7)
    v_mfma_f32_16x16x32_bf16 v[124:127], v[84:87], v[68:71], v[124:127]
    v_mfma_f32_16x16x32_bf16 v[128:131], v[84:87], v[72:75], v[128:131]
    v_xor_b32 v245, 128, v237
    ds_read_b64_tr_b16 v[100:101], v245 offset:8192
    ds_read_b64_tr_b16 v[102:103], v245 offset:9216
    v_lshlrev_b32 v52, 16, v30
    v_and_b32 v53, 0xffff0000, v30
    v_lshlrev_b32 v54, 16, v31
    v_and_b32 v55, 0xffff0000, v31
    v_fma_f32 v48, v48, v227, v231
    v_fma_f32 v49, v49, v227, v231
    s_waitcnt lgkmcnt(7)
    v_mfma_f32_16x16x32_bf16 v[180:183], v[88:91], v[68:71], v[180:183]
    v_mfma_f32_16x16x32_bf16 v[184:187], v[88:91], v[72:75], v[184:187]
    ds_read_b64_tr_b16 v[104:105], v245 offset:24576
    ds_read_b64_tr_b16 v[106:107], v245 offset:25600
    v_fma_f32 v50, v50, v227, v231
    v_fma_f32 v51, v51, v227, v231
    v_fma_f32 v52, v52, v227, v231
    v_fma_f32 v53, v53, v227, v231
    v_fma_f32 v54, v54, v227, v231
    v_fma_f32 v55, v55, v227, v231
    s_waitcnt lgkmcnt(7)
    v_mfma_f32_16x16x32_bf16 v[132:135], v[92:95], v[68:71], v[132:135]
    v_mfma_f32_16x16x32_bf16 v[136:139], v[92:95], v[72:75], v[136:139]
    v_xor_b32 v246, 160, v237
    ds_read_b64_tr_b16 v[76:77], v246 offset:8192
    ds_read_b64_tr_b16 v[78:79], v246 offset:9216
    v_fma_f32 v48, v48, v32, v40
    v_fma_f32 v49, v49, v33, v41
    v_fma_f32 v50, v50, v34, v42
    v_fma_f32 v51, v51, v35, v43
    v_fma_f32 v52, v52, v36, v44
    v_fma_f32 v53, v53, v37, v45
    s_waitcnt lgkmcnt(7)
    v_mfma_f32_16x16x32_bf16 v[188:191], v[96:99], v[68:71], v[188:191]
    v_mfma_f32_16x16x32_bf16 v[192:195], v[96:99], v[72:75], v[192:195]
    ds_read_b64_tr_b16 v[80:81], v246 offset:24576
    ds_read_b64_tr_b16 v[82:83], v246 offset:25600
    v_fma_f32 v54, v54, v38, v46
    v_fma_f32 v55, v55, v39, v47
    v_cvt_pk_bf16_f32 v56, v48, v49
    v_cvt_pk_bf16_f32 v57, v50, v51
    v_cvt_pk_bf16_f32 v58, v52, v53
    v_cvt_pk_bf16_f32 v59, v54, v55
    s_waitcnt lgkmcnt(6)
    v_mfma_f32_16x16x32_bf16 v[140:143], v[100:103], v[68:71], v[140:143]
    v_mfma_f32_16x16x32_bf16 v[144:147], v[100:103], v[72:75], v[144:147]
    v_xor_b32 v247, 192, v237
    ds_read_b64_tr_b16 v[84:85], v247 offset:8192
    ds_read_b64_tr_b16 v[86:87], v247 offset:9216
    ds_write_b128 v232, v[56:59] offset:15360
    s_waitcnt lgkmcnt(7)
    v_mfma_f32_16x16x32_bf16 v[196:199], v[104:107], v[68:71], v[196:199]
    v_mfma_f32_16x16x32_bf16 v[200:203], v[104:107], v[72:75], v[200:203]
    ds_read_b64_tr_b16 v[88:89], v247 offset:24576
    ds_read_b64_tr_b16 v[90:91], v247 offset:25600
    s_waitcnt lgkmcnt(7)
    v_mfma_f32_16x16x32_bf16 v[148:151], v[76:79], v[68:71], v[148:151]
    v_mfma_f32_16x16x32_bf16 v[152:155], v[76:79], v[72:75], v[152:155]
    s_waitcnt lgkmcnt(5)
    v_mfma_f32_16x16x32_bf16 v[204:207], v[80:83], v[68:71], v[204:207]
    v_mfma_f32_16x16x32_bf16 v[208:211], v[80:83], v[72:75], v[208:211]
    s_waitcnt lgkmcnt(3)
    v_mfma_f32_16x16x32_bf16 v[156:159], v[84:87], v[68:71], v[156:159]
    v_mfma_f32_16x16x32_bf16 v[160:163], v[84:87], v[72:75], v[160:163]
    s_waitcnt lgkmcnt(0)
    v_mfma_f32_16x16x32_bf16 v[212:215], v[88:91], v[68:71], v[212:215]
    v_mfma_f32_16x16x32_bf16 v[216:219], v[88:91], v[72:75], v[216:219]
    buffer_load_dwordx4 v[16:19], v220, s[12:15], 0 offen offset:384
    buffer_load_dwordx4 v[20:23], v221, s[12:15], 0 offen offset:384
    buffer_load_dwordx4 v[24:27], v222, s[12:15], 0 offen offset:384
    buffer_load_dwordx4 v[28:31], v223, s[12:15], 0 offen offset:384
    s_waitcnt lgkmcnt(0)
    s_barrier
    s_add_u32 s49, s56, 917504
    s_add_u32 m0, s64, 77824
    s_nop 0
    buffer_load_dwordx4 v234, s[16:19], s49 offen lds
    s_add_u32 s49, s57, 917504
    s_add_u32 m0, s65, 77824
    s_nop 0
    buffer_load_dwordx4 v234, s[16:19], s49 offen lds
    s_add_u32 s49, s58, 917504
    s_add_u32 m0, s66, 77824
    s_nop 0
    buffer_load_dwordx4 v235, s[16:19], s49 offen lds
    s_add_u32 s49, s59, 917504
    s_add_u32 m0, s67, 77824
    s_nop 0
    buffer_load_dwordx4 v235, s[16:19], s49 offen lds
    s_add_u32 s49, s60, 917504
    s_add_u32 m0, s68, 77824
    s_nop 0
    buffer_load_dwordx4 v234, s[16:19], s49 offen lds
    s_add_u32 s49, s61, 917504
    s_add_u32 m0, s69, 77824
    s_nop 0
    buffer_load_dwordx4 v234, s[16:19], s49 offen lds
    s_add_u32 s49, s62, 917504
    s_add_u32 m0, s70, 77824
    s_nop 0
    buffer_load_dwordx4 v235, s[16:19], s49 offen lds
    s_add_u32 s49, s63, 917504
    s_add_u32 m0, s71, 77824
    s_nop 0
    buffer_load_dwordx4 v235, s[16:19], s49 offen lds
    ds_read_b128 v[60:63], v239 offset:0
    ds_read_b128 v[64:67], v239 offset:2560
    v_xor_b32 v241, 0, v238
    ds_read_b64_tr_b16 v[76:77], v241 offset:0
    ds_read_b64_tr_b16 v[78:79], v241 offset:1024
    ds_read_b64_tr_b16 v[80:81], v241 offset:16384
    ds_read_b64_tr_b16 v[82:83], v241 offset:17408
    v_xor_b32 v242, 32, v238
    ds_read_b64_tr_b16 v[84:85], v242 offset:0
    ds_read_b64_tr_b16 v[86:87], v242 offset:1024
    ds_read_b64_tr_b16 v[88:89], v242 offset:16384
    ds_read_b64_tr_b16 v[90:91], v242 offset:17408
    s_waitcnt lgkmcnt(6)
    v_mfma_f32_16x16x32_bf16 v[108:111], v[76:79], v[60:63], v[108:111]
    v_mfma_f32_16x16x32_bf16 v[112:115], v[76:79], v[64:67], v[112:115]
    v_xor_b32 v243, 64, v238
    ds_read_b64_tr_b16 v[92:93], v243 offset:0
    ds_read_b64_tr_b16 v[94:95], v243 offset:1024
    s_waitcnt lgkmcnt(6)
    v_mfma_f32_16x16x32_bf16 v[164:167], v[80:83], v[60:63], v[164:167]
    v_mfma_f32_16x16x32_bf16 v[168:171], v[80:83], v[64:67], v[168:171]
    ds_read_b64_tr_b16 v[96:97], v243 offset:16384
    ds_read_b64_tr_b16 v[98:99], v243 offset:17408
    s_waitcnt lgkmcnt(6)
    v_mfma_f32_16x16x32_bf16 v[116:119], v[84:87], v[60:63], v[116:119]
    v_mfma_f32_16x16x32_bf16 v[120:123], v[84:87], v[64:67], v[120:123]
    v_xor_b32 v244, 96, v238
    ds_read_b64_tr_b16 v[100:101], v244 offset:0
    ds_read_b64_tr_b16 v[102:103], v244 offset:1024
    ds_read_b128 v[32:35], v233 offset:768
    ds_read_b128 v[36:39], v233 offset:784
    ds_read_b128 v[40:43], v233 offset:2816
    ds_read_b128 v[44:47], v233 offset:2832
    s_waitcnt vmcnt(8)
    s_waitcnt lgkmcnt(0)
    v_lshlrev_b32 v48, 16, v16
    v_mfma_f32_16x16x32_bf16 v[172:175], v[88:91], v[60:63], v[172:175]
    v_mfma_f32_16x16x32_bf16 v[176:179], v[88:91], v[64:67], v[176:179]
    ds_read_b64_tr_b16 v[104:105], v244 offset:16384
    ds_read_b64_tr_b16 v[106:107], v244 offset:17408
    v_and_b32 v49, 0xffff0000, v16
    v_lshlrev_b32 v50, 16, v17
    v_and_b32 v51, 0xffff0000, v17
    v_lshlrev_b32 v52, 16, v18
    v_and_b32 v53, 0xffff0000, v18
    v_lshlrev_b32 v54, 16, v19
    v_mfma_f32_16x16x32_bf16 v[124:127], v[92:95], v[60:63], v[124:127]
    v_mfma_f32_16x16x32_bf16 v[128:131], v[92:95], v[64:67], v[128:131]
    v_xor_b32 v245, 128, v238
    ds_read_b64_tr_b16 v[76:77], v245 offset:0
    ds_read_b64_tr_b16 v[78:79], v245 offset:1024
    v_and_b32 v55, 0xffff0000, v19
    v_fma_f32 v48, v48, v224, v228
    v_fma_f32 v49, v49, v224, v228
    v_fma_f32 v50, v50, v224, v228
    v_fma_f32 v51, v51, v224, v228
    v_fma_f32 v52, v52, v224, v228
    v_mfma_f32_16x16x32_bf16 v[180:183], v[96:99], v[60:63], v[180:183]
    v_mfma_f32_16x16x32_bf16 v[184:187], v[96:99], v[64:67], v[184:187]
    ds_read_b64_tr_b16 v[80:81], v245 offset:16384
    ds_read_b64_tr_b16 v[82:83], v245 offset:17408
    v_fma_f32 v53, v53, v224, v228
    v_fma_f32 v54, v54, v224, v228
    v_fma_f32 v55, v55, v224, v228
    v_fma_f32 v48, v48, v32, v40
    v_fma_f32 v49, v49, v33, v41
    v_fma_f32 v50, v50, v34, v42
    ds_read_b128 v[68:71], v239 offset:64
    ds_read_b128 v[72:75], v239 offset:2624
    v_mfma_f32_16x16x32_bf16 v[132:135], v[100:103], v[60:63], v[132:135]
    v_mfma_f32_16x16x32_bf16 v[136:139], v[100:103], v[64:67], v[136:139]
    v_xor_b32 v246, 160, v238
    ds_read_b64_tr_b16 v[84:85], v246 offset:0
    ds_read_b64_tr_b16 v[86:87], v246 offset:1024
    v_fma_f32 v51, v51, v35, v43
    v_fma_f32 v52, v52, v36, v44
    v_fma_f32 v53, v53, v37, v45
    v_fma_f32 v54, v54, v38, v46
    v_fma_f32 v55, v55, v39, v47
    v_cvt_pk_bf16_f32 v56, v48, v49
    s_waitcnt lgkmcnt(8)
    v_mfma_f32_16x16x32_bf16 v[188:191], v[104:107], v[60:63], v[188:191]
    v_mfma_f32_16x16x32_bf16 v[192:195], v[104:107], v[64:67], v[192:195]
    ds_read_b64_tr_b16 v[88:89], v246 offset:16384
    ds_read_b64_tr_b16 v[90:91], v246 offset:17408
    v_cvt_pk_bf16_f32 v57, v50, v51
    v_cvt_pk_bf16_f32 v58, v52, v53
    v_cvt_pk_bf16_f32 v59, v54, v55
    ds_write_b128 v232, v[56:59] offset:20480
    v_lshlrev_b32 v48, 16, v20
    v_and_b32 v49, 0xffff0000, v20
    s_waitcnt lgkmcnt(9)
    v_mfma_f32_16x16x32_bf16 v[140:143], v[76:79], v[60:63], v[140:143]
    v_mfma_f32_16x16x32_bf16 v[144:147], v[76:79], v[64:67], v[144:147]
    v_xor_b32 v247, 192, v238
    ds_read_b64_tr_b16 v[92:93], v247 offset:0
    ds_read_b64_tr_b16 v[94:95], v247 offset:1024
    v_lshlrev_b32 v50, 16, v21
    v_and_b32 v51, 0xffff0000, v21
    v_lshlrev_b32 v52, 16, v22
    v_and_b32 v53, 0xffff0000, v22
    v_lshlrev_b32 v54, 16, v23
    v_and_b32 v55, 0xffff0000, v23
    s_waitcnt lgkmcnt(9)
    v_mfma_f32_16x16x32_bf16 v[196:199], v[80:83], v[60:63], v[196:199]
    v_mfma_f32_16x16x32_bf16 v[200:203], v[80:83], v[64:67], v[200:203]
    ds_read_b64_tr_b16 v[96:97], v247 offset:16384
    ds_read_b64_tr_b16 v[98:99], v247 offset:17408
    v_fma_f32 v48, v48, v225, v229
    v_fma_f32 v49, v49, v225, v229
    v_fma_f32 v50, v50, v225, v229
    v_fma_f32 v51, v51, v225, v229
    v_fma_f32 v52, v52, v225, v229
    v_fma_f32 v53, v53, v225, v229
    s_waitcnt lgkmcnt(7)
    v_mfma_f32_16x16x32_bf16 v[148:151], v[84:87], v[60:63], v[148:151]
    v_mfma_f32_16x16x32_bf16 v[152:155], v[84:87], v[64:67], v[152:155]
    v_xor_b32 v241, 0, v238
    ds_read_b64_tr_b16 v[100:101], v241 offset:8192
    ds_read_b64_tr_b16 v[102:103], v241 offset:9216
    v_fma_f32 v54, v54, v225, v229
    v_fma_f32 v55, v55, v225, v229
    v_fma_f32 v48, v48, v32, v40
    v_fma_f32 v49, v49, v33, v41
    v_fma_f32 v50, v50, v34, v42
    v_fma_f32 v51, v51, v35, v43
    s_waitcnt lgkmcnt(7)
    v_mfma_f32_16x16x32_bf16 v[204:207], v[88:91], v[60:63], v[204:207]
    v_mfma_f32_16x16x32_bf16 v[208:211], v[88:91], v[64:67], v[208:211]
    ds_read_b64_tr_b16 v[104:105], v241 offset:24576
    ds_read_b64_tr_b16 v[106:107], v241 offset:25600
    v_fma_f32 v52, v52, v36, v44
    v_fma_f32 v53, v53, v37, v45
    v_fma_f32 v54, v54, v38, v46
    v_fma_f32 v55, v55, v39, v47
    v_cvt_pk_bf16_f32 v56, v48, v49
    v_cvt_pk_bf16_f32 v57, v50, v51
    s_waitcnt lgkmcnt(6)
    v_mfma_f32_16x16x32_bf16 v[156:159], v[92:95], v[60:63], v[156:159]
    v_mfma_f32_16x16x32_bf16 v[160:163], v[92:95], v[64:67], v[160:163]
    v_xor_b32 v242, 32, v238
    ds_read_b64_tr_b16 v[76:77], v242 offset:8192
    ds_read_b64_tr_b16 v[78:79], v242 offset:9216
    v_cvt_pk_bf16_f32 v58, v52, v53
    v_cvt_pk_bf16_f32 v59, v54, v55
    ds_write_b128 v232, v[56:59] offset:25600
    v_lshlrev_b32 v48, 16, v24
    v_and_b32 v49, 0xffff0000, v24
    v_lshlrev_b32 v50, 16, v25
    s_waitcnt lgkmcnt(7)
    v_mfma_f32_16x16x32_bf16 v[212:215], v[96:99], v[60:63], v[212:215]
    v_mfma_f32_16x16x32_bf16 v[216:219], v[96:99], v[64:67], v[216:219]
    ds_read_b64_tr_b16 v[80:81], v242 offset:24576
    ds_read_b64_tr_b16 v[82:83], v242 offset:25600
    v_and_b32 v51, 0xffff0000, v25
    v_lshlrev_b32 v52, 16, v26
    v_and_b32 v53, 0xffff0000, v26
    v_lshlrev_b32 v54, 16, v27
    v_and_b32 v55, 0xffff0000, v27
    v_fma_f32 v48, v48, v226, v230
    s_waitcnt lgkmcnt(7)
    v_mfma_f32_16x16x32_bf16 v[108:111], v[100:103], v[68:71], v[108:111]
    v_mfma_f32_16x16x32_bf16 v[112:115], v[100:103], v[72:75], v[112:115]
    v_xor_b32 v243, 64, v238
    ds_read_b64_tr_b16 v[84:85], v243 offset:8192
    ds_read_b64_tr_b16 v[86:87], v243 offset:9216
    v_fma_f32 v49, v49, v226, v230
    v_fma_f32 v50, v50, v226, v230
    v_fma_f32 v51, v51, v226, v230
    v_fma_f32 v52, v52, v226, v230
    v_fma_f32 v53, v53, v226, v230
    v_fma_f32 v54, v54, v226, v230
    s_waitcnt lgkmcnt(7)
    v_mfma_f32_16x16x32_bf16 v[164:167], v[104:107], v[68:71], v[164:167]
    v_mfma_f32_16x16x32_bf16 v[168:171], v[104:107], v[72:75], v[168:171]
    ds_read_b64_tr_b16 v[88:89], v243 offset:24576
    ds_read_b64_tr_b16 v[90:91], v243 offset:25600
    v_fma_f32 v55, v55, v226, v230
    v_fma_f32 v48, v48, v32, v40
    v_fma_f32 v49, v49, v33, v41
    v_fma_f32 v50, v50, v34, v42
    v_fma_f32 v51, v51, v35, v43
    v_fma_f32 v52, v52, v36, v44
    s_waitcnt lgkmcnt(7)
    v_mfma_f32_16x16x32_bf16 v[116:119], v[76:79], v[68:71], v[116:119]
    v_mfma_f32_16x16x32_bf16 v[120:123], v[76:79], v[72:75], v[120:123]
    v_xor_b32 v244, 96, v238
    ds_read_b64_tr_b16 v[92:93], v244 offset:8192
    ds_read_b64_tr_b16 v[94:95], v244 offset:9216
    v_fma_f32 v53, v53, v37, v45
    v_fma_f32 v54, v54, v38, v46
    v_fma_f32 v55, v55, v39, v47
    v_cvt_pk_bf16_f32 v56, v48, v49
    v_cvt_pk_bf16_f32 v57, v50, v51
    v_cvt_pk_bf16_f32 v58, v52, v53
    s_waitcnt lgkmcnt(6)
    v_mfma_f32_16x16x32_bf16 v[172:175], v[80:83], v[68:71], v[172:175]
    v_mfma_f32_16x16x32_bf16 v[176:179], v[80:83], v[72:75], v[176:179]
    ds_read_b64_tr_b16 v[96:97], v244 offset:24576
    ds_read_b64_tr_b16 v[98:99], v244 offset:25600
    v_cvt_pk_bf16_f32 v59, v54, v55
    ds_write_b128 v232, v[56:59] offset:30720
    v_lshlrev_b32 v48, 16, v28
    v_and_b32 v49, 0xffff0000, v28
    v_lshlrev_b32 v50, 16, v29
    v_and_b32 v51, 0xffff0000, v29
    s_waitcnt lgkmcnt(7)
    v_mfma_f32_16x16x32_bf16 v[124:127], v[84:87], v[68:71], v[124:127]
    v_mfma_f32_16x16x32_bf16 v[128:131], v[84:87], v[72:75], v[128:131]
    v_xor_b32 v245, 128, v238
    ds_read_b64_tr_b16 v[100:101], v245 offset:8192
    ds_read_b64_tr_b16 v[102:103], v245 offset:9216
    v_lshlrev_b32 v52, 16, v30
    v_and_b32 v53, 0xffff0000, v30
    v_lshlrev_b32 v54, 16, v31
    v_and_b32 v55, 0xffff0000, v31
    v_fma_f32 v48, v48, v227, v231
    v_fma_f32 v49, v49, v227, v231
    s_waitcnt lgkmcnt(7)
    v_mfma_f32_16x16x32_bf16 v[180:183], v[88:91], v[68:71], v[180:183]
    v_mfma_f32_16x16x32_bf16 v[184:187], v[88:91], v[72:75], v[184:187]
    ds_read_b64_tr_b16 v[104:105], v245 offset:24576
    ds_read_b64_tr_b16 v[106:107], v245 offset:25600
    v_fma_f32 v50, v50, v227, v231
    v_fma_f32 v51, v51, v227, v231
    v_fma_f32 v52, v52, v227, v231
    v_fma_f32 v53, v53, v227, v231
    v_fma_f32 v54, v54, v227, v231
    v_fma_f32 v55, v55, v227, v231
    s_waitcnt lgkmcnt(7)
    v_mfma_f32_16x16x32_bf16 v[132:135], v[92:95], v[68:71], v[132:135]
    v_mfma_f32_16x16x32_bf16 v[136:139], v[92:95], v[72:75], v[136:139]
    v_xor_b32 v246, 160, v238
    ds_read_b64_tr_b16 v[76:77], v246 offset:8192
    ds_read_b64_tr_b16 v[78:79], v246 offset:9216
    v_fma_f32 v48, v48, v32, v40
    v_fma_f32 v49, v49, v33, v41
    v_fma_f32 v50, v50, v34, v42
    v_fma_f32 v51, v51, v35, v43
    v_fma_f32 v52, v52, v36, v44
    v_fma_f32 v53, v53, v37, v45
    s_waitcnt lgkmcnt(7)
    v_mfma_f32_16x16x32_bf16 v[188:191], v[96:99], v[68:71], v[188:191]
    v_mfma_f32_16x16x32_bf16 v[192:195], v[96:99], v[72:75], v[192:195]
    ds_read_b64_tr_b16 v[80:81], v246 offset:24576
    ds_read_b64_tr_b16 v[82:83], v246 offset:25600
    v_fma_f32 v54, v54, v38, v46
    v_fma_f32 v55, v55, v39, v47
    v_cvt_pk_bf16_f32 v56, v48, v49
    v_cvt_pk_bf16_f32 v57, v50, v51
    v_cvt_pk_bf16_f32 v58, v52, v53
    v_cvt_pk_bf16_f32 v59, v54, v55
    s_waitcnt lgkmcnt(6)
    v_mfma_f32_16x16x32_bf16 v[140:143], v[100:103], v[68:71], v[140:143]
    v_mfma_f32_16x16x32_bf16 v[144:147], v[100:103], v[72:75], v[144:147]
    v_xor_b32 v247, 192, v238
    ds_read_b64_tr_b16 v[84:85], v247 offset:8192
    ds_read_b64_tr_b16 v[86:87], v247 offset:9216
    ds_write_b128 v232, v[56:59] offset:35840
    s_waitcnt lgkmcnt(7)
    v_mfma_f32_16x16x32_bf16 v[196:199], v[104:107], v[68:71], v[196:199]
    v_mfma_f32_16x16x32_bf16 v[200:203], v[104:107], v[72:75], v[200:203]
    ds_read_b64_tr_b16 v[88:89], v247 offset:24576
    ds_read_b64_tr_b16 v[90:91], v247 offset:25600
    s_waitcnt lgkmcnt(7)
    v_mfma_f32_16x16x32_bf16 v[148:151], v[76:79], v[68:71], v[148:151]
    v_mfma_f32_16x16x32_bf16 v[152:155], v[76:79], v[72:75], v[152:155]
    s_waitcnt lgkmcnt(5)
    v_mfma_f32_16x16x32_bf16 v[204:207], v[80:83], v[68:71], v[204:207]
    v_mfma_f32_16x16x32_bf16 v[208:211], v[80:83], v[72:75], v[208:211]
    s_waitcnt lgkmcnt(3)
    v_mfma_f32_16x16x32_bf16 v[156:159], v[84:87], v[68:71], v[156:159]
    v_mfma_f32_16x16x32_bf16 v[160:163], v[84:87], v[72:75], v[160:163]
    s_waitcnt lgkmcnt(0)
    v_mfma_f32_16x16x32_bf16 v[212:215], v[88:91], v[68:71], v[212:215]
    v_mfma_f32_16x16x32_bf16 v[216:219], v[88:91], v[72:75], v[216:219]
    buffer_load_dwordx4 v[16:19], v220, s[12:15], 0 offen offset:512
    buffer_load_dwordx4 v[20:23], v221, s[12:15], 0 offen offset:512
    buffer_load_dwordx4 v[24:27], v222, s[12:15], 0 offen offset:512
    buffer_load_dwordx4 v[28:31], v223, s[12:15], 0 offen offset:512
    s_waitcnt lgkmcnt(0)
    s_barrier
    s_add_u32 s49, s56, 1146880
    s_add_u32 m0, s64, 110592
    s_nop 0
    buffer_load_dwordx4 v234, s[16:19], s49 offen lds
    s_add_u32 s49, s57, 1146880
    s_add_u32 m0, s65, 110592
    s_nop 0
    buffer_load_dwordx4 v234, s[16:19], s49 offen lds
    s_add_u32 s49, s58, 1146880
    s_add_u32 m0, s66, 110592
    s_nop 0
    buffer_load_dwordx4 v235, s[16:19], s49 offen lds
    s_add_u32 s49, s59, 1146880
    s_add_u32 m0, s67, 110592
    s_nop 0
    buffer_load_dwordx4 v235, s[16:19], s49 offen lds
    s_add_u32 s49, s60, 1146880
    s_add_u32 m0, s68, 110592
    s_nop 0
    buffer_load_dwordx4 v234, s[16:19], s49 offen lds
    s_add_u32 s49, s61, 1146880
    s_add_u32 m0, s69, 110592
    s_nop 0
    buffer_load_dwordx4 v234, s[16:19], s49 offen lds
    s_add_u32 s49, s62, 1146880
    s_add_u32 m0, s70, 110592
    s_nop 0
    buffer_load_dwordx4 v235, s[16:19], s49 offen lds
    s_add_u32 s49, s63, 1146880
    s_add_u32 m0, s71, 110592
    s_nop 0
    buffer_load_dwordx4 v235, s[16:19], s49 offen lds
    ds_read_b128 v[60:63], v239 offset:20480
    ds_read_b128 v[64:67], v239 offset:23040
    v_xor_b32 v241, 0, v236
    ds_read_b64_tr_b16 v[76:77], v241 offset:0
    ds_read_b64_tr_b16 v[78:79], v241 offset:1024
    ds_read_b64_tr_b16 v[80:81], v241 offset:16384
    ds_read_b64_tr_b16 v[82:83], v241 offset:17408
    v_xor_b32 v242, 32, v236
    ds_read_b64_tr_b16 v[84:85], v242 offset:0
    ds_read_b64_tr_b16 v[86:87], v242 offset:1024
    ds_read_b64_tr_b16 v[88:89], v242 offset:16384
    ds_read_b64_tr_b16 v[90:91], v242 offset:17408
    s_waitcnt lgkmcnt(6)
    v_mfma_f32_16x16x32_bf16 v[108:111], v[76:79], v[60:63], v[108:111]
    v_mfma_f32_16x16x32_bf16 v[112:115], v[76:79], v[64:67], v[112:115]
    v_xor_b32 v243, 64, v236
    ds_read_b64_tr_b16 v[92:93], v243 offset:0
    ds_read_b64_tr_b16 v[94:95], v243 offset:1024
    s_waitcnt lgkmcnt(6)
    v_mfma_f32_16x16x32_bf16 v[164:167], v[80:83], v[60:63], v[164:167]
    v_mfma_f32_16x16x32_bf16 v[168:171], v[80:83], v[64:67], v[168:171]
    ds_read_b64_tr_b16 v[96:97], v243 offset:16384
    ds_read_b64_tr_b16 v[98:99], v243 offset:17408
    s_waitcnt lgkmcnt(6)
    v_mfma_f32_16x16x32_bf16 v[116:119], v[84:87], v[60:63], v[116:119]
    v_mfma_f32_16x16x32_bf16 v[120:123], v[84:87], v[64:67], v[120:123]
    v_xor_b32 v244, 96, v236
    ds_read_b64_tr_b16 v[100:101], v244 offset:0
    ds_read_b64_tr_b16 v[102:103], v244 offset:1024
    ds_read_b128 v[32:35], v233 offset:1024
    ds_read_b128 v[36:39], v233 offset:1040
    ds_read_b128 v[40:43], v233 offset:3072
    ds_read_b128 v[44:47], v233 offset:3088
    s_waitcnt vmcnt(8)
    s_waitcnt lgkmcnt(0)
    v_lshlrev_b32 v48, 16, v16
    v_mfma_f32_16x16x32_bf16 v[172:175], v[88:91], v[60:63], v[172:175]
    v_mfma_f32_16x16x32_bf16 v[176:179], v[88:91], v[64:67], v[176:179]
    ds_read_b64_tr_b16 v[104:105], v244 offset:16384
    ds_read_b64_tr_b16 v[106:107], v244 offset:17408
    v_and_b32 v49, 0xffff0000, v16
    v_lshlrev_b32 v50, 16, v17
    v_and_b32 v51, 0xffff0000, v17
    v_lshlrev_b32 v52, 16, v18
    v_and_b32 v53, 0xffff0000, v18
    v_lshlrev_b32 v54, 16, v19
    v_mfma_f32_16x16x32_bf16 v[124:127], v[92:95], v[60:63], v[124:127]
    v_mfma_f32_16x16x32_bf16 v[128:131], v[92:95], v[64:67], v[128:131]
    v_xor_b32 v245, 128, v236
    ds_read_b64_tr_b16 v[76:77], v245 offset:0
    ds_read_b64_tr_b16 v[78:79], v245 offset:1024
    v_and_b32 v55, 0xffff0000, v19
    v_fma_f32 v48, v48, v224, v228
    v_fma_f32 v49, v49, v224, v228
    v_fma_f32 v50, v50, v224, v228
    v_fma_f32 v51, v51, v224, v228
    v_fma_f32 v52, v52, v224, v228
    v_mfma_f32_16x16x32_bf16 v[180:183], v[96:99], v[60:63], v[180:183]
    v_mfma_f32_16x16x32_bf16 v[184:187], v[96:99], v[64:67], v[184:187]
    ds_read_b64_tr_b16 v[80:81], v245 offset:16384
    ds_read_b64_tr_b16 v[82:83], v245 offset:17408
    v_fma_f32 v53, v53, v224, v228
    v_fma_f32 v54, v54, v224, v228
    v_fma_f32 v55, v55, v224, v228
    v_fma_f32 v48, v48, v32, v40
    v_fma_f32 v49, v49, v33, v41
    v_fma_f32 v50, v50, v34, v42
    ds_read_b128 v[68:71], v239 offset:20544
    ds_read_b128 v[72:75], v239 offset:23104
    v_mfma_f32_16x16x32_bf16 v[132:135], v[100:103], v[60:63], v[132:135]
    v_mfma_f32_16x16x32_bf16 v[136:139], v[100:103], v[64:67], v[136:139]
    v_xor_b32 v246, 160, v236
    ds_read_b64_tr_b16 v[84:85], v246 offset:0
    ds_read_b64_tr_b16 v[86:87], v246 offset:1024
    v_fma_f32 v51, v51, v35, v43
    v_fma_f32 v52, v52, v36, v44
    v_fma_f32 v53, v53, v37, v45
    v_fma_f32 v54, v54, v38, v46
    v_fma_f32 v55, v55, v39, v47
    v_cvt_pk_bf16_f32 v56, v48, v49
    s_waitcnt lgkmcnt(8)
    v_mfma_f32_16x16x32_bf16 v[188:191], v[104:107], v[60:63], v[188:191]
    v_mfma_f32_16x16x32_bf16 v[192:195], v[104:107], v[64:67], v[192:195]
    ds_read_b64_tr_b16 v[88:89], v246 offset:16384
    ds_read_b64_tr_b16 v[90:91], v246 offset:17408
    v_cvt_pk_bf16_f32 v57, v50, v51
    v_cvt_pk_bf16_f32 v58, v52, v53
    v_cvt_pk_bf16_f32 v59, v54, v55
    ds_write_b128 v232, v[56:59] offset:0
    v_lshlrev_b32 v48, 16, v20
    v_and_b32 v49, 0xffff0000, v20
    s_waitcnt lgkmcnt(9)
    v_mfma_f32_16x16x32_bf16 v[140:143], v[76:79], v[60:63], v[140:143]
    v_mfma_f32_16x16x32_bf16 v[144:147], v[76:79], v[64:67], v[144:147]
    v_xor_b32 v247, 192, v236
    ds_read_b64_tr_b16 v[92:93], v247 offset:0
    ds_read_b64_tr_b16 v[94:95], v247 offset:1024
    v_lshlrev_b32 v50, 16, v21
    v_and_b32 v51, 0xffff0000, v21
    v_lshlrev_b32 v52, 16, v22
    v_and_b32 v53, 0xffff0000, v22
    v_lshlrev_b32 v54, 16, v23
    v_and_b32 v55, 0xffff0000, v23
    s_waitcnt lgkmcnt(9)
    v_mfma_f32_16x16x32_bf16 v[196:199], v[80:83], v[60:63], v[196:199]
    v_mfma_f32_16x16x32_bf16 v[200:203], v[80:83], v[64:67], v[200:203]
    ds_read_b64_tr_b16 v[96:97], v247 offset:16384
    ds_read_b64_tr_b16 v[98:99], v247 offset:17408
    v_fma_f32 v48, v48, v225, v229
    v_fma_f32 v49, v49, v225, v229
    v_fma_f32 v50, v50, v225, v229
    v_fma_f32 v51, v51, v225, v229
    v_fma_f32 v52, v52, v225, v229
    v_fma_f32 v53, v53, v225, v229
    s_waitcnt lgkmcnt(7)
    v_mfma_f32_16x16x32_bf16 v[148:151], v[84:87], v[60:63], v[148:151]
    v_mfma_f32_16x16x32_bf16 v[152:155], v[84:87], v[64:67], v[152:155]
    v_xor_b32 v241, 0, v236
    ds_read_b64_tr_b16 v[100:101], v241 offset:8192
    ds_read_b64_tr_b16 v[102:103], v241 offset:9216
    v_fma_f32 v54, v54, v225, v229
    v_fma_f32 v55, v55, v225, v229
    v_fma_f32 v48, v48, v32, v40
    v_fma_f32 v49, v49, v33, v41
    v_fma_f32 v50, v50, v34, v42
    v_fma_f32 v51, v51, v35, v43
    s_waitcnt lgkmcnt(7)
    v_mfma_f32_16x16x32_bf16 v[204:207], v[88:91], v[60:63], v[204:207]
    v_mfma_f32_16x16x32_bf16 v[208:211], v[88:91], v[64:67], v[208:211]
    ds_read_b64_tr_b16 v[104:105], v241 offset:24576
    ds_read_b64_tr_b16 v[106:107], v241 offset:25600
    v_fma_f32 v52, v52, v36, v44
    v_fma_f32 v53, v53, v37, v45
    v_fma_f32 v54, v54, v38, v46
    v_fma_f32 v55, v55, v39, v47
    v_cvt_pk_bf16_f32 v56, v48, v49
    v_cvt_pk_bf16_f32 v57, v50, v51
    s_waitcnt lgkmcnt(6)
    v_mfma_f32_16x16x32_bf16 v[156:159], v[92:95], v[60:63], v[156:159]
    v_mfma_f32_16x16x32_bf16 v[160:163], v[92:95], v[64:67], v[160:163]
    v_xor_b32 v242, 32, v236
    ds_read_b64_tr_b16 v[76:77], v242 offset:8192
    ds_read_b64_tr_b16 v[78:79], v242 offset:9216
    v_cvt_pk_bf16_f32 v58, v52, v53
    v_cvt_pk_bf16_f32 v59, v54, v55
    ds_write_b128 v232, v[56:59] offset:5120
    v_lshlrev_b32 v48, 16, v24
    v_and_b32 v49, 0xffff0000, v24
    v_lshlrev_b32 v50, 16, v25
    s_waitcnt lgkmcnt(7)
    v_mfma_f32_16x16x32_bf16 v[212:215], v[96:99], v[60:63], v[212:215]
    v_mfma_f32_16x16x32_bf16 v[216:219], v[96:99], v[64:67], v[216:219]
    ds_read_b64_tr_b16 v[80:81], v242 offset:24576
    ds_read_b64_tr_b16 v[82:83], v242 offset:25600
    v_and_b32 v51, 0xffff0000, v25
    v_lshlrev_b32 v52, 16, v26
    v_and_b32 v53, 0xffff0000, v26
    v_lshlrev_b32 v54, 16, v27
    v_and_b32 v55, 0xffff0000, v27
    v_fma_f32 v48, v48, v226, v230
    s_waitcnt lgkmcnt(7)
    v_mfma_f32_16x16x32_bf16 v[108:111], v[100:103], v[68:71], v[108:111]
    v_mfma_f32_16x16x32_bf16 v[112:115], v[100:103], v[72:75], v[112:115]
    v_xor_b32 v243, 64, v236
    ds_read_b64_tr_b16 v[84:85], v243 offset:8192
    ds_read_b64_tr_b16 v[86:87], v243 offset:9216
    v_fma_f32 v49, v49, v226, v230
    v_fma_f32 v50, v50, v226, v230
    v_fma_f32 v51, v51, v226, v230
    v_fma_f32 v52, v52, v226, v230
    v_fma_f32 v53, v53, v226, v230
    v_fma_f32 v54, v54, v226, v230
    s_waitcnt lgkmcnt(7)
    v_mfma_f32_16x16x32_bf16 v[164:167], v[104:107], v[68:71], v[164:167]
    v_mfma_f32_16x16x32_bf16 v[168:171], v[104:107], v[72:75], v[168:171]
    ds_read_b64_tr_b16 v[88:89], v243 offset:24576
    ds_read_b64_tr_b16 v[90:91], v243 offset:25600
    v_fma_f32 v55, v55, v226, v230
    v_fma_f32 v48, v48, v32, v40
    v_fma_f32 v49, v49, v33, v41
    v_fma_f32 v50, v50, v34, v42
    v_fma_f32 v51, v51, v35, v43
    v_fma_f32 v52, v52, v36, v44
    s_waitcnt lgkmcnt(7)
    v_mfma_f32_16x16x32_bf16 v[116:119], v[76:79], v[68:71], v[116:119]
    v_mfma_f32_16x16x32_bf16 v[120:123], v[76:79], v[72:75], v[120:123]
    v_xor_b32 v244, 96, v236
    ds_read_b64_tr_b16 v[92:93], v244 offset:8192
    ds_read_b64_tr_b16 v[94:95], v244 offset:9216
    v_fma_f32 v53, v53, v37, v45
    v_fma_f32 v54, v54, v38, v46
    v_fma_f32 v55, v55, v39, v47
    v_cvt_pk_bf16_f32 v56, v48, v49
    v_cvt_pk_bf16_f32 v57, v50, v51
    v_cvt_pk_bf16_f32 v58, v52, v53
    s_waitcnt lgkmcnt(6)
    v_mfma_f32_16x16x32_bf16 v[172:175], v[80:83], v[68:71], v[172:175]
    v_mfma_f32_16x16x32_bf16 v[176:179], v[80:83], v[72:75], v[176:179]
    ds_read_b64_tr_b16 v[96:97], v244 offset:24576
    ds_read_b64_tr_b16 v[98:99], v244 offset:25600
    v_cvt_pk_bf16_f32 v59, v54, v55
    ds_write_b128 v232, v[56:59] offset:10240
    v_lshlrev_b32 v48, 16, v28
    v_and_b32 v49, 0xffff0000, v28
    v_lshlrev_b32 v50, 16, v29
    v_and_b32 v51, 0xffff0000, v29
    s_waitcnt lgkmcnt(7)
    v_mfma_f32_16x16x32_bf16 v[124:127], v[84:87], v[68:71], v[124:127]
    v_mfma_f32_16x16x32_bf16 v[128:131], v[84:87], v[72:75], v[128:131]
    v_xor_b32 v245, 128, v236
    ds_read_b64_tr_b16 v[100:101], v245 offset:8192
    ds_read_b64_tr_b16 v[102:103], v245 offset:9216
    v_lshlrev_b32 v52, 16, v30
    v_and_b32 v53, 0xffff0000, v30
    v_lshlrev_b32 v54, 16, v31
    v_and_b32 v55, 0xffff0000, v31
    v_fma_f32 v48, v48, v227, v231
    v_fma_f32 v49, v49, v227, v231
    s_waitcnt lgkmcnt(7)
    v_mfma_f32_16x16x32_bf16 v[180:183], v[88:91], v[68:71], v[180:183]
    v_mfma_f32_16x16x32_bf16 v[184:187], v[88:91], v[72:75], v[184:187]
    ds_read_b64_tr_b16 v[104:105], v245 offset:24576
    ds_read_b64_tr_b16 v[106:107], v245 offset:25600
    v_fma_f32 v50, v50, v227, v231
    v_fma_f32 v51, v51, v227, v231
    v_fma_f32 v52, v52, v227, v231
    v_fma_f32 v53, v53, v227, v231
    v_fma_f32 v54, v54, v227, v231
    v_fma_f32 v55, v55, v227, v231
    s_waitcnt lgkmcnt(7)
    v_mfma_f32_16x16x32_bf16 v[132:135], v[92:95], v[68:71], v[132:135]
    v_mfma_f32_16x16x32_bf16 v[136:139], v[92:95], v[72:75], v[136:139]
    v_xor_b32 v246, 160, v236
    ds_read_b64_tr_b16 v[76:77], v246 offset:8192
    ds_read_b64_tr_b16 v[78:79], v246 offset:9216
    v_fma_f32 v48, v48, v32, v40
    v_fma_f32 v49, v49, v33, v41
    v_fma_f32 v50, v50, v34, v42
    v_fma_f32 v51, v51, v35, v43
    v_fma_f32 v52, v52, v36, v44
    v_fma_f32 v53, v53, v37, v45
    s_waitcnt lgkmcnt(7)
    v_mfma_f32_16x16x32_bf16 v[188:191], v[96:99], v[68:71], v[188:191]
    v_mfma_f32_16x16x32_bf16 v[192:195], v[96:99], v[72:75], v[192:195]
    ds_read_b64_tr_b16 v[80:81], v246 offset:24576
    ds_read_b64_tr_b16 v[82:83], v246 offset:25600
    v_fma_f32 v54, v54, v38, v46
    v_fma_f32 v55, v55, v39, v47
    v_cvt_pk_bf16_f32 v56, v48, v49
    v_cvt_pk_bf16_f32 v57, v50, v51
    v_cvt_pk_bf16_f32 v58, v52, v53
    v_cvt_pk_bf16_f32 v59, v54, v55
    s_waitcnt lgkmcnt(6)
    v_mfma_f32_16x16x32_bf16 v[140:143], v[100:103], v[68:71], v[140:143]
    v_mfma_f32_16x16x32_bf16 v[144:147], v[100:103], v[72:75], v[144:147]
    v_xor_b32 v247, 192, v236
    ds_read_b64_tr_b16 v[84:85], v247 offset:8192
    ds_read_b64_tr_b16 v[86:87], v247 offset:9216
    ds_write_b128 v232, v[56:59] offset:15360
    s_waitcnt lgkmcnt(7)
    v_mfma_f32_16x16x32_bf16 v[196:199], v[104:107], v[68:71], v[196:199]
    v_mfma_f32_16x16x32_bf16 v[200:203], v[104:107], v[72:75], v[200:203]
    ds_read_b64_tr_b16 v[88:89], v247 offset:24576
    ds_read_b64_tr_b16 v[90:91], v247 offset:25600
    s_waitcnt lgkmcnt(7)
    v_mfma_f32_16x16x32_bf16 v[148:151], v[76:79], v[68:71], v[148:151]
    v_mfma_f32_16x16x32_bf16 v[152:155], v[76:79], v[72:75], v[152:155]
    s_waitcnt lgkmcnt(5)
    v_mfma_f32_16x16x32_bf16 v[204:207], v[80:83], v[68:71], v[204:207]
    v_mfma_f32_16x16x32_bf16 v[208:211], v[80:83], v[72:75], v[208:211]
    s_waitcnt lgkmcnt(3)
    v_mfma_f32_16x16x32_bf16 v[156:159], v[84:87], v[68:71], v[156:159]
    v_mfma_f32_16x16x32_bf16 v[160:163], v[84:87], v[72:75], v[160:163]
    s_waitcnt lgkmcnt(0)
    v_mfma_f32_16x16x32_bf16 v[212:215], v[88:91], v[68:71], v[212:215]
    v_mfma_f32_16x16x32_bf16 v[216:219], v[88:91], v[72:75], v[216:219]
    buffer_load_dwordx4 v[16:19], v220, s[12:15], 0 offen offset:640
    buffer_load_dwordx4 v[20:23], v221, s[12:15], 0 offen offset:640
    buffer_load_dwordx4 v[24:27], v222, s[12:15], 0 offen offset:640
    buffer_load_dwordx4 v[28:31], v223, s[12:15], 0 offen offset:640
    s_waitcnt lgkmcnt(0)
    s_barrier
    s_add_u32 s49, s56, 1376256
    s_add_u32 m0, s64, 45056
    s_nop 0
    buffer_load_dwordx4 v234, s[16:19], s49 offen lds
    s_add_u32 s49, s57, 1376256
    s_add_u32 m0, s65, 45056
    s_nop 0
    buffer_load_dwordx4 v234, s[16:19], s49 offen lds
    s_add_u32 s49, s58, 1376256
    s_add_u32 m0, s66, 45056
    s_nop 0
    buffer_load_dwordx4 v235, s[16:19], s49 offen lds
    s_add_u32 s49, s59, 1376256
    s_add_u32 m0, s67, 45056
    s_nop 0
    buffer_load_dwordx4 v235, s[16:19], s49 offen lds
    s_add_u32 s49, s60, 1376256
    s_add_u32 m0, s68, 45056
    s_nop 0
    buffer_load_dwordx4 v234, s[16:19], s49 offen lds
    s_add_u32 s49, s61, 1376256
    s_add_u32 m0, s69, 45056
    s_nop 0
    buffer_load_dwordx4 v234, s[16:19], s49 offen lds
    s_add_u32 s49, s62, 1376256
    s_add_u32 m0, s70, 45056
    s_nop 0
    buffer_load_dwordx4 v235, s[16:19], s49 offen lds
    s_add_u32 s49, s63, 1376256
    s_add_u32 m0, s71, 45056
    s_nop 0
    buffer_load_dwordx4 v235, s[16:19], s49 offen lds
    ds_read_b128 v[60:63], v239 offset:0
    ds_read_b128 v[64:67], v239 offset:2560
    v_xor_b32 v241, 0, v237
    ds_read_b64_tr_b16 v[76:77], v241 offset:0
    ds_read_b64_tr_b16 v[78:79], v241 offset:1024
    ds_read_b64_tr_b16 v[80:81], v241 offset:16384
    ds_read_b64_tr_b16 v[82:83], v241 offset:17408
    v_xor_b32 v242, 32, v237
    ds_read_b64_tr_b16 v[84:85], v242 offset:0
    ds_read_b64_tr_b16 v[86:87], v242 offset:1024
    ds_read_b64_tr_b16 v[88:89], v242 offset:16384
    ds_read_b64_tr_b16 v[90:91], v242 offset:17408
    s_waitcnt lgkmcnt(6)
    v_mfma_f32_16x16x32_bf16 v[108:111], v[76:79], v[60:63], v[108:111]
    v_mfma_f32_16x16x32_bf16 v[112:115], v[76:79], v[64:67], v[112:115]
    v_xor_b32 v243, 64, v237
    ds_read_b64_tr_b16 v[92:93], v243 offset:0
    ds_read_b64_tr_b16 v[94:95], v243 offset:1024
    s_waitcnt lgkmcnt(6)
    v_mfma_f32_16x16x32_bf16 v[164:167], v[80:83], v[60:63], v[164:167]
    v_mfma_f32_16x16x32_bf16 v[168:171], v[80:83], v[64:67], v[168:171]
    ds_read_b64_tr_b16 v[96:97], v243 offset:16384
    ds_read_b64_tr_b16 v[98:99], v243 offset:17408
    s_waitcnt lgkmcnt(6)
    v_mfma_f32_16x16x32_bf16 v[116:119], v[84:87], v[60:63], v[116:119]
    v_mfma_f32_16x16x32_bf16 v[120:123], v[84:87], v[64:67], v[120:123]
    v_xor_b32 v244, 96, v237
    ds_read_b64_tr_b16 v[100:101], v244 offset:0
    ds_read_b64_tr_b16 v[102:103], v244 offset:1024
    ds_read_b128 v[32:35], v233 offset:1280
    ds_read_b128 v[36:39], v233 offset:1296
    ds_read_b128 v[40:43], v233 offset:3328
    ds_read_b128 v[44:47], v233 offset:3344
    s_waitcnt vmcnt(8)
    s_waitcnt lgkmcnt(0)
    v_lshlrev_b32 v48, 16, v16
    v_mfma_f32_16x16x32_bf16 v[172:175], v[88:91], v[60:63], v[172:175]
    v_mfma_f32_16x16x32_bf16 v[176:179], v[88:91], v[64:67], v[176:179]
    ds_read_b64_tr_b16 v[104:105], v244 offset:16384
    ds_read_b64_tr_b16 v[106:107], v244 offset:17408
    v_and_b32 v49, 0xffff0000, v16
    v_lshlrev_b32 v50, 16, v17
    v_and_b32 v51, 0xffff0000, v17
    v_lshlrev_b32 v52, 16, v18
    v_and_b32 v53, 0xffff0000, v18
    v_lshlrev_b32 v54, 16, v19
    v_mfma_f32_16x16x32_bf16 v[124:127], v[92:95], v[60:63], v[124:127]
    v_mfma_f32_16x16x32_bf16 v[128:131], v[92:95], v[64:67], v[128:131]
    v_xor_b32 v245, 128, v237
    ds_read_b64_tr_b16 v[76:77], v245 offset:0
    ds_read_b64_tr_b16 v[78:79], v245 offset:1024
    v_and_b32 v55, 0xffff0000, v19
    v_fma_f32 v48, v48, v224, v228
    v_fma_f32 v49, v49, v224, v228
    v_fma_f32 v50, v50, v224, v228
    v_fma_f32 v51, v51, v224, v228
    v_fma_f32 v52, v52, v224, v228
    v_mfma_f32_16x16x32_bf16 v[180:183], v[96:99], v[60:63], v[180:183]
    v_mfma_f32_16x16x32_bf16 v[184:187], v[96:99], v[64:67], v[184:187]
    ds_read_b64_tr_b16 v[80:81], v245 offset:16384
    ds_read_b64_tr_b16 v[82:83], v245 offset:17408
    v_fma_f32 v53, v53, v224, v228
    v_fma_f32 v54, v54, v224, v228
    v_fma_f32 v55, v55, v224, v228
    v_fma_f32 v48, v48, v32, v40
    v_fma_f32 v49, v49, v33, v41
    v_fma_f32 v50, v50, v34, v42
    ds_read_b128 v[68:71], v239 offset:64
    ds_read_b128 v[72:75], v239 offset:2624
    v_mfma_f32_16x16x32_bf16 v[132:135], v[100:103], v[60:63], v[132:135]
    v_mfma_f32_16x16x32_bf16 v[136:139], v[100:103], v[64:67], v[136:139]
    v_xor_b32 v246, 160, v237
    ds_read_b64_tr_b16 v[84:85], v246 offset:0
    ds_read_b64_tr_b16 v[86:87], v246 offset:1024
    v_fma_f32 v51, v51, v35, v43
    v_fma_f32 v52, v52, v36, v44
    v_fma_f32 v53, v53, v37, v45
    v_fma_f32 v54, v54, v38, v46
    v_fma_f32 v55, v55, v39, v47
    v_cvt_pk_bf16_f32 v56, v48, v49
    s_waitcnt lgkmcnt(8)
    v_mfma_f32_16x16x32_bf16 v[188:191], v[104:107], v[60:63], v[188:191]
    v_mfma_f32_16x16x32_bf16 v[192:195], v[104:107], v[64:67], v[192:195]
    ds_read_b64_tr_b16 v[88:89], v246 offset:16384
    ds_read_b64_tr_b16 v[90:91], v246 offset:17408
    v_cvt_pk_bf16_f32 v57, v50, v51
    v_cvt_pk_bf16_f32 v58, v52, v53
    v_cvt_pk_bf16_f32 v59, v54, v55
    ds_write_b128 v232, v[56:59] offset:20480
    v_lshlrev_b32 v48, 16, v20
    v_and_b32 v49, 0xffff0000, v20
    s_waitcnt lgkmcnt(9)
    v_mfma_f32_16x16x32_bf16 v[140:143], v[76:79], v[60:63], v[140:143]
    v_mfma_f32_16x16x32_bf16 v[144:147], v[76:79], v[64:67], v[144:147]
    v_xor_b32 v247, 192, v237
    ds_read_b64_tr_b16 v[92:93], v247 offset:0
    ds_read_b64_tr_b16 v[94:95], v247 offset:1024
    v_lshlrev_b32 v50, 16, v21
    v_and_b32 v51, 0xffff0000, v21
    v_lshlrev_b32 v52, 16, v22
    v_and_b32 v53, 0xffff0000, v22
    v_lshlrev_b32 v54, 16, v23
    v_and_b32 v55, 0xffff0000, v23
    s_waitcnt lgkmcnt(9)
    v_mfma_f32_16x16x32_bf16 v[196:199], v[80:83], v[60:63], v[196:199]
    v_mfma_f32_16x16x32_bf16 v[200:203], v[80:83], v[64:67], v[200:203]
    ds_read_b64_tr_b16 v[96:97], v247 offset:16384
    ds_read_b64_tr_b16 v[98:99], v247 offset:17408
    v_fma_f32 v48, v48, v225, v229
    v_fma_f32 v49, v49, v225, v229
    v_fma_f32 v50, v50, v225, v229
    v_fma_f32 v51, v51, v225, v229
    v_fma_f32 v52, v52, v225, v229
    v_fma_f32 v53, v53, v225, v229
    s_waitcnt lgkmcnt(7)
    v_mfma_f32_16x16x32_bf16 v[148:151], v[84:87], v[60:63], v[148:151]
    v_mfma_f32_16x16x32_bf16 v[152:155], v[84:87], v[64:67], v[152:155]
    v_xor_b32 v241, 0, v237
    ds_read_b64_tr_b16 v[100:101], v241 offset:8192
    ds_read_b64_tr_b16 v[102:103], v241 offset:9216
    v_fma_f32 v54, v54, v225, v229
    v_fma_f32 v55, v55, v225, v229
    v_fma_f32 v48, v48, v32, v40
    v_fma_f32 v49, v49, v33, v41
    v_fma_f32 v50, v50, v34, v42
    v_fma_f32 v51, v51, v35, v43
    s_waitcnt lgkmcnt(7)
    v_mfma_f32_16x16x32_bf16 v[204:207], v[88:91], v[60:63], v[204:207]
    v_mfma_f32_16x16x32_bf16 v[208:211], v[88:91], v[64:67], v[208:211]
    ds_read_b64_tr_b16 v[104:105], v241 offset:24576
    ds_read_b64_tr_b16 v[106:107], v241 offset:25600
    v_fma_f32 v52, v52, v36, v44
    v_fma_f32 v53, v53, v37, v45
    v_fma_f32 v54, v54, v38, v46
    v_fma_f32 v55, v55, v39, v47
    v_cvt_pk_bf16_f32 v56, v48, v49
    v_cvt_pk_bf16_f32 v57, v50, v51
    s_waitcnt lgkmcnt(6)
    v_mfma_f32_16x16x32_bf16 v[156:159], v[92:95], v[60:63], v[156:159]
    v_mfma_f32_16x16x32_bf16 v[160:163], v[92:95], v[64:67], v[160:163]
    v_xor_b32 v242, 32, v237
    ds_read_b64_tr_b16 v[76:77], v242 offset:8192
    ds_read_b64_tr_b16 v[78:79], v242 offset:9216
    v_cvt_pk_bf16_f32 v58, v52, v53
    v_cvt_pk_bf16_f32 v59, v54, v55
    ds_write_b128 v232, v[56:59] offset:25600
    v_lshlrev_b32 v48, 16, v24
    v_and_b32 v49, 0xffff0000, v24
    v_lshlrev_b32 v50, 16, v25
    s_waitcnt lgkmcnt(7)
    v_mfma_f32_16x16x32_bf16 v[212:215], v[96:99], v[60:63], v[212:215]
    v_mfma_f32_16x16x32_bf16 v[216:219], v[96:99], v[64:67], v[216:219]
    ds_read_b64_tr_b16 v[80:81], v242 offset:24576
    ds_read_b64_tr_b16 v[82:83], v242 offset:25600
    v_and_b32 v51, 0xffff0000, v25
    v_lshlrev_b32 v52, 16, v26
    v_and_b32 v53, 0xffff0000, v26
    v_lshlrev_b32 v54, 16, v27
    v_and_b32 v55, 0xffff0000, v27
    v_fma_f32 v48, v48, v226, v230
    s_waitcnt lgkmcnt(7)
    v_mfma_f32_16x16x32_bf16 v[108:111], v[100:103], v[68:71], v[108:111]
    v_mfma_f32_16x16x32_bf16 v[112:115], v[100:103], v[72:75], v[112:115]
    v_xor_b32 v243, 64, v237
    ds_read_b64_tr_b16 v[84:85], v243 offset:8192
    ds_read_b64_tr_b16 v[86:87], v243 offset:9216
    v_fma_f32 v49, v49, v226, v230
    v_fma_f32 v50, v50, v226, v230
    v_fma_f32 v51, v51, v226, v230
    v_fma_f32 v52, v52, v226, v230
    v_fma_f32 v53, v53, v226, v230
    v_fma_f32 v54, v54, v226, v230
    s_waitcnt lgkmcnt(7)
    v_mfma_f32_16x16x32_bf16 v[164:167], v[104:107], v[68:71], v[164:167]
    v_mfma_f32_16x16x32_bf16 v[168:171], v[104:107], v[72:75], v[168:171]
    ds_read_b64_tr_b16 v[88:89], v243 offset:24576
    ds_read_b64_tr_b16 v[90:91], v243 offset:25600
    v_fma_f32 v55, v55, v226, v230
    v_fma_f32 v48, v48, v32, v40
    v_fma_f32 v49, v49, v33, v41
    v_fma_f32 v50, v50, v34, v42
    v_fma_f32 v51, v51, v35, v43
    v_fma_f32 v52, v52, v36, v44
    s_waitcnt lgkmcnt(7)
    v_mfma_f32_16x16x32_bf16 v[116:119], v[76:79], v[68:71], v[116:119]
    v_mfma_f32_16x16x32_bf16 v[120:123], v[76:79], v[72:75], v[120:123]
    v_xor_b32 v244, 96, v237
    ds_read_b64_tr_b16 v[92:93], v244 offset:8192
    ds_read_b64_tr_b16 v[94:95], v244 offset:9216
    v_fma_f32 v53, v53, v37, v45
    v_fma_f32 v54, v54, v38, v46
    v_fma_f32 v55, v55, v39, v47
    v_cvt_pk_bf16_f32 v56, v48, v49
    v_cvt_pk_bf16_f32 v57, v50, v51
    v_cvt_pk_bf16_f32 v58, v52, v53
    s_waitcnt lgkmcnt(6)
    v_mfma_f32_16x16x32_bf16 v[172:175], v[80:83], v[68:71], v[172:175]
    v_mfma_f32_16x16x32_bf16 v[176:179], v[80:83], v[72:75], v[176:179]
    ds_read_b64_tr_b16 v[96:97], v244 offset:24576
    ds_read_b64_tr_b16 v[98:99], v244 offset:25600
    v_cvt_pk_bf16_f32 v59, v54, v55
    ds_write_b128 v232, v[56:59] offset:30720
    v_lshlrev_b32 v48, 16, v28
    v_and_b32 v49, 0xffff0000, v28
    v_lshlrev_b32 v50, 16, v29
    v_and_b32 v51, 0xffff0000, v29
    s_waitcnt lgkmcnt(7)
    v_mfma_f32_16x16x32_bf16 v[124:127], v[84:87], v[68:71], v[124:127]
    v_mfma_f32_16x16x32_bf16 v[128:131], v[84:87], v[72:75], v[128:131]
    v_xor_b32 v245, 128, v237
    ds_read_b64_tr_b16 v[100:101], v245 offset:8192
    ds_read_b64_tr_b16 v[102:103], v245 offset:9216
    v_lshlrev_b32 v52, 16, v30
    v_and_b32 v53, 0xffff0000, v30
    v_lshlrev_b32 v54, 16, v31
    v_and_b32 v55, 0xffff0000, v31
    v_fma_f32 v48, v48, v227, v231
    v_fma_f32 v49, v49, v227, v231
    s_waitcnt lgkmcnt(7)
    v_mfma_f32_16x16x32_bf16 v[180:183], v[88:91], v[68:71], v[180:183]
    v_mfma_f32_16x16x32_bf16 v[184:187], v[88:91], v[72:75], v[184:187]
    ds_read_b64_tr_b16 v[104:105], v245 offset:24576
    ds_read_b64_tr_b16 v[106:107], v245 offset:25600
    v_fma_f32 v50, v50, v227, v231
    v_fma_f32 v51, v51, v227, v231
    v_fma_f32 v52, v52, v227, v231
    v_fma_f32 v53, v53, v227, v231
    v_fma_f32 v54, v54, v227, v231
    v_fma_f32 v55, v55, v227, v231
    s_waitcnt lgkmcnt(7)
    v_mfma_f32_16x16x32_bf16 v[132:135], v[92:95], v[68:71], v[132:135]
    v_mfma_f32_16x16x32_bf16 v[136:139], v[92:95], v[72:75], v[136:139]
    v_xor_b32 v246, 160, v237
    ds_read_b64_tr_b16 v[76:77], v246 offset:8192
    ds_read_b64_tr_b16 v[78:79], v246 offset:9216
    v_fma_f32 v48, v48, v32, v40
    v_fma_f32 v49, v49, v33, v41
    v_fma_f32 v50, v50, v34, v42
    v_fma_f32 v51, v51, v35, v43
    v_fma_f32 v52, v52, v36, v44
    v_fma_f32 v53, v53, v37, v45
    s_waitcnt lgkmcnt(7)
    v_mfma_f32_16x16x32_bf16 v[188:191], v[96:99], v[68:71], v[188:191]
    v_mfma_f32_16x16x32_bf16 v[192:195], v[96:99], v[72:75], v[192:195]
    ds_read_b64_tr_b16 v[80:81], v246 offset:24576
    ds_read_b64_tr_b16 v[82:83], v246 offset:25600
    v_fma_f32 v54, v54, v38, v46
    v_fma_f32 v55, v55, v39, v47
    v_cvt_pk_bf16_f32 v56, v48, v49
    v_cvt_pk_bf16_f32 v57, v50, v51
    v_cvt_pk_bf16_f32 v58, v52, v53
    v_cvt_pk_bf16_f32 v59, v54, v55
    s_waitcnt lgkmcnt(6)
    v_mfma_f32_16x16x32_bf16 v[140:143], v[100:103], v[68:71], v[140:143]
    v_mfma_f32_16x16x32_bf16 v[144:147], v[100:103], v[72:75], v[144:147]
    v_xor_b32 v247, 192, v237
    ds_read_b64_tr_b16 v[84:85], v247 offset:8192
    ds_read_b64_tr_b16 v[86:87], v247 offset:9216
    ds_write_b128 v232, v[56:59] offset:35840
    s_waitcnt lgkmcnt(7)
    v_mfma_f32_16x16x32_bf16 v[196:199], v[104:107], v[68:71], v[196:199]
    v_mfma_f32_16x16x32_bf16 v[200:203], v[104:107], v[72:75], v[200:203]
    ds_read_b64_tr_b16 v[88:89], v247 offset:24576
    ds_read_b64_tr_b16 v[90:91], v247 offset:25600
    s_waitcnt lgkmcnt(7)
    v_mfma_f32_16x16x32_bf16 v[148:151], v[76:79], v[68:71], v[148:151]
    v_mfma_f32_16x16x32_bf16 v[152:155], v[76:79], v[72:75], v[152:155]
    s_waitcnt lgkmcnt(5)
    v_mfma_f32_16x16x32_bf16 v[204:207], v[80:83], v[68:71], v[204:207]
    v_mfma_f32_16x16x32_bf16 v[208:211], v[80:83], v[72:75], v[208:211]
    s_waitcnt lgkmcnt(3)
    v_mfma_f32_16x16x32_bf16 v[156:159], v[84:87], v[68:71], v[156:159]
    v_mfma_f32_16x16x32_bf16 v[160:163], v[84:87], v[72:75], v[160:163]
    s_waitcnt lgkmcnt(0)
    v_mfma_f32_16x16x32_bf16 v[212:215], v[88:91], v[68:71], v[212:215]
    v_mfma_f32_16x16x32_bf16 v[216:219], v[88:91], v[72:75], v[216:219]
    buffer_load_dwordx4 v[16:19], v220, s[12:15], 0 offen offset:768
    buffer_load_dwordx4 v[20:23], v221, s[12:15], 0 offen offset:768
    buffer_load_dwordx4 v[24:27], v222, s[12:15], 0 offen offset:768
    buffer_load_dwordx4 v[28:31], v223, s[12:15], 0 offen offset:768
    s_waitcnt lgkmcnt(0)
    s_barrier
    s_add_u32 s49, s56, 1605632
    s_add_u32 m0, s64, 77824
    s_nop 0
    buffer_load_dwordx4 v234, s[16:19], s49 offen lds
    s_add_u32 s49, s57, 1605632
    s_add_u32 m0, s65, 77824
    s_nop 0
    buffer_load_dwordx4 v234, s[16:19], s49 offen lds
    s_add_u32 s49, s58, 1605632
    s_add_u32 m0, s66, 77824
    s_nop 0
    buffer_load_dwordx4 v235, s[16:19], s49 offen lds
    s_add_u32 s49, s59, 1605632
    s_add_u32 m0, s67, 77824
    s_nop 0
    buffer_load_dwordx4 v235, s[16:19], s49 offen lds
    s_add_u32 s49, s60, 1605632
    s_add_u32 m0, s68, 77824
    s_nop 0
    buffer_load_dwordx4 v234, s[16:19], s49 offen lds
    s_add_u32 s49, s61, 1605632
    s_add_u32 m0, s69, 77824
    s_nop 0
    buffer_load_dwordx4 v234, s[16:19], s49 offen lds
    s_add_u32 s49, s62, 1605632
    s_add_u32 m0, s70, 77824
    s_nop 0
    buffer_load_dwordx4 v235, s[16:19], s49 offen lds
    s_add_u32 s49, s63, 1605632
    s_add_u32 m0, s71, 77824
    s_nop 0
    buffer_load_dwordx4 v235, s[16:19], s49 offen lds
    ds_read_b128 v[60:63], v239 offset:20480
    ds_read_b128 v[64:67], v239 offset:23040
    v_xor_b32 v241, 0, v238
    ds_read_b64_tr_b16 v[76:77], v241 offset:0
    ds_read_b64_tr_b16 v[78:79], v241 offset:1024
    ds_read_b64_tr_b16 v[80:81], v241 offset:16384
    ds_read_b64_tr_b16 v[82:83], v241 offset:17408
    v_xor_b32 v242, 32, v238
    ds_read_b64_tr_b16 v[84:85], v242 offset:0
    ds_read_b64_tr_b16 v[86:87], v242 offset:1024
    ds_read_b64_tr_b16 v[88:89], v242 offset:16384
    ds_read_b64_tr_b16 v[90:91], v242 offset:17408
    s_waitcnt lgkmcnt(6)
    v_mfma_f32_16x16x32_bf16 v[108:111], v[76:79], v[60:63], v[108:111]
    v_mfma_f32_16x16x32_bf16 v[112:115], v[76:79], v[64:67], v[112:115]
    v_xor_b32 v243, 64, v238
    ds_read_b64_tr_b16 v[92:93], v243 offset:0
    ds_read_b64_tr_b16 v[94:95], v243 offset:1024
    s_waitcnt lgkmcnt(6)
    v_mfma_f32_16x16x32_bf16 v[164:167], v[80:83], v[60:63], v[164:167]
    v_mfma_f32_16x16x32_bf16 v[168:171], v[80:83], v[64:67], v[168:171]
    ds_read_b64_tr_b16 v[96:97], v243 offset:16384
    ds_read_b64_tr_b16 v[98:99], v243 offset:17408
    s_waitcnt lgkmcnt(6)
    v_mfma_f32_16x16x32_bf16 v[116:119], v[84:87], v[60:63], v[116:119]
    v_mfma_f32_16x16x32_bf16 v[120:123], v[84:87], v[64:67], v[120:123]
    v_xor_b32 v244, 96, v238
    ds_read_b64_tr_b16 v[100:101], v244 offset:0
    ds_read_b64_tr_b16 v[102:103], v244 offset:1024
    ds_read_b128 v[32:35], v233 offset:1536
    ds_read_b128 v[36:39], v233 offset:1552
    ds_read_b128 v[40:43], v233 offset:3584
    ds_read_b128 v[44:47], v233 offset:3600
    s_waitcnt vmcnt(8)
    s_waitcnt lgkmcnt(0)
    v_lshlrev_b32 v48, 16, v16
    v_mfma_f32_16x16x32_bf16 v[172:175], v[88:91], v[60:63], v[172:175]
    v_mfma_f32_16x16x32_bf16 v[176:179], v[88:91], v[64:67], v[176:179]
    ds_read_b64_tr_b16 v[104:105], v244 offset:16384
    ds_read_b64_tr_b16 v[106:107], v244 offset:17408
    v_and_b32 v49, 0xffff0000, v16
    v_lshlrev_b32 v50, 16, v17
    v_and_b32 v51, 0xffff0000, v17
    v_lshlrev_b32 v52, 16, v18
    v_and_b32 v53, 0xffff0000, v18
    v_lshlrev_b32 v54, 16, v19
    v_mfma_f32_16x16x32_bf16 v[124:127], v[92:95], v[60:63], v[124:127]
    v_mfma_f32_16x16x32_bf16 v[128:131], v[92:95], v[64:67], v[128:131]
    v_xor_b32 v245, 128, v238
    ds_read_b64_tr_b16 v[76:77], v245 offset:0
    ds_read_b64_tr_b16 v[78:79], v245 offset:1024
    v_and_b32 v55, 0xffff0000, v19
    v_fma_f32 v48, v48, v224, v228
    v_fma_f32 v49, v49, v224, v228
    v_fma_f32 v50, v50, v224, v228
    v_fma_f32 v51, v51, v224, v228
    v_fma_f32 v52, v52, v224, v228
    v_mfma_f32_16x16x32_bf16 v[180:183], v[96:99], v[60:63], v[180:183]
    v_mfma_f32_16x16x32_bf16 v[184:187], v[96:99], v[64:67], v[184:187]
    ds_read_b64_tr_b16 v[80:81], v245 offset:16384
    ds_read_b64_tr_b16 v[82:83], v245 offset:17408
    v_fma_f32 v53, v53, v224, v228
    v_fma_f32 v54, v54, v224, v228
    v_fma_f32 v55, v55, v224, v228
    v_fma_f32 v48, v48, v32, v40
    v_fma_f32 v49, v49, v33, v41
    v_fma_f32 v50, v50, v34, v42
    ds_read_b128 v[68:71], v239 offset:20544
    ds_read_b128 v[72:75], v239 offset:23104
    v_mfma_f32_16x16x32_bf16 v[132:135], v[100:103], v[60:63], v[132:135]
    v_mfma_f32_16x16x32_bf16 v[136:139], v[100:103], v[64:67], v[136:139]
    v_xor_b32 v246, 160, v238
    ds_read_b64_tr_b16 v[84:85], v246 offset:0
    ds_read_b64_tr_b16 v[86:87], v246 offset:1024
    v_fma_f32 v51, v51, v35, v43
    v_fma_f32 v52, v52, v36, v44
    v_fma_f32 v53, v53, v37, v45
    v_fma_f32 v54, v54, v38, v46
    v_fma_f32 v55, v55, v39, v47
    v_cvt_pk_bf16_f32 v56, v48, v49
    s_waitcnt lgkmcnt(8)
    v_mfma_f32_16x16x32_bf16 v[188:191], v[104:107], v[60:63], v[188:191]
    v_mfma_f32_16x16x32_bf16 v[192:195], v[104:107], v[64:67], v[192:195]
    ds_read_b64_tr_b16 v[88:89], v246 offset:16384
    ds_read_b64_tr_b16 v[90:91], v246 offset:17408
    v_cvt_pk_bf16_f32 v57, v50, v51
    v_cvt_pk_bf16_f32 v58, v52, v53
    v_cvt_pk_bf16_f32 v59, v54, v55
    ds_write_b128 v232, v[56:59] offset:0
    v_lshlrev_b32 v48, 16, v20
    v_and_b32 v49, 0xffff0000, v20
    s_waitcnt lgkmcnt(9)
    v_mfma_f32_16x16x32_bf16 v[140:143], v[76:79], v[60:63], v[140:143]
    v_mfma_f32_16x16x32_bf16 v[144:147], v[76:79], v[64:67], v[144:147]
    v_xor_b32 v247, 192, v238
    ds_read_b64_tr_b16 v[92:93], v247 offset:0
    ds_read_b64_tr_b16 v[94:95], v247 offset:1024
    v_lshlrev_b32 v50, 16, v21
    v_and_b32 v51, 0xffff0000, v21
    v_lshlrev_b32 v52, 16, v22
    v_and_b32 v53, 0xffff0000, v22
    v_lshlrev_b32 v54, 16, v23
    v_and_b32 v55, 0xffff0000, v23
    s_waitcnt lgkmcnt(9)
    v_mfma_f32_16x16x32_bf16 v[196:199], v[80:83], v[60:63], v[196:199]
    v_mfma_f32_16x16x32_bf16 v[200:203], v[80:83], v[64:67], v[200:203]
    ds_read_b64_tr_b16 v[96:97], v247 offset:16384
    ds_read_b64_tr_b16 v[98:99], v247 offset:17408
    v_fma_f32 v48, v48, v225, v229
    v_fma_f32 v49, v49, v225, v229
    v_fma_f32 v50, v50, v225, v229
    v_fma_f32 v51, v51, v225, v229
    v_fma_f32 v52, v52, v225, v229
    v_fma_f32 v53, v53, v225, v229
    s_waitcnt lgkmcnt(7)
    v_mfma_f32_16x16x32_bf16 v[148:151], v[84:87], v[60:63], v[148:151]
    v_mfma_f32_16x16x32_bf16 v[152:155], v[84:87], v[64:67], v[152:155]
    v_xor_b32 v241, 0, v238
    ds_read_b64_tr_b16 v[100:101], v241 offset:8192
    ds_read_b64_tr_b16 v[102:103], v241 offset:9216
    v_fma_f32 v54, v54, v225, v229
    v_fma_f32 v55, v55, v225, v229
    v_fma_f32 v48, v48, v32, v40
    v_fma_f32 v49, v49, v33, v41
    v_fma_f32 v50, v50, v34, v42
    v_fma_f32 v51, v51, v35, v43
    s_waitcnt lgkmcnt(7)
    v_mfma_f32_16x16x32_bf16 v[204:207], v[88:91], v[60:63], v[204:207]
    v_mfma_f32_16x16x32_bf16 v[208:211], v[88:91], v[64:67], v[208:211]
    ds_read_b64_tr_b16 v[104:105], v241 offset:24576
    ds_read_b64_tr_b16 v[106:107], v241 offset:25600
    v_fma_f32 v52, v52, v36, v44
    v_fma_f32 v53, v53, v37, v45
    v_fma_f32 v54, v54, v38, v46
    v_fma_f32 v55, v55, v39, v47
    v_cvt_pk_bf16_f32 v56, v48, v49
    v_cvt_pk_bf16_f32 v57, v50, v51
    s_waitcnt lgkmcnt(6)
    v_mfma_f32_16x16x32_bf16 v[156:159], v[92:95], v[60:63], v[156:159]
    v_mfma_f32_16x16x32_bf16 v[160:163], v[92:95], v[64:67], v[160:163]
    v_xor_b32 v242, 32, v238
    ds_read_b64_tr_b16 v[76:77], v242 offset:8192
    ds_read_b64_tr_b16 v[78:79], v242 offset:9216
    v_cvt_pk_bf16_f32 v58, v52, v53
    v_cvt_pk_bf16_f32 v59, v54, v55
    ds_write_b128 v232, v[56:59] offset:5120
    v_lshlrev_b32 v48, 16, v24
    v_and_b32 v49, 0xffff0000, v24
    v_lshlrev_b32 v50, 16, v25
    s_waitcnt lgkmcnt(7)
    v_mfma_f32_16x16x32_bf16 v[212:215], v[96:99], v[60:63], v[212:215]
    v_mfma_f32_16x16x32_bf16 v[216:219], v[96:99], v[64:67], v[216:219]
    ds_read_b64_tr_b16 v[80:81], v242 offset:24576
    ds_read_b64_tr_b16 v[82:83], v242 offset:25600
    v_and_b32 v51, 0xffff0000, v25
    v_lshlrev_b32 v52, 16, v26
    v_and_b32 v53, 0xffff0000, v26
    v_lshlrev_b32 v54, 16, v27
    v_and_b32 v55, 0xffff0000, v27
    v_fma_f32 v48, v48, v226, v230
    s_waitcnt lgkmcnt(7)
    v_mfma_f32_16x16x32_bf16 v[108:111], v[100:103], v[68:71], v[108:111]
    v_mfma_f32_16x16x32_bf16 v[112:115], v[100:103], v[72:75], v[112:115]
    v_xor_b32 v243, 64, v238
    ds_read_b64_tr_b16 v[84:85], v243 offset:8192
    ds_read_b64_tr_b16 v[86:87], v243 offset:9216
    v_fma_f32 v49, v49, v226, v230
    v_fma_f32 v50, v50, v226, v230
    v_fma_f32 v51, v51, v226, v230
    v_fma_f32 v52, v52, v226, v230
    v_fma_f32 v53, v53, v226, v230
    v_fma_f32 v54, v54, v226, v230
    s_waitcnt lgkmcnt(7)
    v_mfma_f32_16x16x32_bf16 v[164:167], v[104:107], v[68:71], v[164:167]
    v_mfma_f32_16x16x32_bf16 v[168:171], v[104:107], v[72:75], v[168:171]
    ds_read_b64_tr_b16 v[88:89], v243 offset:24576
    ds_read_b64_tr_b16 v[90:91], v243 offset:25600
    v_fma_f32 v55, v55, v226, v230
    v_fma_f32 v48, v48, v32, v40
    v_fma_f32 v49, v49, v33, v41
    v_fma_f32 v50, v50, v34, v42
    v_fma_f32 v51, v51, v35, v43
    v_fma_f32 v52, v52, v36, v44
    s_waitcnt lgkmcnt(7)
    v_mfma_f32_16x16x32_bf16 v[116:119], v[76:79], v[68:71], v[116:119]
    v_mfma_f32_16x16x32_bf16 v[120:123], v[76:79], v[72:75], v[120:123]
    v_xor_b32 v244, 96, v238
    ds_read_b64_tr_b16 v[92:93], v244 offset:8192
    ds_read_b64_tr_b16 v[94:95], v244 offset:9216
    v_fma_f32 v53, v53, v37, v45
    v_fma_f32 v54, v54, v38, v46
    v_fma_f32 v55, v55, v39, v47
    v_cvt_pk_bf16_f32 v56, v48, v49
    v_cvt_pk_bf16_f32 v57, v50, v51
    v_cvt_pk_bf16_f32 v58, v52, v53
    s_waitcnt lgkmcnt(6)
    v_mfma_f32_16x16x32_bf16 v[172:175], v[80:83], v[68:71], v[172:175]
    v_mfma_f32_16x16x32_bf16 v[176:179], v[80:83], v[72:75], v[176:179]
    ds_read_b64_tr_b16 v[96:97], v244 offset:24576
    ds_read_b64_tr_b16 v[98:99], v244 offset:25600
    v_cvt_pk_bf16_f32 v59, v54, v55
    ds_write_b128 v232, v[56:59] offset:10240
    v_lshlrev_b32 v48, 16, v28
    v_and_b32 v49, 0xffff0000, v28
    v_lshlrev_b32 v50, 16, v29
    v_and_b32 v51, 0xffff0000, v29
    s_waitcnt lgkmcnt(7)
    v_mfma_f32_16x16x32_bf16 v[124:127], v[84:87], v[68:71], v[124:127]
    v_mfma_f32_16x16x32_bf16 v[128:131], v[84:87], v[72:75], v[128:131]
    v_xor_b32 v245, 128, v238
    ds_read_b64_tr_b16 v[100:101], v245 offset:8192
    ds_read_b64_tr_b16 v[102:103], v245 offset:9216
    v_lshlrev_b32 v52, 16, v30
    v_and_b32 v53, 0xffff0000, v30
    v_lshlrev_b32 v54, 16, v31
    v_and_b32 v55, 0xffff0000, v31
    v_fma_f32 v48, v48, v227, v231
    v_fma_f32 v49, v49, v227, v231
    s_waitcnt lgkmcnt(7)
    v_mfma_f32_16x16x32_bf16 v[180:183], v[88:91], v[68:71], v[180:183]
    v_mfma_f32_16x16x32_bf16 v[184:187], v[88:91], v[72:75], v[184:187]
    ds_read_b64_tr_b16 v[104:105], v245 offset:24576
    ds_read_b64_tr_b16 v[106:107], v245 offset:25600
    v_fma_f32 v50, v50, v227, v231
    v_fma_f32 v51, v51, v227, v231
    v_fma_f32 v52, v52, v227, v231
    v_fma_f32 v53, v53, v227, v231
    v_fma_f32 v54, v54, v227, v231
    v_fma_f32 v55, v55, v227, v231
    s_waitcnt lgkmcnt(7)
    v_mfma_f32_16x16x32_bf16 v[132:135], v[92:95], v[68:71], v[132:135]
    v_mfma_f32_16x16x32_bf16 v[136:139], v[92:95], v[72:75], v[136:139]
    v_xor_b32 v246, 160, v238
    ds_read_b64_tr_b16 v[76:77], v246 offset:8192
    ds_read_b64_tr_b16 v[78:79], v246 offset:9216
    v_fma_f32 v48, v48, v32, v40
    v_fma_f32 v49, v49, v33, v41
    v_fma_f32 v50, v50, v34, v42
    v_fma_f32 v51, v51, v35, v43
    v_fma_f32 v52, v52, v36, v44
    v_fma_f32 v53, v53, v37, v45
    s_waitcnt lgkmcnt(7)
    v_mfma_f32_16x16x32_bf16 v[188:191], v[96:99], v[68:71], v[188:191]
    v_mfma_f32_16x16x32_bf16 v[192:195], v[96:99], v[72:75], v[192:195]
    ds_read_b64_tr_b16 v[80:81], v246 offset:24576
    ds_read_b64_tr_b16 v[82:83], v246 offset:25600
    v_fma_f32 v54, v54, v38, v46
    v_fma_f32 v55, v55, v39, v47
    v_cvt_pk_bf16_f32 v56, v48, v49
    v_cvt_pk_bf16_f32 v57, v50, v51
    v_cvt_pk_bf16_f32 v58, v52, v53
    v_cvt_pk_bf16_f32 v59, v54, v55
    s_waitcnt lgkmcnt(6)
    v_mfma_f32_16x16x32_bf16 v[140:143], v[100:103], v[68:71], v[140:143]
    v_mfma_f32_16x16x32_bf16 v[144:147], v[100:103], v[72:75], v[144:147]
    v_xor_b32 v247, 192, v238
    ds_read_b64_tr_b16 v[84:85], v247 offset:8192
    ds_read_b64_tr_b16 v[86:87], v247 offset:9216
    ds_write_b128 v232, v[56:59] offset:15360
    s_waitcnt lgkmcnt(7)
    v_mfma_f32_16x16x32_bf16 v[196:199], v[104:107], v[68:71], v[196:199]
    v_mfma_f32_16x16x32_bf16 v[200:203], v[104:107], v[72:75], v[200:203]
    ds_read_b64_tr_b16 v[88:89], v247 offset:24576
    ds_read_b64_tr_b16 v[90:91], v247 offset:25600
    s_waitcnt lgkmcnt(7)
    v_mfma_f32_16x16x32_bf16 v[148:151], v[76:79], v[68:71], v[148:151]
    v_mfma_f32_16x16x32_bf16 v[152:155], v[76:79], v[72:75], v[152:155]
    s_waitcnt lgkmcnt(5)
    v_mfma_f32_16x16x32_bf16 v[204:207], v[80:83], v[68:71], v[204:207]
    v_mfma_f32_16x16x32_bf16 v[208:211], v[80:83], v[72:75], v[208:211]
    s_waitcnt lgkmcnt(3)
    v_mfma_f32_16x16x32_bf16 v[156:159], v[84:87], v[68:71], v[156:159]
    v_mfma_f32_16x16x32_bf16 v[160:163], v[84:87], v[72:75], v[160:163]
    s_waitcnt lgkmcnt(0)
    v_mfma_f32_16x16x32_bf16 v[212:215], v[88:91], v[68:71], v[212:215]
    v_mfma_f32_16x16x32_bf16 v[216:219], v[88:91], v[72:75], v[216:219]
    buffer_load_dwordx4 v[16:19], v220, s[12:15], 0 offen offset:896
    buffer_load_dwordx4 v[20:23], v221, s[12:15], 0 offen offset:896
    buffer_load_dwordx4 v[24:27], v222, s[12:15], 0 offen offset:896
    buffer_load_dwordx4 v[28:31], v223, s[12:15], 0 offen offset:896
    s_waitcnt lgkmcnt(0)
    s_barrier
    ds_read_b128 v[60:63], v239 offset:0
    ds_read_b128 v[64:67], v239 offset:2560
    v_xor_b32 v241, 0, v236
    ds_read_b64_tr_b16 v[76:77], v241 offset:0
    ds_read_b64_tr_b16 v[78:79], v241 offset:1024
    ds_read_b64_tr_b16 v[80:81], v241 offset:16384
    ds_read_b64_tr_b16 v[82:83], v241 offset:17408
    v_xor_b32 v242, 32, v236
    ds_read_b64_tr_b16 v[84:85], v242 offset:0
    ds_read_b64_tr_b16 v[86:87], v242 offset:1024
    ds_read_b64_tr_b16 v[88:89], v242 offset:16384
    ds_read_b64_tr_b16 v[90:91], v242 offset:17408
    s_waitcnt lgkmcnt(6)
    v_mfma_f32_16x16x32_bf16 v[108:111], v[76:79], v[60:63], v[108:111]
    v_mfma_f32_16x16x32_bf16 v[112:115], v[76:79], v[64:67], v[112:115]
    v_xor_b32 v243, 64, v236
    ds_read_b64_tr_b16 v[92:93], v243 offset:0
    ds_read_b64_tr_b16 v[94:95], v243 offset:1024
    s_waitcnt lgkmcnt(6)
    v_mfma_f32_16x16x32_bf16 v[164:167], v[80:83], v[60:63], v[164:167]
    v_mfma_f32_16x16x32_bf16 v[168:171], v[80:83], v[64:67], v[168:171]
    ds_read_b64_tr_b16 v[96:97], v243 offset:16384
    ds_read_b64_tr_b16 v[98:99], v243 offset:17408
    s_waitcnt lgkmcnt(6)
    v_mfma_f32_16x16x32_bf16 v[116:119], v[84:87], v[60:63], v[116:119]
    v_mfma_f32_16x16x32_bf16 v[120:123], v[84:87], v[64:67], v[120:123]
    v_xor_b32 v244, 96, v236
    ds_read_b64_tr_b16 v[100:101], v244 offset:0
    ds_read_b64_tr_b16 v[102:103], v244 offset:1024
    ds_read_b128 v[32:35], v233 offset:1792
    ds_read_b128 v[36:39], v233 offset:1808
    ds_read_b128 v[40:43], v233 offset:3840
    ds_read_b128 v[44:47], v233 offset:3856
    s_waitcnt vmcnt(0)
    s_waitcnt lgkmcnt(0)
    v_lshlrev_b32 v48, 16, v16
    v_mfma_f32_16x16x32_bf16 v[172:175], v[88:91], v[60:63], v[172:175]
    v_mfma_f32_16x16x32_bf16 v[176:179], v[88:91], v[64:67], v[176:179]
    ds_read_b64_tr_b16 v[104:105], v244 offset:16384
    ds_read_b64_tr_b16 v[106:107], v244 offset:17408
    v_and_b32 v49, 0xffff0000, v16
    v_lshlrev_b32 v50, 16, v17
    v_and_b32 v51, 0xffff0000, v17
    v_lshlrev_b32 v52, 16, v18
    v_and_b32 v53, 0xffff0000, v18
    v_lshlrev_b32 v54, 16, v19
    v_mfma_f32_16x16x32_bf16 v[124:127], v[92:95], v[60:63], v[124:127]
    v_mfma_f32_16x16x32_bf16 v[128:131], v[92:95], v[64:67], v[128:131]
    v_xor_b32 v245, 128, v236
    ds_read_b64_tr_b16 v[76:77], v245 offset:0
    ds_read_b64_tr_b16 v[78:79], v245 offset:1024
    v_and_b32 v55, 0xffff0000, v19
    v_fma_f32 v48, v48, v224, v228
    v_fma_f32 v49, v49, v224, v228
    v_fma_f32 v50, v50, v224, v228
    v_fma_f32 v51, v51, v224, v228
    v_fma_f32 v52, v52, v224, v228
    v_mfma_f32_16x16x32_bf16 v[180:183], v[96:99], v[60:63], v[180:183]
    v_mfma_f32_16x16x32_bf16 v[184:187], v[96:99], v[64:67], v[184:187]
    ds_read_b64_tr_b16 v[80:81], v245 offset:16384
    ds_read_b64_tr_b16 v[82:83], v245 offset:17408
    v_fma_f32 v53, v53, v224, v228
    v_fma_f32 v54, v54, v224, v228
    v_fma_f32 v55, v55, v224, v228
    v_fma_f32 v48, v48, v32, v40
    v_fma_f32 v49, v49, v33, v41
    v_fma_f32 v50, v50, v34, v42
    ds_read_b128 v[68:71], v239 offset:64
    ds_read_b128 v[72:75], v239 offset:2624
    v_mfma_f32_16x16x32_bf16 v[132:135], v[100:103], v[60:63], v[132:135]
    v_mfma_f32_16x16x32_bf16 v[136:139], v[100:103], v[64:67], v[136:139]
    v_xor_b32 v246, 160, v236
    ds_read_b64_tr_b16 v[84:85], v246 offset:0
    ds_read_b64_tr_b16 v[86:87], v246 offset:1024
    v_fma_f32 v51, v51, v35, v43
    v_fma_f32 v52, v52, v36, v44
    v_fma_f32 v53, v53, v37, v45
    v_fma_f32 v54, v54, v38, v46
    v_fma_f32 v55, v55, v39, v47
    v_cvt_pk_bf16_f32 v56, v48, v49
    s_waitcnt lgkmcnt(8)
    v_mfma_f32_16x16x32_bf16 v[188:191], v[104:107], v[60:63], v[188:191]
    v_mfma_f32_16x16x32_bf16 v[192:195], v[104:107], v[64:67], v[192:195]
    ds_read_b64_tr_b16 v[88:89], v246 offset:16384
    ds_read_b64_tr_b16 v[90:91], v246 offset:17408
    v_cvt_pk_bf16_f32 v57, v50, v51
    v_cvt_pk_bf16_f32 v58, v52, v53
    v_cvt_pk_bf16_f32 v59, v54, v55
    ds_write_b128 v232, v[56:59] offset:20480
    v_lshlrev_b32 v48, 16, v20
    v_and_b32 v49, 0xffff0000, v20
    s_waitcnt lgkmcnt(9)
    v_mfma_f32_16x16x32_bf16 v[140:143], v[76:79], v[60:63], v[140:143]
    v_mfma_f32_16x16x32_bf16 v[144:147], v[76:79], v[64:67], v[144:147]
    v_xor_b32 v247, 192, v236
    ds_read_b64_tr_b16 v[92:93], v247 offset:0
    ds_read_b64_tr_b16 v[94:95], v247 offset:1024
    v_lshlrev_b32 v50, 16, v21
    v_and_b32 v51, 0xffff0000, v21
    v_lshlrev_b32 v52, 16, v22
    v_and_b32 v53, 0xffff0000, v22
    v_lshlrev_b32 v54, 16, v23
    v_and_b32 v55, 0xffff0000, v23
    s_waitcnt lgkmcnt(9)
    v_mfma_f32_16x16x32_bf16 v[196:199], v[80:83], v[60:63], v[196:199]
    v_mfma_f32_16x16x32_bf16 v[200:203], v[80:83], v[64:67], v[200:203]
    ds_read_b64_tr_b16 v[96:97], v247 offset:16384
    ds_read_b64_tr_b16 v[98:99], v247 offset:17408
    v_fma_f32 v48, v48, v225, v229
    v_fma_f32 v49, v49, v225, v229
    v_fma_f32 v50, v50, v225, v229
    v_fma_f32 v51, v51, v225, v229
    v_fma_f32 v52, v52, v225, v229
    v_fma_f32 v53, v53, v225, v229
    s_waitcnt lgkmcnt(7)
    v_mfma_f32_16x16x32_bf16 v[148:151], v[84:87], v[60:63], v[148:151]
    v_mfma_f32_16x16x32_bf16 v[152:155], v[84:87], v[64:67], v[152:155]
    v_xor_b32 v241, 0, v236
    ds_read_b64_tr_b16 v[100:101], v241 offset:8192
    ds_read_b64_tr_b16 v[102:103], v241 offset:9216
    v_fma_f32 v54, v54, v225, v229
    v_fma_f32 v55, v55, v225, v229
    v_fma_f32 v48, v48, v32, v40
    v_fma_f32 v49, v49, v33, v41
    v_fma_f32 v50, v50, v34, v42
    v_fma_f32 v51, v51, v35, v43
    s_waitcnt lgkmcnt(7)
    v_mfma_f32_16x16x32_bf16 v[204:207], v[88:91], v[60:63], v[204:207]
    v_mfma_f32_16x16x32_bf16 v[208:211], v[88:91], v[64:67], v[208:211]
    ds_read_b64_tr_b16 v[104:105], v241 offset:24576
    ds_read_b64_tr_b16 v[106:107], v241 offset:25600
    v_fma_f32 v52, v52, v36, v44
    v_fma_f32 v53, v53, v37, v45
    v_fma_f32 v54, v54, v38, v46
    v_fma_f32 v55, v55, v39, v47
    v_cvt_pk_bf16_f32 v56, v48, v49
    v_cvt_pk_bf16_f32 v57, v50, v51
    s_waitcnt lgkmcnt(6)
    v_mfma_f32_16x16x32_bf16 v[156:159], v[92:95], v[60:63], v[156:159]
    v_mfma_f32_16x16x32_bf16 v[160:163], v[92:95], v[64:67], v[160:163]
    v_xor_b32 v242, 32, v236
    ds_read_b64_tr_b16 v[76:77], v242 offset:8192
    ds_read_b64_tr_b16 v[78:79], v242 offset:9216
    v_cvt_pk_bf16_f32 v58, v52, v53
    v_cvt_pk_bf16_f32 v59, v54, v55
    ds_write_b128 v232, v[56:59] offset:25600
    v_lshlrev_b32 v48, 16, v24
    v_and_b32 v49, 0xffff0000, v24
    v_lshlrev_b32 v50, 16, v25
    s_waitcnt lgkmcnt(7)
    v_mfma_f32_16x16x32_bf16 v[212:215], v[96:99], v[60:63], v[212:215]
    v_mfma_f32_16x16x32_bf16 v[216:219], v[96:99], v[64:67], v[216:219]
    ds_read_b64_tr_b16 v[80:81], v242 offset:24576
    ds_read_b64_tr_b16 v[82:83], v242 offset:25600
    v_and_b32 v51, 0xffff0000, v25
    v_lshlrev_b32 v52, 16, v26
    v_and_b32 v53, 0xffff0000, v26
    v_lshlrev_b32 v54, 16, v27
    v_and_b32 v55, 0xffff0000, v27
    v_fma_f32 v48, v48, v226, v230
    s_waitcnt lgkmcnt(7)
    v_mfma_f32_16x16x32_bf16 v[108:111], v[100:103], v[68:71], v[108:111]
    v_mfma_f32_16x16x32_bf16 v[112:115], v[100:103], v[72:75], v[112:115]
    v_xor_b32 v243, 64, v236
    ds_read_b64_tr_b16 v[84:85], v243 offset:8192
    ds_read_b64_tr_b16 v[86:87], v243 offset:9216
    v_fma_f32 v49, v49, v226, v230
    v_fma_f32 v50, v50, v226, v230
    v_fma_f32 v51, v51, v226, v230
    v_fma_f32 v52, v52, v226, v230
    v_fma_f32 v53, v53, v226, v230
    v_fma_f32 v54, v54, v226, v230
    s_waitcnt lgkmcnt(7)
    v_mfma_f32_16x16x32_bf16 v[164:167], v[104:107], v[68:71], v[164:167]
    v_mfma_f32_16x16x32_bf16 v[168:171], v[104:107], v[72:75], v[168:171]
    ds_read_b64_tr_b16 v[88:89], v243 offset:24576
    ds_read_b64_tr_b16 v[90:91], v243 offset:25600
    v_fma_f32 v55, v55, v226, v230
    v_fma_f32 v48, v48, v32, v40
    v_fma_f32 v49, v49, v33, v41
    v_fma_f32 v50, v50, v34, v42
    v_fma_f32 v51, v51, v35, v43
    v_fma_f32 v52, v52, v36, v44
    s_waitcnt lgkmcnt(7)
    v_mfma_f32_16x16x32_bf16 v[116:119], v[76:79], v[68:71], v[116:119]
    v_mfma_f32_16x16x32_bf16 v[120:123], v[76:79], v[72:75], v[120:123]
    v_xor_b32 v244, 96, v236
    ds_read_b64_tr_b16 v[92:93], v244 offset:8192
    ds_read_b64_tr_b16 v[94:95], v244 offset:9216
    v_fma_f32 v53, v53, v37, v45
    v_fma_f32 v54, v54, v38, v46
    v_fma_f32 v55, v55, v39, v47
    v_cvt_pk_bf16_f32 v56, v48, v49
    v_cvt_pk_bf16_f32 v57, v50, v51
    v_cvt_pk_bf16_f32 v58, v52, v53
    s_waitcnt lgkmcnt(6)
    v_mfma_f32_16x16x32_bf16 v[172:175], v[80:83], v[68:71], v[172:175]
    v_mfma_f32_16x16x32_bf16 v[176:179], v[80:83], v[72:75], v[176:179]
    ds_read_b64_tr_b16 v[96:97], v244 offset:24576
    ds_read_b64_tr_b16 v[98:99], v244 offset:25600
    v_cvt_pk_bf16_f32 v59, v54, v55
    ds_write_b128 v232, v[56:59] offset:30720
    v_lshlrev_b32 v48, 16, v28
    v_and_b32 v49, 0xffff0000, v28
    v_lshlrev_b32 v50, 16, v29
    v_and_b32 v51, 0xffff0000, v29
    s_waitcnt lgkmcnt(7)
    v_mfma_f32_16x16x32_bf16 v[124:127], v[84:87], v[68:71], v[124:127]
    v_mfma_f32_16x16x32_bf16 v[128:131], v[84:87], v[72:75], v[128:131]
    v_xor_b32 v245, 128, v236
    ds_read_b64_tr_b16 v[100:101], v245 offset:8192
    ds_read_b64_tr_b16 v[102:103], v245 offset:9216
    v_lshlrev_b32 v52, 16, v30
    v_and_b32 v53, 0xffff0000, v30
    v_lshlrev_b32 v54, 16, v31
    v_and_b32 v55, 0xffff0000, v31
    v_fma_f32 v48, v48, v227, v231
    v_fma_f32 v49, v49, v227, v231
    s_waitcnt lgkmcnt(7)
    v_mfma_f32_16x16x32_bf16 v[180:183], v[88:91], v[68:71], v[180:183]
    v_mfma_f32_16x16x32_bf16 v[184:187], v[88:91], v[72:75], v[184:187]
    ds_read_b64_tr_b16 v[104:105], v245 offset:24576
    ds_read_b64_tr_b16 v[106:107], v245 offset:25600
    v_fma_f32 v50, v50, v227, v231
    v_fma_f32 v51, v51, v227, v231
    v_fma_f32 v52, v52, v227, v231
    v_fma_f32 v53, v53, v227, v231
    v_fma_f32 v54, v54, v227, v231
    v_fma_f32 v55, v55, v227, v231
    s_waitcnt lgkmcnt(7)
    v_mfma_f32_16x16x32_bf16 v[132:135], v[92:95], v[68:71], v[132:135]
    v_mfma_f32_16x16x32_bf16 v[136:139], v[92:95], v[72:75], v[136:139]
    v_xor_b32 v246, 160, v236
    ds_read_b64_tr_b16 v[76:77], v246 offset:8192
    ds_read_b64_tr_b16 v[78:79], v246 offset:9216
    v_fma_f32 v48, v48, v32, v40
    v_fma_f32 v49, v49, v33, v41
    v_fma_f32 v50, v50, v34, v42
    v_fma_f32 v51, v51, v35, v43
    v_fma_f32 v52, v52, v36, v44
    v_fma_f32 v53, v53, v37, v45
    s_waitcnt lgkmcnt(7)
    v_mfma_f32_16x16x32_bf16 v[188:191], v[96:99], v[68:71], v[188:191]
    v_mfma_f32_16x16x32_bf16 v[192:195], v[96:99], v[72:75], v[192:195]
    ds_read_b64_tr_b16 v[80:81], v246 offset:24576
    ds_read_b64_tr_b16 v[82:83], v246 offset:25600
    v_fma_f32 v54, v54, v38, v46
    v_fma_f32 v55, v55, v39, v47
    v_cvt_pk_bf16_f32 v56, v48, v49
    v_cvt_pk_bf16_f32 v57, v50, v51
    v_cvt_pk_bf16_f32 v58, v52, v53
    v_cvt_pk_bf16_f32 v59, v54, v55
    s_waitcnt lgkmcnt(6)
    v_mfma_f32_16x16x32_bf16 v[140:143], v[100:103], v[68:71], v[140:143]
    v_mfma_f32_16x16x32_bf16 v[144:147], v[100:103], v[72:75], v[144:147]
    v_xor_b32 v247, 192, v236
    ds_read_b64_tr_b16 v[84:85], v247 offset:8192
    ds_read_b64_tr_b16 v[86:87], v247 offset:9216
    ds_write_b128 v232, v[56:59] offset:35840
    s_waitcnt lgkmcnt(7)
    v_mfma_f32_16x16x32_bf16 v[196:199], v[104:107], v[68:71], v[196:199]
    v_mfma_f32_16x16x32_bf16 v[200:203], v[104:107], v[72:75], v[200:203]
    ds_read_b64_tr_b16 v[88:89], v247 offset:24576
    ds_read_b64_tr_b16 v[90:91], v247 offset:25600
    s_waitcnt lgkmcnt(7)
    v_mfma_f32_16x16x32_bf16 v[148:151], v[76:79], v[68:71], v[148:151]
    v_mfma_f32_16x16x32_bf16 v[152:155], v[76:79], v[72:75], v[152:155]
    s_waitcnt lgkmcnt(5)
    v_mfma_f32_16x16x32_bf16 v[204:207], v[80:83], v[68:71], v[204:207]
    v_mfma_f32_16x16x32_bf16 v[208:211], v[80:83], v[72:75], v[208:211]
    s_waitcnt lgkmcnt(3)
    v_mfma_f32_16x16x32_bf16 v[156:159], v[84:87], v[68:71], v[156:159]
    v_mfma_f32_16x16x32_bf16 v[160:163], v[84:87], v[72:75], v[160:163]
    s_waitcnt lgkmcnt(0)
    v_mfma_f32_16x16x32_bf16 v[212:215], v[88:91], v[68:71], v[212:215]
    v_mfma_f32_16x16x32_bf16 v[216:219], v[88:91], v[72:75], v[216:219]
    s_waitcnt lgkmcnt(0)
    s_barrier
    ds_read_b128 v[60:63], v239 offset:20480
    ds_read_b128 v[64:67], v239 offset:23040
    v_xor_b32 v241, 0, v237
    ds_read_b64_tr_b16 v[76:77], v241 offset:0
    ds_read_b64_tr_b16 v[78:79], v241 offset:1024
    ds_read_b64_tr_b16 v[80:81], v241 offset:16384
    ds_read_b64_tr_b16 v[82:83], v241 offset:17408
    v_xor_b32 v242, 32, v237
    ds_read_b64_tr_b16 v[84:85], v242 offset:0
    ds_read_b64_tr_b16 v[86:87], v242 offset:1024
    ds_read_b64_tr_b16 v[88:89], v242 offset:16384
    ds_read_b64_tr_b16 v[90:91], v242 offset:17408
    s_waitcnt lgkmcnt(6)
    v_mfma_f32_16x16x32_bf16 v[108:111], v[76:79], v[60:63], v[108:111]
    v_mfma_f32_16x16x32_bf16 v[112:115], v[76:79], v[64:67], v[112:115]
    v_xor_b32 v243, 64, v237
    ds_read_b64_tr_b16 v[92:93], v243 offset:0
    ds_read_b64_tr_b16 v[94:95], v243 offset:1024
    s_waitcnt lgkmcnt(6)
    v_mfma_f32_16x16x32_bf16 v[164:167], v[80:83], v[60:63], v[164:167]
    v_mfma_f32_16x16x32_bf16 v[168:171], v[80:83], v[64:67], v[168:171]
    ds_read_b64_tr_b16 v[96:97], v243 offset:16384
    ds_read_b64_tr_b16 v[98:99], v243 offset:17408
    s_waitcnt lgkmcnt(6)
    v_mfma_f32_16x16x32_bf16 v[116:119], v[84:87], v[60:63], v[116:119]
    v_mfma_f32_16x16x32_bf16 v[120:123], v[84:87], v[64:67], v[120:123]
    v_xor_b32 v244, 96, v237
    ds_read_b64_tr_b16 v[100:101], v244 offset:0
    ds_read_b64_tr_b16 v[102:103], v244 offset:1024
    s_waitcnt lgkmcnt(6)
    v_mfma_f32_16x16x32_bf16 v[172:175], v[88:91], v[60:63], v[172:175]
    v_mfma_f32_16x16x32_bf16 v[176:179], v[88:91], v[64:67], v[176:179]
    ds_read_b64_tr_b16 v[104:105], v244 offset:16384
    ds_read_b64_tr_b16 v[106:107], v244 offset:17408
    s_waitcnt lgkmcnt(6)
    v_mfma_f32_16x16x32_bf16 v[124:127], v[92:95], v[60:63], v[124:127]
    v_mfma_f32_16x16x32_bf16 v[128:131], v[92:95], v[64:67], v[128:131]
    v_xor_b32 v245, 128, v237
    ds_read_b64_tr_b16 v[76:77], v245 offset:0
    ds_read_b64_tr_b16 v[78:79], v245 offset:1024
    s_waitcnt lgkmcnt(6)
    v_mfma_f32_16x16x32_bf16 v[180:183], v[96:99], v[60:63], v[180:183]
    v_mfma_f32_16x16x32_bf16 v[184:187], v[96:99], v[64:67], v[184:187]
    ds_read_b64_tr_b16 v[80:81], v245 offset:16384
    ds_read_b64_tr_b16 v[82:83], v245 offset:17408
    ds_read_b128 v[68:71], v239 offset:20544
    ds_read_b128 v[72:75], v239 offset:23104
    s_waitcnt lgkmcnt(8)
    v_mfma_f32_16x16x32_bf16 v[132:135], v[100:103], v[60:63], v[132:135]
    v_mfma_f32_16x16x32_bf16 v[136:139], v[100:103], v[64:67], v[136:139]
    v_xor_b32 v246, 160, v237
    ds_read_b64_tr_b16 v[84:85], v246 offset:0
    ds_read_b64_tr_b16 v[86:87], v246 offset:1024
    s_waitcnt lgkmcnt(8)
    v_mfma_f32_16x16x32_bf16 v[188:191], v[104:107], v[60:63], v[188:191]
    v_mfma_f32_16x16x32_bf16 v[192:195], v[104:107], v[64:67], v[192:195]
    ds_read_b64_tr_b16 v[88:89], v246 offset:16384
    ds_read_b64_tr_b16 v[90:91], v246 offset:17408
    s_waitcnt lgkmcnt(8)
    v_mfma_f32_16x16x32_bf16 v[140:143], v[76:79], v[60:63], v[140:143]
    v_mfma_f32_16x16x32_bf16 v[144:147], v[76:79], v[64:67], v[144:147]
    v_xor_b32 v247, 192, v237
    ds_read_b64_tr_b16 v[92:93], v247 offset:0
    ds_read_b64_tr_b16 v[94:95], v247 offset:1024
    s_waitcnt lgkmcnt(8)
    v_mfma_f32_16x16x32_bf16 v[196:199], v[80:83], v[60:63], v[196:199]
    v_mfma_f32_16x16x32_bf16 v[200:203], v[80:83], v[64:67], v[200:203]
    ds_read_b64_tr_b16 v[96:97], v247 offset:16384
    ds_read_b64_tr_b16 v[98:99], v247 offset:17408
    s_waitcnt lgkmcnt(6)
    v_mfma_f32_16x16x32_bf16 v[148:151], v[84:87], v[60:63], v[148:151]
    v_mfma_f32_16x16x32_bf16 v[152:155], v[84:87], v[64:67], v[152:155]
    v_xor_b32 v241, 0, v237
    ds_read_b64_tr_b16 v[100:101], v241 offset:8192
    ds_read_b64_tr_b16 v[102:103], v241 offset:9216
    s_waitcnt lgkmcnt(6)
    v_mfma_f32_16x16x32_bf16 v[204:207], v[88:91], v[60:63], v[204:207]
    v_mfma_f32_16x16x32_bf16 v[208:211], v[88:91], v[64:67], v[208:211]
    ds_read_b64_tr_b16 v[104:105], v241 offset:24576
    ds_read_b64_tr_b16 v[106:107], v241 offset:25600
    s_waitcnt lgkmcnt(6)
    v_mfma_f32_16x16x32_bf16 v[156:159], v[92:95], v[60:63], v[156:159]
    v_mfma_f32_16x16x32_bf16 v[160:163], v[92:95], v[64:67], v[160:163]
    v_xor_b32 v242, 32, v237
    ds_read_b64_tr_b16 v[76:77], v242 offset:8192
    ds_read_b64_tr_b16 v[78:79], v242 offset:9216
    s_waitcnt lgkmcnt(6)
    v_mfma_f32_16x16x32_bf16 v[212:215], v[96:99], v[60:63], v[212:215]
    v_mfma_f32_16x16x32_bf16 v[216:219], v[96:99], v[64:67], v[216:219]
    ds_read_b64_tr_b16 v[80:81], v242 offset:24576
    ds_read_b64_tr_b16 v[82:83], v242 offset:25600
    s_waitcnt lgkmcnt(6)
    v_mfma_f32_16x16x32_bf16 v[108:111], v[100:103], v[68:71], v[108:111]
    v_mfma_f32_16x16x32_bf16 v[112:115], v[100:103], v[72:75], v[112:115]
    v_xor_b32 v243, 64, v237
    ds_read_b64_tr_b16 v[84:85], v243 offset:8192
    ds_read_b64_tr_b16 v[86:87], v243 offset:9216
    s_waitcnt lgkmcnt(6)
    v_mfma_f32_16x16x32_bf16 v[164:167], v[104:107], v[68:71], v[164:167]
    v_mfma_f32_16x16x32_bf16 v[168:171], v[104:107], v[72:75], v[168:171]
    ds_read_b64_tr_b16 v[88:89], v243 offset:24576
    ds_read_b64_tr_b16 v[90:91], v243 offset:25600
    s_waitcnt lgkmcnt(6)
    v_mfma_f32_16x16x32_bf16 v[116:119], v[76:79], v[68:71], v[116:119]
    v_mfma_f32_16x16x32_bf16 v[120:123], v[76:79], v[72:75], v[120:123]
    v_xor_b32 v244, 96, v237
    ds_read_b64_tr_b16 v[92:93], v244 offset:8192
    ds_read_b64_tr_b16 v[94:95], v244 offset:9216
    s_waitcnt lgkmcnt(6)
    v_mfma_f32_16x16x32_bf16 v[172:175], v[80:83], v[68:71], v[172:175]
    v_mfma_f32_16x16x32_bf16 v[176:179], v[80:83], v[72:75], v[176:179]
    ds_read_b64_tr_b16 v[96:97], v244 offset:24576
    ds_read_b64_tr_b16 v[98:99], v244 offset:25600
    s_waitcnt lgkmcnt(6)
    v_mfma_f32_16x16x32_bf16 v[124:127], v[84:87], v[68:71], v[124:127]
    v_mfma_f32_16x16x32_bf16 v[128:131], v[84:87], v[72:75], v[128:131]
    v_xor_b32 v245, 128, v237
    ds_read_b64_tr_b16 v[100:101], v245 offset:8192
    ds_read_b64_tr_b16 v[102:103], v245 offset:9216
    s_waitcnt lgkmcnt(6)
    v_mfma_f32_16x16x32_bf16 v[180:183], v[88:91], v[68:71], v[180:183]
    v_mfma_f32_16x16x32_bf16 v[184:187], v[88:91], v[72:75], v[184:187]
    ds_read_b64_tr_b16 v[104:105], v245 offset:24576
    ds_read_b64_tr_b16 v[106:107], v245 offset:25600
    s_waitcnt lgkmcnt(6)
    v_mfma_f32_16x16x32_bf16 v[132:135], v[92:95], v[68:71], v[132:135]
    v_mfma_f32_16x16x32_bf16 v[136:139], v[92:95], v[72:75], v[136:139]
    v_xor_b32 v246, 160, v237
    ds_read_b64_tr_b16 v[76:77], v246 offset:8192
    ds_read_b64_tr_b16 v[78:79], v246 offset:9216
    s_waitcnt lgkmcnt(6)
    v_mfma_f32_16x16x32_bf16 v[188:191], v[96:99], v[68:71], v[188:191]
    v_mfma_f32_16x16x32_bf16 v[192:195], v[96:99], v[72:75], v[192:195]
    ds_read_b64_tr_b16 v[80:81], v246 offset:24576
    ds_read_b64_tr_b16 v[82:83], v246 offset:25600
    s_waitcnt lgkmcnt(6)
    v_mfma_f32_16x16x32_bf16 v[140:143], v[100:103], v[68:71], v[140:143]
    v_mfma_f32_16x16x32_bf16 v[144:147], v[100:103], v[72:75], v[144:147]
    v_xor_b32 v247, 192, v237
    ds_read_b64_tr_b16 v[84:85], v247 offset:8192
    ds_read_b64_tr_b16 v[86:87], v247 offset:9216
    s_waitcnt lgkmcnt(6)
    v_mfma_f32_16x16x32_bf16 v[196:199], v[104:107], v[68:71], v[196:199]
    v_mfma_f32_16x16x32_bf16 v[200:203], v[104:107], v[72:75], v[200:203]
    ds_read_b64_tr_b16 v[88:89], v247 offset:24576
    ds_read_b64_tr_b16 v[90:91], v247 offset:25600
    s_waitcnt lgkmcnt(6)
    v_mfma_f32_16x16x32_bf16 v[148:151], v[76:79], v[68:71], v[148:151]
    v_mfma_f32_16x16x32_bf16 v[152:155], v[76:79], v[72:75], v[152:155]
    s_waitcnt lgkmcnt(4)
    v_mfma_f32_16x16x32_bf16 v[204:207], v[80:83], v[68:71], v[204:207]
    v_mfma_f32_16x16x32_bf16 v[208:211], v[80:83], v[72:75], v[208:211]
    s_waitcnt lgkmcnt(2)
    v_mfma_f32_16x16x32_bf16 v[156:159], v[84:87], v[68:71], v[156:159]
    v_mfma_f32_16x16x32_bf16 v[160:163], v[84:87], v[72:75], v[160:163]
    s_waitcnt lgkmcnt(0)
    v_mfma_f32_16x16x32_bf16 v[212:215], v[88:91], v[68:71], v[212:215]
    v_mfma_f32_16x16x32_bf16 v[216:219], v[88:91], v[72:75], v[216:219]
    s_mov_b32 s50, 0xc0135761
    s_mov_b32 s51, 0xbdd2d3e8
    v_mul_f32 v16, v108, v108
    v_mul_f32 v17, v109, v109
    v_mul_f32 v18, v110, v110
    v_mul_f32 v19, v111, v111
    v_mov_b32 v20, s50
    v_mov_b32 v21, s50
    v_mov_b32 v22, s50
    v_mov_b32 v23, s50
    v_fmac_f32 v20, s51, v16
    v_fmac_f32 v21, s51, v17
    v_fmac_f32 v22, s51, v18
    v_fmac_f32 v23, s51, v19
    v_mul_f32 v16, v108, v20
    v_mul_f32 v17, v109, v21
    v_mul_f32 v18, v110, v22
    v_mul_f32 v19, v111, v23
    v_exp_f32 v16, v16
    v_exp_f32 v17, v17
    v_exp_f32 v18, v18
    v_exp_f32 v19, v19
    v_add_f32 v16, 1.0, v16
    v_add_f32 v17, 1.0, v17
    v_add_f32 v18, 1.0, v18
    v_add_f32 v19, 1.0, v19
    v_rcp_f32 v16, v16
    v_rcp_f32 v17, v17
    v_rcp_f32 v18, v18
    v_rcp_f32 v19, v19
    v_mul_f32 v16, v16, v108
    v_mul_f32 v17, v17, v109
    v_mul_f32 v18, v18, v110
    v_mul_f32 v19, v19, v111
    v_mul_f32 v16, v16, v164
    v_mul_f32 v17, v17, v165
    v_mul_f32 v18, v18, v166
    v_mul_f32 v19, v19, v167
    v_cvt_pk_bf16_f32 v20, v16, v17
    v_cvt_pk_bf16_f32 v21, v18, v19
    s_mov_b32 s49, 0
    buffer_store_dwordx2 v[20:21], v240, s[28:31], s49 offen offset:0
    v_mul_f32 v24, v116, v116
    v_mul_f32 v25, v117, v117
    v_mul_f32 v26, v118, v118
    v_mul_f32 v27, v119, v119
    v_mov_b32 v28, s50
    v_mov_b32 v29, s50
    v_mov_b32 v30, s50
    v_mov_b32 v31, s50
    v_fmac_f32 v28, s51, v24
    v_fmac_f32 v29, s51, v25
    v_fmac_f32 v30, s51, v26
    v_fmac_f32 v31, s51, v27
    v_mul_f32 v24, v116, v28
    v_mul_f32 v25, v117, v29
    v_mul_f32 v26, v118, v30
    v_mul_f32 v27, v119, v31
    v_exp_f32 v24, v24
    v_exp_f32 v25, v25
    v_exp_f32 v26, v26
    v_exp_f32 v27, v27
    v_add_f32 v24, 1.0, v24
    v_add_f32 v25, 1.0, v25
    v_add_f32 v26, 1.0, v26
    v_add_f32 v27, 1.0, v27
    v_rcp_f32 v24, v24
    v_rcp_f32 v25, v25
    v_rcp_f32 v26, v26
    v_rcp_f32 v27, v27
    v_mul_f32 v24, v24, v116
    v_mul_f32 v25, v25, v117
    v_mul_f32 v26, v26, v118
    v_mul_f32 v27, v27, v119
    v_mul_f32 v24, v24, v172
    v_mul_f32 v25, v25, v173
    v_mul_f32 v26, v26, v174
    v_mul_f32 v27, v27, v175
    v_cvt_pk_bf16_f32 v28, v24, v25
    v_cvt_pk_bf16_f32 v29, v26, v27
    s_mov_b32 s49, 0
    buffer_store_dwordx2 v[28:29], v240, s[28:31], s49 offen offset:32
    v_mul_f32 v16, v124, v124
    v_mul_f32 v17, v125, v125
    v_mul_f32 v18, v126, v126
    v_mul_f32 v19, v127, v127
    v_mov_b32 v20, s50
    v_mov_b32 v21, s50
    v_mov_b32 v22, s50
    v_mov_b32 v23, s50
    v_fmac_f32 v20, s51, v16
    v_fmac_f32 v21, s51, v17
    v_fmac_f32 v22, s51, v18
    v_fmac_f32 v23, s51, v19
    v_mul_f32 v16, v124, v20
    v_mul_f32 v17, v125, v21
    v_mul_f32 v18, v126, v22
    v_mul_f32 v19, v127, v23
    v_exp_f32 v16, v16
    v_exp_f32 v17, v17
    v_exp_f32 v18, v18
    v_exp_f32 v19, v19
    v_add_f32 v16, 1.0, v16
    v_add_f32 v17, 1.0, v17
    v_add_f32 v18, 1.0, v18
    v_add_f32 v19, 1.0, v19
    v_rcp_f32 v16, v16
    v_rcp_f32 v17, v17
    v_rcp_f32 v18, v18
    v_rcp_f32 v19, v19
    v_mul_f32 v16, v16, v124
    v_mul_f32 v17, v17, v125
    v_mul_f32 v18, v18, v126
    v_mul_f32 v19, v19, v127
    v_mul_f32 v16, v16, v180
    v_mul_f32 v17, v17, v181
    v_mul_f32 v18, v18, v182
    v_mul_f32 v19, v19, v183
    v_cvt_pk_bf16_f32 v20, v16, v17
    v_cvt_pk_bf16_f32 v21, v18, v19
    s_mov_b32 s49, 0
    buffer_store_dwordx2 v[20:21], v240, s[28:31], s49 offen offset:64
    v_mul_f32 v24, v132, v132
    v_mul_f32 v25, v133, v133
    v_mul_f32 v26, v134, v134
    v_mul_f32 v27, v135, v135
    v_mov_b32 v28, s50
    v_mov_b32 v29, s50
    v_mov_b32 v30, s50
    v_mov_b32 v31, s50
    v_fmac_f32 v28, s51, v24
    v_fmac_f32 v29, s51, v25
    v_fmac_f32 v30, s51, v26
    v_fmac_f32 v31, s51, v27
    v_mul_f32 v24, v132, v28
    v_mul_f32 v25, v133, v29
    v_mul_f32 v26, v134, v30
    v_mul_f32 v27, v135, v31
    v_exp_f32 v24, v24
    v_exp_f32 v25, v25
    v_exp_f32 v26, v26
    v_exp_f32 v27, v27
    v_add_f32 v24, 1.0, v24
    v_add_f32 v25, 1.0, v25
    v_add_f32 v26, 1.0, v26
    v_add_f32 v27, 1.0, v27
    v_rcp_f32 v24, v24
    v_rcp_f32 v25, v25
    v_rcp_f32 v26, v26
    v_rcp_f32 v27, v27
    v_mul_f32 v24, v24, v132
    v_mul_f32 v25, v25, v133
    v_mul_f32 v26, v26, v134
    v_mul_f32 v27, v27, v135
    v_mul_f32 v24, v24, v188
    v_mul_f32 v25, v25, v189
    v_mul_f32 v26, v26, v190
    v_mul_f32 v27, v27, v191
    v_cvt_pk_bf16_f32 v28, v24, v25
    v_cvt_pk_bf16_f32 v29, v26, v27
    s_mov_b32 s49, 0
    buffer_store_dwordx2 v[28:29], v240, s[28:31], s49 offen offset:96
    v_mul_f32 v16, v140, v140
    v_mul_f32 v17, v141, v141
    v_mul_f32 v18, v142, v142
    v_mul_f32 v19, v143, v143
    v_mov_b32 v20, s50
    v_mov_b32 v21, s50
    v_mov_b32 v22, s50
    v_mov_b32 v23, s50
    v_fmac_f32 v20, s51, v16
    v_fmac_f32 v21, s51, v17
    v_fmac_f32 v22, s51, v18
    v_fmac_f32 v23, s51, v19
    v_mul_f32 v16, v140, v20
    v_mul_f32 v17, v141, v21
    v_mul_f32 v18, v142, v22
    v_mul_f32 v19, v143, v23
    v_exp_f32 v16, v16
    v_exp_f32 v17, v17
    v_exp_f32 v18, v18
    v_exp_f32 v19, v19
    v_add_f32 v16, 1.0, v16
    v_add_f32 v17, 1.0, v17
    v_add_f32 v18, 1.0, v18
    v_add_f32 v19, 1.0, v19
    v_rcp_f32 v16, v16
    v_rcp_f32 v17, v17
    v_rcp_f32 v18, v18
    v_rcp_f32 v19, v19
    v_mul_f32 v16, v16, v140
    v_mul_f32 v17, v17, v141
    v_mul_f32 v18, v18, v142
    v_mul_f32 v19, v19, v143
    v_mul_f32 v16, v16, v196
    v_mul_f32 v17, v17, v197
    v_mul_f32 v18, v18, v198
    v_mul_f32 v19, v19, v199
    v_cvt_pk_bf16_f32 v20, v16, v17
    v_cvt_pk_bf16_f32 v21, v18, v19
    s_mov_b32 s49, 0
    buffer_store_dwordx2 v[20:21], v240, s[28:31], s49 offen offset:128
    v_mul_f32 v24, v148, v148
    v_mul_f32 v25, v149, v149
    v_mul_f32 v26, v150, v150
    v_mul_f32 v27, v151, v151
    v_mov_b32 v28, s50
    v_mov_b32 v29, s50
    v_mov_b32 v30, s50
    v_mov_b32 v31, s50
    v_fmac_f32 v28, s51, v24
    v_fmac_f32 v29, s51, v25
    v_fmac_f32 v30, s51, v26
    v_fmac_f32 v31, s51, v27
    v_mul_f32 v24, v148, v28
    v_mul_f32 v25, v149, v29
    v_mul_f32 v26, v150, v30
    v_mul_f32 v27, v151, v31
    v_exp_f32 v24, v24
    v_exp_f32 v25, v25
    v_exp_f32 v26, v26
    v_exp_f32 v27, v27
    v_add_f32 v24, 1.0, v24
    v_add_f32 v25, 1.0, v25
    v_add_f32 v26, 1.0, v26
    v_add_f32 v27, 1.0, v27
    v_rcp_f32 v24, v24
    v_rcp_f32 v25, v25
    v_rcp_f32 v26, v26
    v_rcp_f32 v27, v27
    v_mul_f32 v24, v24, v148
    v_mul_f32 v25, v25, v149
    v_mul_f32 v26, v26, v150
    v_mul_f32 v27, v27, v151
    v_mul_f32 v24, v24, v204
    v_mul_f32 v25, v25, v205
    v_mul_f32 v26, v26, v206
    v_mul_f32 v27, v27, v207
    v_cvt_pk_bf16_f32 v28, v24, v25
    v_cvt_pk_bf16_f32 v29, v26, v27
    s_mov_b32 s49, 0
    buffer_store_dwordx2 v[28:29], v240, s[28:31], s49 offen offset:160
    v_mul_f32 v16, v156, v156
    v_mul_f32 v17, v157, v157
    v_mul_f32 v18, v158, v158
    v_mul_f32 v19, v159, v159
    v_mov_b32 v20, s50
    v_mov_b32 v21, s50
    v_mov_b32 v22, s50
    v_mov_b32 v23, s50
    v_fmac_f32 v20, s51, v16
    v_fmac_f32 v21, s51, v17
    v_fmac_f32 v22, s51, v18
    v_fmac_f32 v23, s51, v19
    v_mul_f32 v16, v156, v20
    v_mul_f32 v17, v157, v21
    v_mul_f32 v18, v158, v22
    v_mul_f32 v19, v159, v23
    v_exp_f32 v16, v16
    v_exp_f32 v17, v17
    v_exp_f32 v18, v18
    v_exp_f32 v19, v19
    v_add_f32 v16, 1.0, v16
    v_add_f32 v17, 1.0, v17
    v_add_f32 v18, 1.0, v18
    v_add_f32 v19, 1.0, v19
    v_rcp_f32 v16, v16
    v_rcp_f32 v17, v17
    v_rcp_f32 v18, v18
    v_rcp_f32 v19, v19
    v_mul_f32 v16, v16, v156
    v_mul_f32 v17, v17, v157
    v_mul_f32 v18, v18, v158
    v_mul_f32 v19, v19, v159
    v_mul_f32 v16, v16, v212
    v_mul_f32 v17, v17, v213
    v_mul_f32 v18, v18, v214
    v_mul_f32 v19, v19, v215
    v_cvt_pk_bf16_f32 v20, v16, v17
    v_cvt_pk_bf16_f32 v21, v18, v19
    s_mov_b32 s49, 0
    buffer_store_dwordx2 v[20:21], v240, s[28:31], s49 offen offset:192
    v_mul_f32 v16, v112, v112
    v_mul_f32 v17, v113, v113
    v_mul_f32 v18, v114, v114
    v_mul_f32 v19, v115, v115
    v_mov_b32 v20, s50
    v_mov_b32 v21, s50
    v_mov_b32 v22, s50
    v_mov_b32 v23, s50
    v_fmac_f32 v20, s51, v16
    v_fmac_f32 v21, s51, v17
    v_fmac_f32 v22, s51, v18
    v_fmac_f32 v23, s51, v19
    v_mul_f32 v16, v112, v20
    v_mul_f32 v17, v113, v21
    v_mul_f32 v18, v114, v22
    v_mul_f32 v19, v115, v23
    v_exp_f32 v16, v16
    v_exp_f32 v17, v17
    v_exp_f32 v18, v18
    v_exp_f32 v19, v19
    v_add_f32 v16, 1.0, v16
    v_add_f32 v17, 1.0, v17
    v_add_f32 v18, 1.0, v18
    v_add_f32 v19, 1.0, v19
    v_rcp_f32 v16, v16
    v_rcp_f32 v17, v17
    v_rcp_f32 v18, v18
    v_rcp_f32 v19, v19
    v_mul_f32 v16, v16, v112
    v_mul_f32 v17, v17, v113
    v_mul_f32 v18, v18, v114
    v_mul_f32 v19, v19, v115
    v_mul_f32 v16, v16, v168
    v_mul_f32 v17, v17, v169
    v_mul_f32 v18, v18, v170
    v_mul_f32 v19, v19, v171
    v_cvt_pk_bf16_f32 v20, v16, v17
    v_cvt_pk_bf16_f32 v21, v18, v19
    s_mov_b32 s49, 57344
    buffer_store_dwordx2 v[20:21], v240, s[28:31], s49 offen offset:0
    v_mul_f32 v24, v120, v120
    v_mul_f32 v25, v121, v121
    v_mul_f32 v26, v122, v122
    v_mul_f32 v27, v123, v123
    v_mov_b32 v28, s50
    v_mov_b32 v29, s50
    v_mov_b32 v30, s50
    v_mov_b32 v31, s50
    v_fmac_f32 v28, s51, v24
    v_fmac_f32 v29, s51, v25
    v_fmac_f32 v30, s51, v26
    v_fmac_f32 v31, s51, v27
    v_mul_f32 v24, v120, v28
    v_mul_f32 v25, v121, v29
    v_mul_f32 v26, v122, v30
    v_mul_f32 v27, v123, v31
    v_exp_f32 v24, v24
    v_exp_f32 v25, v25
    v_exp_f32 v26, v26
    v_exp_f32 v27, v27
    v_add_f32 v24, 1.0, v24
    v_add_f32 v25, 1.0, v25
    v_add_f32 v26, 1.0, v26
    v_add_f32 v27, 1.0, v27
    v_rcp_f32 v24, v24
    v_rcp_f32 v25, v25
    v_rcp_f32 v26, v26
    v_rcp_f32 v27, v27
    v_mul_f32 v24, v24, v120
    v_mul_f32 v25, v25, v121
    v_mul_f32 v26, v26, v122
    v_mul_f32 v27, v27, v123
    v_mul_f32 v24, v24, v176
    v_mul_f32 v25, v25, v177
    v_mul_f32 v26, v26, v178
    v_mul_f32 v27, v27, v179
    v_cvt_pk_bf16_f32 v28, v24, v25
    v_cvt_pk_bf16_f32 v29, v26, v27
    s_mov_b32 s49, 57344
    buffer_store_dwordx2 v[28:29], v240, s[28:31], s49 offen offset:32
    v_mul_f32 v16, v128, v128
    v_mul_f32 v17, v129, v129
    v_mul_f32 v18, v130, v130
    v_mul_f32 v19, v131, v131
    v_mov_b32 v20, s50
    v_mov_b32 v21, s50
    v_mov_b32 v22, s50
    v_mov_b32 v23, s50
    v_fmac_f32 v20, s51, v16
    v_fmac_f32 v21, s51, v17
    v_fmac_f32 v22, s51, v18
    v_fmac_f32 v23, s51, v19
    v_mul_f32 v16, v128, v20
    v_mul_f32 v17, v129, v21
    v_mul_f32 v18, v130, v22
    v_mul_f32 v19, v131, v23
    v_exp_f32 v16, v16
    v_exp_f32 v17, v17
    v_exp_f32 v18, v18
    v_exp_f32 v19, v19
    v_add_f32 v16, 1.0, v16
    v_add_f32 v17, 1.0, v17
    v_add_f32 v18, 1.0, v18
    v_add_f32 v19, 1.0, v19
    v_rcp_f32 v16, v16
    v_rcp_f32 v17, v17
    v_rcp_f32 v18, v18
    v_rcp_f32 v19, v19
    v_mul_f32 v16, v16, v128
    v_mul_f32 v17, v17, v129
    v_mul_f32 v18, v18, v130
    v_mul_f32 v19, v19, v131
    v_mul_f32 v16, v16, v184
    v_mul_f32 v17, v17, v185
    v_mul_f32 v18, v18, v186
    v_mul_f32 v19, v19, v187
    v_cvt_pk_bf16_f32 v20, v16, v17
    v_cvt_pk_bf16_f32 v21, v18, v19
    s_mov_b32 s49, 57344
    buffer_store_dwordx2 v[20:21], v240, s[28:31], s49 offen offset:64
    v_mul_f32 v24, v136, v136
    v_mul_f32 v25, v137, v137
    v_mul_f32 v26, v138, v138
    v_mul_f32 v27, v139, v139
    v_mov_b32 v28, s50
    v_mov_b32 v29, s50
    v_mov_b32 v30, s50
    v_mov_b32 v31, s50
    v_fmac_f32 v28, s51, v24
    v_fmac_f32 v29, s51, v25
    v_fmac_f32 v30, s51, v26
    v_fmac_f32 v31, s51, v27
    v_mul_f32 v24, v136, v28
    v_mul_f32 v25, v137, v29
    v_mul_f32 v26, v138, v30
    v_mul_f32 v27, v139, v31
    v_exp_f32 v24, v24
    v_exp_f32 v25, v25
    v_exp_f32 v26, v26
    v_exp_f32 v27, v27
    v_add_f32 v24, 1.0, v24
    v_add_f32 v25, 1.0, v25
    v_add_f32 v26, 1.0, v26
    v_add_f32 v27, 1.0, v27
    v_rcp_f32 v24, v24
    v_rcp_f32 v25, v25
    v_rcp_f32 v26, v26
    v_rcp_f32 v27, v27
    v_mul_f32 v24, v24, v136
    v_mul_f32 v25, v25, v137
    v_mul_f32 v26, v26, v138
    v_mul_f32 v27, v27, v139
    v_mul_f32 v24, v24, v192
    v_mul_f32 v25, v25, v193
    v_mul_f32 v26, v26, v194
    v_mul_f32 v27, v27, v195
    v_cvt_pk_bf16_f32 v28, v24, v25
    v_cvt_pk_bf16_f32 v29, v26, v27
    s_mov_b32 s49, 57344
    buffer_store_dwordx2 v[28:29], v240, s[28:31], s49 offen offset:96
    v_mul_f32 v16, v144, v144
    v_mul_f32 v17, v145, v145
    v_mul_f32 v18, v146, v146
    v_mul_f32 v19, v147, v147
    v_mov_b32 v20, s50
    v_mov_b32 v21, s50
    v_mov_b32 v22, s50
    v_mov_b32 v23, s50
    v_fmac_f32 v20, s51, v16
    v_fmac_f32 v21, s51, v17
    v_fmac_f32 v22, s51, v18
    v_fmac_f32 v23, s51, v19
    v_mul_f32 v16, v144, v20
    v_mul_f32 v17, v145, v21
    v_mul_f32 v18, v146, v22
    v_mul_f32 v19, v147, v23
    v_exp_f32 v16, v16
    v_exp_f32 v17, v17
    v_exp_f32 v18, v18
    v_exp_f32 v19, v19
    v_add_f32 v16, 1.0, v16
    v_add_f32 v17, 1.0, v17
    v_add_f32 v18, 1.0, v18
    v_add_f32 v19, 1.0, v19
    v_rcp_f32 v16, v16
    v_rcp_f32 v17, v17
    v_rcp_f32 v18, v18
    v_rcp_f32 v19, v19
    v_mul_f32 v16, v16, v144
    v_mul_f32 v17, v17, v145
    v_mul_f32 v18, v18, v146
    v_mul_f32 v19, v19, v147
    v_mul_f32 v16, v16, v200
    v_mul_f32 v17, v17, v201
    v_mul_f32 v18, v18, v202
    v_mul_f32 v19, v19, v203
    v_cvt_pk_bf16_f32 v20, v16, v17
    v_cvt_pk_bf16_f32 v21, v18, v19
    s_mov_b32 s49, 57344
    buffer_store_dwordx2 v[20:21], v240, s[28:31], s49 offen offset:128
    v_mul_f32 v24, v152, v152
    v_mul_f32 v25, v153, v153
    v_mul_f32 v26, v154, v154
    v_mul_f32 v27, v155, v155
    v_mov_b32 v28, s50
    v_mov_b32 v29, s50
    v_mov_b32 v30, s50
    v_mov_b32 v31, s50
    v_fmac_f32 v28, s51, v24
    v_fmac_f32 v29, s51, v25
    v_fmac_f32 v30, s51, v26
    v_fmac_f32 v31, s51, v27
    v_mul_f32 v24, v152, v28
    v_mul_f32 v25, v153, v29
    v_mul_f32 v26, v154, v30
    v_mul_f32 v27, v155, v31
    v_exp_f32 v24, v24
    v_exp_f32 v25, v25
    v_exp_f32 v26, v26
    v_exp_f32 v27, v27
    v_add_f32 v24, 1.0, v24
    v_add_f32 v25, 1.0, v25
    v_add_f32 v26, 1.0, v26
    v_add_f32 v27, 1.0, v27
    v_rcp_f32 v24, v24
    v_rcp_f32 v25, v25
    v_rcp_f32 v26, v26
    v_rcp_f32 v27, v27
    v_mul_f32 v24, v24, v152
    v_mul_f32 v25, v25, v153
    v_mul_f32 v26, v26, v154
    v_mul_f32 v27, v27, v155
    v_mul_f32 v24, v24, v208
    v_mul_f32 v25, v25, v209
    v_mul_f32 v26, v26, v210
    v_mul_f32 v27, v27, v211
    v_cvt_pk_bf16_f32 v28, v24, v25
    v_cvt_pk_bf16_f32 v29, v26, v27
    s_mov_b32 s49, 57344
    buffer_store_dwordx2 v[28:29], v240, s[28:31], s49 offen offset:160
    v_mul_f32 v16, v160, v160
    v_mul_f32 v17, v161, v161
    v_mul_f32 v18, v162, v162
    v_mul_f32 v19, v163, v163
    v_mov_b32 v20, s50
    v_mov_b32 v21, s50
    v_mov_b32 v22, s50
    v_mov_b32 v23, s50
    v_fmac_f32 v20, s51, v16
    v_fmac_f32 v21, s51, v17
    v_fmac_f32 v22, s51, v18
    v_fmac_f32 v23, s51, v19
    v_mul_f32 v16, v160, v20
    v_mul_f32 v17, v161, v21
    v_mul_f32 v18, v162, v22
    v_mul_f32 v19, v163, v23
    v_exp_f32 v16, v16
    v_exp_f32 v17, v17
    v_exp_f32 v18, v18
    v_exp_f32 v19, v19
    v_add_f32 v16, 1.0, v16
    v_add_f32 v17, 1.0, v17
    v_add_f32 v18, 1.0, v18
    v_add_f32 v19, 1.0, v19
    v_rcp_f32 v16, v16
    v_rcp_f32 v17, v17
    v_rcp_f32 v18, v18
    v_rcp_f32 v19, v19
    v_mul_f32 v16, v16, v160
    v_mul_f32 v17, v17, v161
    v_mul_f32 v18, v18, v162
    v_mul_f32 v19, v19, v163
    v_mul_f32 v16, v16, v216
    v_mul_f32 v17, v17, v217
    v_mul_f32 v18, v18, v218
    v_mul_f32 v19, v19, v219
    v_cvt_pk_bf16_f32 v20, v16, v17
    v_cvt_pk_bf16_f32 v21, v18, v19
    s_mov_b32 s49, 57344
    buffer_store_dwordx2 v[20:21], v240, s[28:31], s49 offen offset:192
k3_end:
    s_endpgm
.globl k4_kernel
.type k4_kernel,@function
.p2align 8
k4_kernel:
    s_cmp_ge_u32 s2, 256
    s_cbranch_scc1 k4_kernel_end
    s_load_dwordx2 s[8:9], s[0:1], 88
    s_load_dwordx2 s[4:5], s[0:1], 48
    s_load_dwordx2 s[6:7], s[0:1], 72
    v_lshrrev_b32 v1, 6, v0
    s_nop 0
    v_readfirstlane_b32 s32, v1
    s_and_b32 s33, s2, 7
    s_lshr_b32 s34, s2, 3
    s_and_b32 s34, s34, 3
    s_lshl_b32 s34, s34, 3
    s_add_u32 s33, s33, s34
    s_lshr_b32 s34, s2, 5
    s_lshl_b32 s35, s33, 6
    v_and_b32 v4, 63, v0
    v_and_b32 v5, 15, v0
    v_bfe_u32 v6, v0, 4, 2
    s_waitcnt lgkmcnt(0)
    s_add_u32 s16, s8, 8388608
    s_addc_u32 s17, s9, 0
    s_mov_b32 s18, 7340032
    s_mov_b32 s19, 0x20000
    s_mov_b32 s20, s4
    s_mov_b32 s21, s5
    s_mov_b32 s22, 1835008
    s_mov_b32 s23, 0x20000
    s_add_u32 s24, s8, 4194304
    s_addc_u32 s25, s9, 0
    s_mov_b32 s26, 2097152
    s_mov_b32 s27, 0x20000
    s_mov_b32 s28, s6
    s_mov_b32 s29, s7
    s_mov_b32 s30, 2097152
    s_mov_b32 s31, 0x20000
    s_mov_b32 s40, s8
    s_mov_b32 s41, s9
    s_mov_b32 s42, 12288
    s_mov_b32 s43, 0x20000
    s_cmp_lt_u32 s32, 2
    s_cselect_b32 s12, s16, s20
    s_cselect_b32 s13, s17, s21
    s_cselect_b32 s14, s18, s22
    s_mov_b32 s15, 0x20000
    s_and_b32 s44, s32, 1
    s_lshl_b32 s44, s44, 2
    s_cmp_lt_u32 s32, 2
    s_movk_i32 s45, 128
    s_cselect_b32 s45, s45, 65536
    s_cselect_b32 s46, 0, 8192
    s_add_u32 s47, s44, 0
    s_lshl_b32 s48, s47, 3
    s_add_u32 s49, s48, s35
    s_mul_i32 s49, s49, 3584
    s_lshl_b32 s50, s48, 10
    s_lshl_b32 s51, s34, 7
    s_add_u32 s50, s50, s51
    s_cmp_lt_u32 s32, 2
    s_cselect_b32 s52, s49, s50
    s_lshl_b32 s47, s47, 10
    s_add_u32 s56, s47, s46
    s_add_u32 s47, s44, 1
    s_lshl_b32 s48, s47, 3
    s_add_u32 s49, s48, s35
    s_mul_i32 s49, s49, 3584
    s_lshl_b32 s50, s48, 10
    s_lshl_b32 s51, s34, 7
    s_add_u32 s50, s50, s51
    s_cmp_lt_u32 s32, 2
    s_cselect_b32 s53, s49, s50
    s_lshl_b32 s47, s47, 10
    s_add_u32 s57, s47, s46
    s_add_u32 s47, s44, 2
    s_lshl_b32 s48, s47, 3
    s_add_u32 s49, s48, s35
    s_mul_i32 s49, s49, 3584
    s_lshl_b32 s50, s48, 10
    s_lshl_b32 s51, s34, 7
    s_add_u32 s50, s50, s51
    s_cmp_lt_u32 s32, 2
    s_cselect_b32 s54, s49, s50
    s_lshl_b32 s47, s47, 10
    s_add_u32 s58, s47, s46
    s_add_u32 s47, s44, 3
    s_lshl_b32 s48, s47, 3
    s_add_u32 s49, s48, s35
    s_mul_i32 s49, s49, 3584
    s_lshl_b32 s50, s48, 10
    s_lshl_b32 s51, s34, 7
    s_add_u32 s50, s50, s51
    s_cmp_lt_u32 s32, 2
    s_cselect_b32 s55, s49, s50
    s_lshl_b32 s47, s47, 10
    s_add_u32 s59, s47, s46
    v_lshrrev_b32 v7, 3, v4
    v_and_b32 v8, 7, v4
    v_lshrrev_b32 v9, 4, v4
    v_and_b32 v9, 7, v9
    v_xor_b32 v9, v8, v9
    v_lshlrev_b32 v9, 4, v9
    v_mul_u32_u24 v10, 3584, v7
    v_add_u32 v9, v9, v10
    v_and_b32 v10, 2, v7
    v_xor_b32 v10, v8, v10
    v_lshlrev_b32 v10, 4, v10
    v_lshl_add_u32 v10, v7, 10, v10
    s_cmp_lt_u32 s32, 2
    s_cselect_b64 vcc, -1, 0
    v_cndmask_b32 v112, v10, v9, vcc
    v_lshrrev_b32 v9, 4, v4
    v_add_u32 v9, 4, v9
    v_and_b32 v9, 7, v9
    v_xor_b32 v9, v8, v9
    v_lshlrev_b32 v9, 4, v9
    v_mul_u32_u24 v10, 3584, v7
    v_add_u32 v9, v9, v10
    v_and_b32 v10, 2, v7
    v_or_b32 v10, 4, v10
    v_xor_b32 v10, v8, v10
    v_lshlrev_b32 v10, 4, v10
    v_lshl_add_u32 v10, v7, 10, v10
    s_cmp_lt_u32 s32, 2
    s_cselect_b64 vcc, -1, 0
    v_cndmask_b32 v113, v10, v9, vcc
    s_lshr_b32 s47, s32, 1
    s_lshl_b32 s47, s47, 5
    v_add_u32 v7, s47, v5
    v_lshlrev_b32 v7, 7, v7
    v_lshrrev_b32 v8, 1, v5
    v_and_b32 v8, 7, v8
    v_xor_b32 v8, v6, v8
    v_lshl_add_u32 v114, v8, 4, v7
    v_xor_b32 v115, 64, v114
    v_lshrrev_b32 v7, 2, v5
    v_lshl_add_u32 v7, v6, 3, v7
    v_lshlrev_b32 v7, 7, v7
    v_bfe_u32 v8, v5, 3, 1
    v_lshlrev_b32 v8, 1, v8
    v_and_b32 v9, 1, v6
    v_lshl_or_b32 v8, v9, 2, v8
    v_bfe_u32 v9, v5, 1, 1
    s_and_b32 s47, s32, 1
    s_lshl_b32 s47, s47, 2
    v_add_u32 v9, s47, v9
    v_xor_b32 v8, v8, v9
    v_lshl_add_u32 v7, v8, 4, v7
    v_and_b32 v9, 1, v5
    v_lshl_add_u32 v7, v9, 3, v7
    v_add_u32 v116, 8192, v7
    v_xor_b32 v117, 32, v116
    v_add_u32 v120, 0x10000, v114
    v_add_u32 v122, 0x10000, v116
    v_add_u32 v121, 0x10000, v115
    v_add_u32 v123, 0x10000, v117
    s_lshr_b32 s47, s32, 1
    s_lshl_b32 s47, s47, 5
    s_add_u32 s47, s47, s35
    v_add_u32 v7, s47, v5
    v_lshlrev_b32 v8, 10, v7
    s_and_b32 s48, s32, 1
    s_lshl_b32 s48, s48, 5
    s_lshl_b32 s49, s34, 6
    s_add_u32 s48, s48, s49
    v_lshl_add_u32 v9, v6, 2, s48
    v_lshl_add_u32 v118, v9, 1, v8
    s_lshl_b32 s48, s34, 1
    s_and_b32 s49, s32, 1
    s_add_u32 s48, s48, s49
    v_lshl_add_u32 v10, v7, 4, s48
    v_lshlrev_b32 v119, 3, v10
    v_lshlrev_b32 v10, 2, v9
    s_mov_b32 s47, 10240
    buffer_load_dwordx4 v[88:91], v10, s[40:43], s47 offen
    buffer_load_dwordx4 v[92:95], v10, s[40:43], s47 offen offset:64
    s_mov_b32 s47, 0
    buffer_load_dwordx2 v[80:81], v118, s[24:27], s47 offen offset:0
    s_mov_b32 s47, 16384
    buffer_load_dwordx2 v[82:83], v118, s[24:27], s47 offen offset:0
    s_mov_b32 s47, 0
    buffer_load_dwordx2 v[84:85], v118, s[24:27], s47 offen offset:32
    s_mov_b32 s47, 16384
    buffer_load_dwordx2 v[86:87], v118, s[24:27], s47 offen offset:32
    s_add_u32 m0, s56, 0
    s_nop 0
    buffer_load_dwordx4 v112, s[12:15], s52 offen lds
    s_add_u32 s52, s52, s45
    s_add_u32 m0, s57, 0
    s_nop 0
    buffer_load_dwordx4 v113, s[12:15], s53 offen lds
    s_add_u32 s53, s53, s45
    s_add_u32 m0, s58, 0
    s_nop 0
    buffer_load_dwordx4 v112, s[12:15], s54 offen lds
    s_add_u32 s54, s54, s45
    s_add_u32 m0, s59, 0
    s_nop 0
    buffer_load_dwordx4 v113, s[12:15], s55 offen lds
    s_add_u32 s55, s55, s45
    s_add_u32 m0, s56, 16384
    s_nop 0
    buffer_load_dwordx4 v112, s[12:15], s52 offen lds
    s_add_u32 s52, s52, s45
    s_add_u32 m0, s57, 16384
    s_nop 0
    buffer_load_dwordx4 v113, s[12:15], s53 offen lds
    s_add_u32 s53, s53, s45
    s_add_u32 m0, s58, 16384
    s_nop 0
    buffer_load_dwordx4 v112, s[12:15], s54 offen lds
    s_add_u32 s54, s54, s45
    s_add_u32 m0, s59, 16384
    s_nop 0
    buffer_load_dwordx4 v113, s[12:15], s55 offen lds
    s_add_u32 s55, s55, s45
    s_add_u32 m0, s56, 32768
    s_nop 0
    buffer_load_dwordx4 v112, s[12:15], s52 offen lds
    s_add_u32 s52, s52, s45
    s_add_u32 m0, s57, 32768
    s_nop 0
    buffer_load_dwordx4 v113, s[12:15], s53 offen lds
    s_add_u32 s53, s53, s45
    s_add_u32 m0, s58, 32768
    s_nop 0
    buffer_load_dwordx4 v112, s[12:15], s54 offen lds
    s_add_u32 s54, s54, s45
    s_add_u32 m0, s59, 32768
    s_nop 0
    buffer_load_dwordx4 v113, s[12:15], s55 offen lds
    s_add_u32 s55, s55, s45
    s_add_u32 m0, s56, 49152
    s_nop 0
    buffer_load_dwordx4 v112, s[12:15], s52 offen lds
    s_add_u32 s52, s52, s45
    s_add_u32 m0, s57, 49152
    s_nop 0
    buffer_load_dwordx4 v113, s[12:15], s53 offen lds
    s_add_u32 s53, s53, s45
    s_add_u32 m0, s58, 49152
    s_nop 0
    buffer_load_dwordx4 v112, s[12:15], s54 offen lds
    s_add_u32 s54, s54, s45
    s_add_u32 m0, s59, 49152
    s_nop 0
    buffer_load_dwordx4 v113, s[12:15], s55 offen lds
    s_add_u32 s55, s55, s45
    s_add_u32 m0, s56, 65536
    s_nop 0
    buffer_load_dwordx4 v112, s[12:15], s52 offen lds
    s_add_u32 s52, s52, s45
    s_add_u32 m0, s57, 65536
    s_nop 0
    buffer_load_dwordx4 v113, s[12:15], s53 offen lds
    s_add_u32 s53, s53, s45
    s_add_u32 m0, s58, 65536
    s_nop 0
    buffer_load_dwordx4 v112, s[12:15], s54 offen lds
    s_add_u32 s54, s54, s45
    s_add_u32 m0, s59, 65536
    s_nop 0
    buffer_load_dwordx4 v113, s[12:15], s55 offen lds
    s_add_u32 s55, s55, s45
    s_add_u32 m0, s56, 81920
    s_nop 0
    buffer_load_dwordx4 v112, s[12:15], s52 offen lds
    s_add_u32 s52, s52, s45
    s_add_u32 m0, s57, 81920
    s_nop 0
    buffer_load_dwordx4 v113, s[12:15], s53 offen lds
    s_add_u32 s53, s53, s45
    s_add_u32 m0, s58, 81920
    s_nop 0
    buffer_load_dwordx4 v112, s[12:15], s54 offen lds
    s_add_u32 s54, s54, s45
    s_add_u32 m0, s59, 81920
    s_nop 0
    buffer_load_dwordx4 v113, s[12:15], s55 offen lds
    s_add_u32 s55, s55, s45
    s_waitcnt vmcnt(16)
    s_barrier
    ds_read_b128 v[16:19], v114 offset:0
    ds_read_b128 v[20:23], v114 offset:2048
    ds_read_b64_tr_b16 v[24:25], v116 offset:0
    ds_read_b64_tr_b16 v[26:27], v116 offset:512
    ds_read_b64_tr_b16 v[28:29], v117 offset:0
    ds_read_b64_tr_b16 v[30:31], v117 offset:512
    ds_read_b128 v[40:43], v115 offset:0
    ds_read_b128 v[44:47], v115 offset:2048
    ds_read_b64_tr_b16 v[48:49], v116 offset:4096
    ds_read_b64_tr_b16 v[50:51], v116 offset:4608
    ds_read_b64_tr_b16 v[52:53], v117 offset:4096
    ds_read_b64_tr_b16 v[54:55], v117 offset:4608
    s_waitcnt lgkmcnt(6)
    v_mfma_f32_16x16x32_bf16 v[64:67], v[24:27], v[16:19], 0
    v_mfma_f32_16x16x32_bf16 v[68:71], v[24:27], v[20:23], 0
    v_mfma_f32_16x16x32_bf16 v[72:75], v[28:31], v[16:19], 0
    v_mfma_f32_16x16x32_bf16 v[76:79], v[28:31], v[20:23], 0
    ds_read_b128 v[16:19], v114 offset:16384
    ds_read_b128 v[20:23], v114 offset:18432
    ds_read_b64_tr_b16 v[24:25], v116 offset:16384
    ds_read_b64_tr_b16 v[26:27], v116 offset:16896
    ds_read_b64_tr_b16 v[28:29], v117 offset:16384
    ds_read_b64_tr_b16 v[30:31], v117 offset:16896
    s_waitcnt lgkmcnt(6)
    v_mfma_f32_16x16x32_bf16 v[64:67], v[48:51], v[40:43], v[64:67]
    v_mfma_f32_16x16x32_bf16 v[68:71], v[48:51], v[44:47], v[68:71]
    v_mfma_f32_16x16x32_bf16 v[72:75], v[52:55], v[40:43], v[72:75]
    v_mfma_f32_16x16x32_bf16 v[76:79], v[52:55], v[44:47], v[76:79]
    ds_read_b128 v[40:43], v115 offset:16384
    ds_read_b128 v[44:47], v115 offset:18432
    ds_read_b64_tr_b16 v[48:49], v116 offset:20480
    ds_read_b64_tr_b16 v[50:51], v116 offset:20992
    ds_read_b64_tr_b16 v[52:53], v117 offset:20480
    ds_read_b64_tr_b16 v[54:55], v117 offset:20992
    s_waitcnt lgkmcnt(6)
    v_mfma_f32_16x16x32_bf16 v[64:67], v[24:27], v[16:19], v[64:67]
    v_mfma_f32_16x16x32_bf16 v[68:71], v[24:27], v[20:23], v[68:71]
    v_mfma_f32_16x16x32_bf16 v[72:75], v[28:31], v[16:19], v[72:75]
    v_mfma_f32_16x16x32_bf16 v[76:79], v[28:31], v[20:23], v[76:79]
    s_waitcnt vmcnt(8)
    s_barrier
    s_add_u32 m0, s56, 98304
    s_nop 0
    buffer_load_dwordx4 v112, s[12:15], s52 offen lds
    s_add_u32 s52, s52, s45
    s_add_u32 m0, s57, 98304
    s_nop 0
    buffer_load_dwordx4 v113, s[12:15], s53 offen lds
    s_add_u32 s53, s53, s45
    s_add_u32 m0, s58, 98304
    s_nop 0
    buffer_load_dwordx4 v112, s[12:15], s54 offen lds
    s_add_u32 s54, s54, s45
    s_add_u32 m0, s59, 98304
    s_nop 0
    buffer_load_dwordx4 v113, s[12:15], s55 offen lds
    s_add_u32 s55, s55, s45
    s_add_u32 m0, s56, 114688
    s_nop 0
    buffer_load_dwordx4 v112, s[12:15], s52 offen lds
    s_add_u32 s52, s52, s45
    s_add_u32 m0, s57, 114688
    s_nop 0
    buffer_load_dwordx4 v113, s[12:15], s53 offen lds
    s_add_u32 s53, s53, s45
    s_add_u32 m0, s58, 114688
    s_nop 0
    buffer_load_dwordx4 v112, s[12:15], s54 offen lds
    s_add_u32 s54, s54, s45
    s_add_u32 m0, s59, 114688
    s_nop 0
    buffer_load_dwordx4 v113, s[12:15], s55 offen lds
    s_add_u32 s55, s55, s45
    ds_read_b128 v[16:19], v114 offset:32768
    ds_read_b128 v[20:23], v114 offset:34816
    ds_read_b64_tr_b16 v[24:25], v116 offset:32768
    ds_read_b64_tr_b16 v[26:27], v116 offset:33280
    ds_read_b64_tr_b16 v[28:29], v117 offset:32768
    ds_read_b64_tr_b16 v[30:31], v117 offset:33280
    s_waitcnt lgkmcnt(6)
    v_mfma_f32_16x16x32_bf16 v[64:67], v[48:51], v[40:43], v[64:67]
    v_mfma_f32_16x16x32_bf16 v[68:71], v[48:51], v[44:47], v[68:71]
    v_mfma_f32_16x16x32_bf16 v[72:75], v[52:55], v[40:43], v[72:75]
    v_mfma_f32_16x16x32_bf16 v[76:79], v[52:55], v[44:47], v[76:79]
    ds_read_b128 v[40:43], v115 offset:32768
    ds_read_b128 v[44:47], v115 offset:34816
    ds_read_b64_tr_b16 v[48:49], v116 offset:36864
    ds_read_b64_tr_b16 v[50:51], v116 offset:37376
    ds_read_b64_tr_b16 v[52:53], v117 offset:36864
    ds_read_b64_tr_b16 v[54:55], v117 offset:37376
    s_waitcnt lgkmcnt(6)
    v_mfma_f32_16x16x32_bf16 v[64:67], v[24:27], v[16:19], v[64:67]
    v_mfma_f32_16x16x32_bf16 v[68:71], v[24:27], v[20:23], v[68:71]
    v_mfma_f32_16x16x32_bf16 v[72:75], v[28:31], v[16:19], v[72:75]
    v_mfma_f32_16x16x32_bf16 v[76:79], v[28:31], v[20:23], v[76:79]
    ds_read_b128 v[16:19], v114 offset:49152
    ds_read_b128 v[20:23], v114 offset:51200
    ds_read_b64_tr_b16 v[24:25], v116 offset:49152
    ds_read_b64_tr_b16 v[26:27], v116 offset:49664
    ds_read_b64_tr_b16 v[28:29], v117 offset:49152
    ds_read_b64_tr_b16 v[30:31], v117 offset:49664
    s_waitcnt lgkmcnt(6)
    v_mfma_f32_16x16x32_bf16 v[64:67], v[48:51], v[40:43], v[64:67]
    v_mfma_f32_16x16x32_bf16 v[68:71], v[48:51], v[44:47], v[68:71]
    v_mfma_f32_16x16x32_bf16 v[72:75], v[52:55], v[40:43], v[72:75]
    v_mfma_f32_16x16x32_bf16 v[76:79], v[52:55], v[44:47], v[76:79]
    ds_read_b128 v[40:43], v115 offset:49152
    ds_read_b128 v[44:47], v115 offset:51200
    ds_read_b64_tr_b16 v[48:49], v116 offset:53248
    ds_read_b64_tr_b16 v[50:51], v116 offset:53760
    ds_read_b64_tr_b16 v[52:53], v117 offset:53248
    ds_read_b64_tr_b16 v[54:55], v117 offset:53760
    s_waitcnt lgkmcnt(6)
    v_mfma_f32_16x16x32_bf16 v[64:67], v[24:27], v[16:19], v[64:67]
    v_mfma_f32_16x16x32_bf16 v[68:71], v[24:27], v[20:23], v[68:71]
    v_mfma_f32_16x16x32_bf16 v[72:75], v[28:31], v[16:19], v[72:75]
    v_mfma_f32_16x16x32_bf16 v[76:79], v[28:31], v[20:23], v[76:79]
    s_waitcnt vmcnt(8)
    s_barrier
    s_add_u32 m0, s56, 0
    s_nop 0
    buffer_load_dwordx4 v112, s[12:15], s52 offen lds
    s_add_u32 s52, s52, s45
    s_add_u32 m0, s57, 0
    s_nop 0
    buffer_load_dwordx4 v113, s[12:15], s53 offen lds
    s_add_u32 s53, s53, s45
    s_add_u32 m0, s58, 0
    s_nop 0
    buffer_load_dwordx4 v112, s[12:15], s54 offen lds
    s_add_u32 s54, s54, s45
    s_add_u32 m0, s59, 0
    s_nop 0
    buffer_load_dwordx4 v113, s[12:15], s55 offen lds
    s_add_u32 s55, s55, s45
    s_add_u32 m0, s56, 16384
    s_nop 0
    buffer_load_dwordx4 v112, s[12:15], s52 offen lds
    s_add_u32 s52, s52, s45
    s_add_u32 m0, s57, 16384
    s_nop 0
    buffer_load_dwordx4 v113, s[12:15], s53 offen lds
    s_add_u32 s53, s53, s45
    s_add_u32 m0, s58, 16384
    s_nop 0
    buffer_load_dwordx4 v112, s[12:15], s54 offen lds
    s_add_u32 s54, s54, s45
    s_add_u32 m0, s59, 16384
    s_nop 0
    buffer_load_dwordx4 v113, s[12:15], s55 offen lds
    s_add_u32 s55, s55, s45
    ds_read_b128 v[16:19], v120 offset:0
    ds_read_b128 v[20:23], v120 offset:2048
    ds_read_b64_tr_b16 v[24:25], v122 offset:0
    ds_read_b64_tr_b16 v[26:27], v122 offset:512
    ds_read_b64_tr_b16 v[28:29], v123 offset:0
    ds_read_b64_tr_b16 v[30:31], v123 offset:512
    s_waitcnt lgkmcnt(6)
    v_mfma_f32_16x16x32_bf16 v[64:67], v[48:51], v[40:43], v[64:67]
    v_mfma_f32_16x16x32_bf16 v[68:71], v[48:51], v[44:47], v[68:71]
    v_mfma_f32_16x16x32_bf16 v[72:75], v[52:55], v[40:43], v[72:75]
    v_mfma_f32_16x16x32_bf16 v[76:79], v[52:55], v[44:47], v[76:79]
    ds_read_b128 v[40:43], v121 offset:0
    ds_read_b128 v[44:47], v121 offset:2048
    ds_read_b64_tr_b16 v[48:49], v122 offset:4096
    ds_read_b64_tr_b16 v[50:51], v122 offset:4608
    ds_read_b64_tr_b16 v[52:53], v123 offset:4096
    ds_read_b64_tr_b16 v[54:55], v123 offset:4608
    s_waitcnt lgkmcnt(6)
    v_mfma_f32_16x16x32_bf16 v[64:67], v[24:27], v[16:19], v[64:67]
    v_mfma_f32_16x16x32_bf16 v[68:71], v[24:27], v[20:23], v[68:71]
    v_mfma_f32_16x16x32_bf16 v[72:75], v[28:31], v[16:19], v[72:75]
    v_mfma_f32_16x16x32_bf16 v[76:79], v[28:31], v[20:23], v[76:79]
    ds_read_b128 v[16:19], v120 offset:16384
    ds_read_b128 v[20:23], v120 offset:18432
    ds_read_b64_tr_b16 v[24:25], v122 offset:16384
    ds_read_b64_tr_b16 v[26:27], v122 offset:16896
    ds_read_b64_tr_b16 v[28:29], v123 offset:16384
    ds_read_b64_tr_b16 v[30:31], v123 offset:16896
    s_waitcnt lgkmcnt(6)
    v_mfma_f32_16x16x32_bf16 v[64:67], v[48:51], v[40:43], v[64:67]
    v_mfma_f32_16x16x32_bf16 v[68:71], v[48:51], v[44:47], v[68:71]
    v_mfma_f32_16x16x32_bf16 v[72:75], v[52:55], v[40:43], v[72:75]
    v_mfma_f32_16x16x32_bf16 v[76:79], v[52:55], v[44:47], v[76:79]
    ds_read_b128 v[40:43], v121 offset:16384
    ds_read_b128 v[44:47], v121 offset:18432
    ds_read_b64_tr_b16 v[48:49], v122 offset:20480
    ds_read_b64_tr_b16 v[50:51], v122 offset:20992
    ds_read_b64_tr_b16 v[52:53], v123 offset:20480
    ds_read_b64_tr_b16 v[54:55], v123 offset:20992
    s_waitcnt lgkmcnt(6)
    v_mfma_f32_16x16x32_bf16 v[64:67], v[24:27], v[16:19], v[64:67]
    v_mfma_f32_16x16x32_bf16 v[68:71], v[24:27], v[20:23], v[68:71]
    v_mfma_f32_16x16x32_bf16 v[72:75], v[28:31], v[16:19], v[72:75]
    v_mfma_f32_16x16x32_bf16 v[76:79], v[28:31], v[20:23], v[76:79]
    s_waitcnt vmcnt(8)
    s_barrier
    s_add_u32 m0, s56, 32768
    s_nop 0
    buffer_load_dwordx4 v112, s[12:15], s52 offen lds
    s_add_u32 s52, s52, s45
    s_add_u32 m0, s57, 32768
    s_nop 0
    buffer_load_dwordx4 v113, s[12:15], s53 offen lds
    s_add_u32 s53, s53, s45
    s_add_u32 m0, s58, 32768
    s_nop 0
    buffer_load_dwordx4 v112, s[12:15], s54 offen lds
    s_add_u32 s54, s54, s45
    s_add_u32 m0, s59, 32768
    s_nop 0
    buffer_load_dwordx4 v113, s[12:15], s55 offen lds
    s_add_u32 s55, s55, s45
    s_add_u32 m0, s56, 49152
    s_nop 0
    buffer_load_dwordx4 v112, s[12:15], s52 offen lds
    s_add_u32 s52, s52, s45
    s_add_u32 m0, s57, 49152
    s_nop 0
    buffer_load_dwordx4 v113, s[12:15], s53 offen lds
    s_add_u32 s53, s53, s45
    s_add_u32 m0, s58, 49152
    s_nop 0
    buffer_load_dwordx4 v112, s[12:15], s54 offen lds
    s_add_u32 s54, s54, s45
    s_add_u32 m0, s59, 49152
    s_nop 0
    buffer_load_dwordx4 v113, s[12:15], s55 offen lds
    s_add_u32 s55, s55, s45
    ds_read_b128 v[16:19], v120 offset:32768
    ds_read_b128 v[20:23], v120 offset:34816
    ds_read_b64_tr_b16 v[24:25], v122 offset:32768
    ds_read_b64_tr_b16 v[26:27], v122 offset:33280
    ds_read_b64_tr_b16 v[28:29], v123 offset:32768
    ds_read_b64_tr_b16 v[30:31], v123 offset:33280
    s_waitcnt lgkmcnt(6)
    v_mfma_f32_16x16x32_bf16 v[64:67], v[48:51], v[40:43], v[64:67]
    v_mfma_f32_16x16x32_bf16 v[68:71], v[48:51], v[44:47], v[68:71]
    v_mfma_f32_16x16x32_bf16 v[72:75], v[52:55], v[40:43], v[72:75]
    v_mfma_f32_16x16x32_bf16 v[76:79], v[52:55], v[44:47], v[76:79]
    ds_read_b128 v[40:43], v121 offset:32768
    ds_read_b128 v[44:47], v121 offset:34816
    ds_read_b64_tr_b16 v[48:49], v122 offset:36864
    ds_read_b64_tr_b16 v[50:51], v122 offset:37376
    ds_read_b64_tr_b16 v[52:53], v123 offset:36864
    ds_read_b64_tr_b16 v[54:55], v123 offset:37376
    s_waitcnt lgkmcnt(6)
    v_mfma_f32_16x16x32_bf16 v[64:67], v[24:27], v[16:19], v[64:67]
    v_mfma_f32_16x16x32_bf16 v[68:71], v[24:27], v[20:23], v[68:71]
    v_mfma_f32_16x16x32_bf16 v[72:75], v[28:31], v[16:19], v[72:75]
    v_mfma_f32_16x16x32_bf16 v[76:79], v[28:31], v[20:23], v[76:79]
    ds_read_b128 v[16:19], v120 offset:49152
    ds_read_b128 v[20:23], v120 offset:51200
    ds_read_b64_tr_b16 v[24:25], v122 offset:49152
    ds_read_b64_tr_b16 v[26:27], v122 offset:49664
    ds_read_b64_tr_b16 v[28:29], v123 offset:49152
    ds_read_b64_tr_b16 v[30:31], v123 offset:49664
    s_waitcnt lgkmcnt(6)
    v_mfma_f32_16x16x32_bf16 v[64:67], v[48:51], v[40:43], v[64:67]
    v_mfma_f32_16x16x32_bf16 v[68:71], v[48:51], v[44:47], v[68:71]
    v_mfma_f32_16x16x32_bf16 v[72:75], v[52:55], v[40:43], v[72:75]
    v_mfma_f32_16x16x32_bf16 v[76:79], v[52:55], v[44:47], v[76:79]
    ds_read_b128 v[40:43], v121 offset:49152
    ds_read_b128 v[44:47], v121 offset:51200
    ds_read_b64_tr_b16 v[48:49], v122 offset:53248
    ds_read_b64_tr_b16 v[50:51], v122 offset:53760
    ds_read_b64_tr_b16 v[52:53], v123 offset:53248
    ds_read_b64_tr_b16 v[54:55], v123 offset:53760
    s_waitcnt lgkmcnt(6)
    v_mfma_f32_16x16x32_bf16 v[64:67], v[24:27], v[16:19], v[64:67]
    v_mfma_f32_16x16x32_bf16 v[68:71], v[24:27], v[20:23], v[68:71]
    v_mfma_f32_16x16x32_bf16 v[72:75], v[28:31], v[16:19], v[72:75]
    v_mfma_f32_16x16x32_bf16 v[76:79], v[28:31], v[20:23], v[76:79]
    s_waitcnt vmcnt(8)
    s_barrier
    s_add_u32 m0, s56, 65536
    s_nop 0
    buffer_load_dwordx4 v112, s[12:15], s52 offen lds
    s_add_u32 s52, s52, s45
    s_add_u32 m0, s57, 65536
    s_nop 0
    buffer_load_dwordx4 v113, s[12:15], s53 offen lds
    s_add_u32 s53, s53, s45
    s_add_u32 m0, s58, 65536
    s_nop 0
    buffer_load_dwordx4 v112, s[12:15], s54 offen lds
    s_add_u32 s54, s54, s45
    s_add_u32 m0, s59, 65536
    s_nop 0
    buffer_load_dwordx4 v113, s[12:15], s55 offen lds
    s_add_u32 s55, s55, s45
    s_add_u32 m0, s56, 81920
    s_nop 0
    buffer_load_dwordx4 v112, s[12:15], s52 offen lds
    s_add_u32 s52, s52, s45
    s_add_u32 m0, s57, 81920
    s_nop 0
    buffer_load_dwordx4 v113, s[12:15], s53 offen lds
    s_add_u32 s53, s53, s45
    s_add_u32 m0, s58, 81920
    s_nop 0
    buffer_load_dwordx4 v112, s[12:15], s54 offen lds
    s_add_u32 s54, s54, s45
    s_add_u32 m0, s59, 81920
    s_nop 0
    buffer_load_dwordx4 v113, s[12:15], s55 offen lds
    s_add_u32 s55, s55, s45
    ds_read_b128 v[16:19], v114 offset:0
    ds_read_b128 v[20:23], v114 offset:2048
    ds_read_b64_tr_b16 v[24:25], v116 offset:0
    ds_read_b64_tr_b16 v[26:27], v116 offset:512
    ds_read_b64_tr_b16 v[28:29], v117 offset:0
    ds_read_b64_tr_b16 v[30:31], v117 offset:512
    s_waitcnt lgkmcnt(6)
    v_mfma_f32_16x16x32_bf16 v[64:67], v[48:51], v[40:43], v[64:67]
    v_mfma_f32_16x16x32_bf16 v[68:71], v[48:51], v[44:47], v[68:71]
    v_mfma_f32_16x16x32_bf16 v[72:75], v[52:55], v[40:43], v[72:75]
    v_mfma_f32_16x16x32_bf16 v[76:79], v[52:55], v[44:47], v[76:79]
    ds_read_b128 v[40:43], v115 offset:0
    ds_read_b128 v[44:47], v115 offset:2048
    ds_read_b64_tr_b16 v[48:49], v116 offset:4096
    ds_read_b64_tr_b16 v[50:51], v116 offset:4608
    ds_read_b64_tr_b16 v[52:53], v117 offset:4096
    ds_read_b64_tr_b16 v[54:55], v117 offset:4608
    s_waitcnt lgkmcnt(6)
    v_mfma_f32_16x16x32_bf16 v[64:67], v[24:27], v[16:19], v[64:67]
    v_mfma_f32_16x16x32_bf16 v[68:71], v[24:27], v[20:23], v[68:71]
    v_mfma_f32_16x16x32_bf16 v[72:75], v[28:31], v[16:19], v[72:75]
    v_mfma_f32_16x16x32_bf16 v[76:79], v[28:31], v[20:23], v[76:79]
    ds_read_b128 v[16:19], v114 offset:16384
    ds_read_b128 v[20:23], v114 offset:18432
    ds_read_b64_tr_b16 v[24:25], v116 offset:16384
    ds_read_b64_tr_b16 v[26:27], v116 offset:16896
    ds_read_b64_tr_b16 v[28:29], v117 offset:16384
    ds_read_b64_tr_b16 v[30:31], v117 offset:16896
    s_waitcnt lgkmcnt(6)
    v_mfma_f32_16x16x32_bf16 v[64:67], v[48:51], v[40:43], v[64:67]
    v_mfma_f32_16x16x32_bf16 v[68:71], v[48:51], v[44:47], v[68:71]
    v_mfma_f32_16x16x32_bf16 v[72:75], v[52:55], v[40:43], v[72:75]
    v_mfma_f32_16x16x32_bf16 v[76:79], v[52:55], v[44:47], v[76:79]
    ds_read_b128 v[40:43], v115 offset:16384
    ds_read_b128 v[44:47], v115 offset:18432
    ds_read_b64_tr_b16 v[48:49], v116 offset:20480
    ds_read_b64_tr_b16 v[50:51], v116 offset:20992
    ds_read_b64_tr_b16 v[52:53], v117 offset:20480
    ds_read_b64_tr_b16 v[54:55], v117 offset:20992
    s_waitcnt lgkmcnt(6)
    v_mfma_f32_16x16x32_bf16 v[64:67], v[24:27], v[16:19], v[64:67]
    v_mfma_f32_16x16x32_bf16 v[68:71], v[24:27], v[20:23], v[68:71]
    v_mfma_f32_16x16x32_bf16 v[72:75], v[28:31], v[16:19], v[72:75]
    v_mfma_f32_16x16x32_bf16 v[76:79], v[28:31], v[20:23], v[76:79]
    s_waitcnt vmcnt(8)
    s_barrier
    s_add_u32 m0, s56, 98304
    s_nop 0
    buffer_load_dwordx4 v112, s[12:15], s52 offen lds
    s_add_u32 s52, s52, s45
    s_add_u32 m0, s57, 98304
    s_nop 0
    buffer_load_dwordx4 v113, s[12:15], s53 offen lds
    s_add_u32 s53, s53, s45
    s_add_u32 m0, s58, 98304
    s_nop 0
    buffer_load_dwordx4 v112, s[12:15], s54 offen lds
    s_add_u32 s54, s54, s45
    s_add_u32 m0, s59, 98304
    s_nop 0
    buffer_load_dwordx4 v113, s[12:15], s55 offen lds
    s_add_u32 s55, s55, s45
    s_add_u32 m0, s56, 114688
    s_nop 0
    buffer_load_dwordx4 v112, s[12:15], s52 offen lds
    s_add_u32 s52, s52, s45
    s_add_u32 m0, s57, 114688
    s_nop 0
    buffer_load_dwordx4 v113, s[12:15], s53 offen lds
    s_add_u32 s53, s53, s45
    s_add_u32 m0, s58, 114688
    s_nop 0
    buffer_load_dwordx4 v112, s[12:15], s54 offen lds
    s_add_u32 s54, s54, s45
    s_add_u32 m0, s59, 114688
    s_nop 0
    buffer_load_dwordx4 v113, s[12:15], s55 offen lds
    s_add_u32 s55, s55, s45
    ds_read_b128 v[16:19], v114 offset:32768
    ds_read_b128 v[20:23], v114 offset:34816
    ds_read_b64_tr_b16 v[24:25], v116 offset:32768
    ds_read_b64_tr_b16 v[26:27], v116 offset:33280
    ds_read_b64_tr_b16 v[28:29], v117 offset:32768
    ds_read_b64_tr_b16 v[30:31], v117 offset:33280
    s_waitcnt lgkmcnt(6)
    v_mfma_f32_16x16x32_bf16 v[64:67], v[48:51], v[40:43], v[64:67]
    v_mfma_f32_16x16x32_bf16 v[68:71], v[48:51], v[44:47], v[68:71]
    v_mfma_f32_16x16x32_bf16 v[72:75], v[52:55], v[40:43], v[72:75]
    v_mfma_f32_16x16x32_bf16 v[76:79], v[52:55], v[44:47], v[76:79]
    ds_read_b128 v[40:43], v115 offset:32768
    ds_read_b128 v[44:47], v115 offset:34816
    ds_read_b64_tr_b16 v[48:49], v116 offset:36864
    ds_read_b64_tr_b16 v[50:51], v116 offset:37376
    ds_read_b64_tr_b16 v[52:53], v117 offset:36864
    ds_read_b64_tr_b16 v[54:55], v117 offset:37376
    s_waitcnt lgkmcnt(6)
    v_mfma_f32_16x16x32_bf16 v[64:67], v[24:27], v[16:19], v[64:67]
    v_mfma_f32_16x16x32_bf16 v[68:71], v[24:27], v[20:23], v[68:71]
    v_mfma_f32_16x16x32_bf16 v[72:75], v[28:31], v[16:19], v[72:75]
    v_mfma_f32_16x16x32_bf16 v[76:79], v[28:31], v[20:23], v[76:79]
    ds_read_b128 v[16:19], v114 offset:49152
    ds_read_b128 v[20:23], v114 offset:51200
    ds_read_b64_tr_b16 v[24:25], v116 offset:49152
    ds_read_b64_tr_b16 v[26:27], v116 offset:49664
    ds_read_b64_tr_b16 v[28:29], v117 offset:49152
    ds_read_b64_tr_b16 v[30:31], v117 offset:49664
    s_waitcnt lgkmcnt(6)
    v_mfma_f32_16x16x32_bf16 v[64:67], v[48:51], v[40:43], v[64:67]
    v_mfma_f32_16x16x32_bf16 v[68:71], v[48:51], v[44:47], v[68:71]
    v_mfma_f32_16x16x32_bf16 v[72:75], v[52:55], v[40:43], v[72:75]
    v_mfma_f32_16x16x32_bf16 v[76:79], v[52:55], v[44:47], v[76:79]
    ds_read_b128 v[40:43], v115 offset:49152
    ds_read_b128 v[44:47], v115 offset:51200
    ds_read_b64_tr_b16 v[48:49], v116 offset:53248
    ds_read_b64_tr_b16 v[50:51], v116 offset:53760
    ds_read_b64_tr_b16 v[52:53], v117 offset:53248
    ds_read_b64_tr_b16 v[54:55], v117 offset:53760
    s_waitcnt lgkmcnt(6)
    v_mfma_f32_16x16x32_bf16 v[64:67], v[24:27], v[16:19], v[64:67]
    v_mfma_f32_16x16x32_bf16 v[68:71], v[24:27], v[20:23], v[68:71]
    v_mfma_f32_16x16x32_bf16 v[72:75], v[28:31], v[16:19], v[72:75]
    v_mfma_f32_16x16x32_bf16 v[76:79], v[28:31], v[20:23], v[76:79]
    s_waitcnt vmcnt(8)
    s_barrier
    s_add_u32 m0, s56, 0
    s_nop 0
    buffer_load_dwordx4 v112, s[12:15], s52 offen lds
    s_add_u32 s52, s52, s45
    s_add_u32 m0, s57, 0
    s_nop 0
    buffer_load_dwordx4 v113, s[12:15], s53 offen lds
    s_add_u32 s53, s53, s45
    s_add_u32 m0, s58, 0
    s_nop 0
    buffer_load_dwordx4 v112, s[12:15], s54 offen lds
    s_add_u32 s54, s54, s45
    s_add_u32 m0, s59, 0
    s_nop 0
    buffer_load_dwordx4 v113, s[12:15], s55 offen lds
    s_add_u32 s55, s55, s45
    s_add_u32 m0, s56, 16384
    s_nop 0
    buffer_load_dwordx4 v112, s[12:15], s52 offen lds
    s_add_u32 s52, s52, s45
    s_add_u32 m0, s57, 16384
    s_nop 0
    buffer_load_dwordx4 v113, s[12:15], s53 offen lds
    s_add_u32 s53, s53, s45
    s_add_u32 m0, s58, 16384
    s_nop 0
    buffer_load_dwordx4 v112, s[12:15], s54 offen lds
    s_add_u32 s54, s54, s45
    s_add_u32 m0, s59, 16384
    s_nop 0
    buffer_load_dwordx4 v113, s[12:15], s55 offen lds
    s_add_u32 s55, s55, s45
    ds_read_b128 v[16:19], v120 offset:0
    ds_read_b128 v[20:23], v120 offset:2048
    ds_read_b64_tr_b16 v[24:25], v122 offset:0
    ds_read_b64_tr_b16 v[26:27], v122 offset:512
    ds_read_b64_tr_b16 v[28:29], v123 offset:0
    ds_read_b64_tr_b16 v[30:31], v123 offset:512
    s_waitcnt lgkmcnt(6)
    v_mfma_f32_16x16x32_bf16 v[64:67], v[48:51], v[40:43], v[64:67]
    v_mfma_f32_16x16x32_bf16 v[68:71], v[48:51], v[44:47], v[68:71]
    v_mfma_f32_16x16x32_bf16 v[72:75], v[52:55], v[40:43], v[72:75]
    v_mfma_f32_16x16x32_bf16 v[76:79], v[52:55], v[44:47], v[76:79]
    ds_read_b128 v[40:43], v121 offset:0
    ds_read_b128 v[44:47], v121 offset:2048
    ds_read_b64_tr_b16 v[48:49], v122 offset:4096
    ds_read_b64_tr_b16 v[50:51], v122 offset:4608
    ds_read_b64_tr_b16 v[52:53], v123 offset:4096
    ds_read_b64_tr_b16 v[54:55], v123 offset:4608
    s_waitcnt lgkmcnt(6)
    v_mfma_f32_16x16x32_bf16 v[64:67], v[24:27], v[16:19], v[64:67]
    v_mfma_f32_16x16x32_bf16 v[68:71], v[24:27], v[20:23], v[68:71]
    v_mfma_f32_16x16x32_bf16 v[72:75], v[28:31], v[16:19], v[72:75]
    v_mfma_f32_16x16x32_bf16 v[76:79], v[28:31], v[20:23], v[76:79]
    ds_read_b128 v[16:19], v120 offset:16384
    ds_read_b128 v[20:23], v120 offset:18432
    ds_read_b64_tr_b16 v[24:25], v122 offset:16384
    ds_read_b64_tr_b16 v[26:27], v122 offset:16896
    ds_read_b64_tr_b16 v[28:29], v123 offset:16384
    ds_read_b64_tr_b16 v[30:31], v123 offset:16896
    s_waitcnt lgkmcnt(6)
    v_mfma_f32_16x16x32_bf16 v[64:67], v[48:51], v[40:43], v[64:67]
    v_mfma_f32_16x16x32_bf16 v[68:71], v[48:51], v[44:47], v[68:71]
    v_mfma_f32_16x16x32_bf16 v[72:75], v[52:55], v[40:43], v[72:75]
    v_mfma_f32_16x16x32_bf16 v[76:79], v[52:55], v[44:47], v[76:79]
    ds_read_b128 v[40:43], v121 offset:16384
    ds_read_b128 v[44:47], v121 offset:18432
    ds_read_b64_tr_b16 v[48:49], v122 offset:20480
    ds_read_b64_tr_b16 v[50:51], v122 offset:20992
    ds_read_b64_tr_b16 v[52:53], v123 offset:20480
    ds_read_b64_tr_b16 v[54:55], v123 offset:20992
    s_waitcnt lgkmcnt(6)
    v_mfma_f32_16x16x32_bf16 v[64:67], v[24:27], v[16:19], v[64:67]
    v_mfma_f32_16x16x32_bf16 v[68:71], v[24:27], v[20:23], v[68:71]
    v_mfma_f32_16x16x32_bf16 v[72:75], v[28:31], v[16:19], v[72:75]
    v_mfma_f32_16x16x32_bf16 v[76:79], v[28:31], v[20:23], v[76:79]
    s_waitcnt vmcnt(8)
    s_barrier
    s_add_u32 m0, s56, 32768
    s_nop 0
    buffer_load_dwordx4 v112, s[12:15], s52 offen lds
    s_add_u32 s52, s52, s45
    s_add_u32 m0, s57, 32768
    s_nop 0
    buffer_load_dwordx4 v113, s[12:15], s53 offen lds
    s_add_u32 s53, s53, s45
    s_add_u32 m0, s58, 32768
    s_nop 0
    buffer_load_dwordx4 v112, s[12:15], s54 offen lds
    s_add_u32 s54, s54, s45
    s_add_u32 m0, s59, 32768
    s_nop 0
    buffer_load_dwordx4 v113, s[12:15], s55 offen lds
    s_add_u32 s55, s55, s45
    s_add_u32 m0, s56, 49152
    s_nop 0
    buffer_load_dwordx4 v112, s[12:15], s52 offen lds
    s_add_u32 s52, s52, s45
    s_add_u32 m0, s57, 49152
    s_nop 0
    buffer_load_dwordx4 v113, s[12:15], s53 offen lds
    s_add_u32 s53, s53, s45
    s_add_u32 m0, s58, 49152
    s_nop 0
    buffer_load_dwordx4 v112, s[12:15], s54 offen lds
    s_add_u32 s54, s54, s45
    s_add_u32 m0, s59, 49152
    s_nop 0
    buffer_load_dwordx4 v113, s[12:15], s55 offen lds
    s_add_u32 s55, s55, s45
    ds_read_b128 v[16:19], v120 offset:32768
    ds_read_b128 v[20:23], v120 offset:34816
    ds_read_b64_tr_b16 v[24:25], v122 offset:32768
    ds_read_b64_tr_b16 v[26:27], v122 offset:33280
    ds_read_b64_tr_b16 v[28:29], v123 offset:32768
    ds_read_b64_tr_b16 v[30:31], v123 offset:33280
    s_waitcnt lgkmcnt(6)
    v_mfma_f32_16x16x32_bf16 v[64:67], v[48:51], v[40:43], v[64:67]
    v_mfma_f32_16x16x32_bf16 v[68:71], v[48:51], v[44:47], v[68:71]
    v_mfma_f32_16x16x32_bf16 v[72:75], v[52:55], v[40:43], v[72:75]
    v_mfma_f32_16x16x32_bf16 v[76:79], v[52:55], v[44:47], v[76:79]
    ds_read_b128 v[40:43], v121 offset:32768
    ds_read_b128 v[44:47], v121 offset:34816
    ds_read_b64_tr_b16 v[48:49], v122 offset:36864
    ds_read_b64_tr_b16 v[50:51], v122 offset:37376
    ds_read_b64_tr_b16 v[52:53], v123 offset:36864
    ds_read_b64_tr_b16 v[54:55], v123 offset:37376
    s_waitcnt lgkmcnt(6)
    v_mfma_f32_16x16x32_bf16 v[64:67], v[24:27], v[16:19], v[64:67]
    v_mfma_f32_16x16x32_bf16 v[68:71], v[24:27], v[20:23], v[68:71]
    v_mfma_f32_16x16x32_bf16 v[72:75], v[28:31], v[16:19], v[72:75]
    v_mfma_f32_16x16x32_bf16 v[76:79], v[28:31], v[20:23], v[76:79]
    ds_read_b128 v[16:19], v120 offset:49152
    ds_read_b128 v[20:23], v120 offset:51200
    ds_read_b64_tr_b16 v[24:25], v122 offset:49152
    ds_read_b64_tr_b16 v[26:27], v122 offset:49664
    ds_read_b64_tr_b16 v[28:29], v123 offset:49152
    ds_read_b64_tr_b16 v[30:31], v123 offset:49664
    s_waitcnt lgkmcnt(6)
    v_mfma_f32_16x16x32_bf16 v[64:67], v[48:51], v[40:43], v[64:67]
    v_mfma_f32_16x16x32_bf16 v[68:71], v[48:51], v[44:47], v[68:71]
    v_mfma_f32_16x16x32_bf16 v[72:75], v[52:55], v[40:43], v[72:75]
    v_mfma_f32_16x16x32_bf16 v[76:79], v[52:55], v[44:47], v[76:79]
    ds_read_b128 v[40:43], v121 offset:49152
    ds_read_b128 v[44:47], v121 offset:51200
    ds_read_b64_tr_b16 v[48:49], v122 offset:53248
    ds_read_b64_tr_b16 v[50:51], v122 offset:53760
    ds_read_b64_tr_b16 v[52:53], v123 offset:53248
    ds_read_b64_tr_b16 v[54:55], v123 offset:53760
    s_waitcnt lgkmcnt(6)
    v_mfma_f32_16x16x32_bf16 v[64:67], v[24:27], v[16:19], v[64:67]
    v_mfma_f32_16x16x32_bf16 v[68:71], v[24:27], v[20:23], v[68:71]
    v_mfma_f32_16x16x32_bf16 v[72:75], v[28:31], v[16:19], v[72:75]
    v_mfma_f32_16x16x32_bf16 v[76:79], v[28:31], v[20:23], v[76:79]
    s_waitcnt vmcnt(8)
    s_barrier
    s_add_u32 m0, s56, 65536
    s_nop 0
    buffer_load_dwordx4 v112, s[12:15], s52 offen lds
    s_add_u32 s52, s52, s45
    s_add_u32 m0, s57, 65536
    s_nop 0
    buffer_load_dwordx4 v113, s[12:15], s53 offen lds
    s_add_u32 s53, s53, s45
    s_add_u32 m0, s58, 65536
    s_nop 0
    buffer_load_dwordx4 v112, s[12:15], s54 offen lds
    s_add_u32 s54, s54, s45
    s_add_u32 m0, s59, 65536
    s_nop 0
    buffer_load_dwordx4 v113, s[12:15], s55 offen lds
    s_add_u32 s55, s55, s45
    s_add_u32 m0, s56, 81920
    s_nop 0
    buffer_load_dwordx4 v112, s[12:15], s52 offen lds
    s_add_u32 s52, s52, s45
    s_add_u32 m0, s57, 81920
    s_nop 0
    buffer_load_dwordx4 v113, s[12:15], s53 offen lds
    s_add_u32 s53, s53, s45
    s_add_u32 m0, s58, 81920
    s_nop 0
    buffer_load_dwordx4 v112, s[12:15], s54 offen lds
    s_add_u32 s54, s54, s45
    s_add_u32 m0, s59, 81920
    s_nop 0
    buffer_load_dwordx4 v113, s[12:15], s55 offen lds
    s_add_u32 s55, s55, s45
    ds_read_b128 v[16:19], v114 offset:0
    ds_read_b128 v[20:23], v114 offset:2048
    ds_read_b64_tr_b16 v[24:25], v116 offset:0
    ds_read_b64_tr_b16 v[26:27], v116 offset:512
    ds_read_b64_tr_b16 v[28:29], v117 offset:0
    ds_read_b64_tr_b16 v[30:31], v117 offset:512
    s_waitcnt lgkmcnt(6)
    v_mfma_f32_16x16x32_bf16 v[64:67], v[48:51], v[40:43], v[64:67]
    v_mfma_f32_16x16x32_bf16 v[68:71], v[48:51], v[44:47], v[68:71]
    v_mfma_f32_16x16x32_bf16 v[72:75], v[52:55], v[40:43], v[72:75]
    v_mfma_f32_16x16x32_bf16 v[76:79], v[52:55], v[44:47], v[76:79]
    ds_read_b128 v[40:43], v115 offset:0
    ds_read_b128 v[44:47], v115 offset:2048
    ds_read_b64_tr_b16 v[48:49], v116 offset:4096
    ds_read_b64_tr_b16 v[50:51], v116 offset:4608
    ds_read_b64_tr_b16 v[52:53], v117 offset:4096
    ds_read_b64_tr_b16 v[54:55], v117 offset:4608
    s_waitcnt lgkmcnt(6)
    v_mfma_f32_16x16x32_bf16 v[64:67], v[24:27], v[16:19], v[64:67]
    v_mfma_f32_16x16x32_bf16 v[68:71], v[24:27], v[20:23], v[68:71]
    v_mfma_f32_16x16x32_bf16 v[72:75], v[28:31], v[16:19], v[72:75]
    v_mfma_f32_16x16x32_bf16 v[76:79], v[28:31], v[20:23], v[76:79]
    ds_read_b128 v[16:19], v114 offset:16384
    ds_read_b128 v[20:23], v114 offset:18432
    ds_read_b64_tr_b16 v[24:25], v116 offset:16384
    ds_read_b64_tr_b16 v[26:27], v116 offset:16896
    ds_read_b64_tr_b16 v[28:29], v117 offset:16384
    ds_read_b64_tr_b16 v[30:31], v117 offset:16896
    s_waitcnt lgkmcnt(6)
    v_mfma_f32_16x16x32_bf16 v[64:67], v[48:51], v[40:43], v[64:67]
    v_mfma_f32_16x16x32_bf16 v[68:71], v[48:51], v[44:47], v[68:71]
    v_mfma_f32_16x16x32_bf16 v[72:75], v[52:55], v[40:43], v[72:75]
    v_mfma_f32_16x16x32_bf16 v[76:79], v[52:55], v[44:47], v[76:79]
    ds_read_b128 v[40:43], v115 offset:16384
    ds_read_b128 v[44:47], v115 offset:18432
    ds_read_b64_tr_b16 v[48:49], v116 offset:20480
    ds_read_b64_tr_b16 v[50:51], v116 offset:20992
    ds_read_b64_tr_b16 v[52:53], v117 offset:20480
    ds_read_b64_tr_b16 v[54:55], v117 offset:20992
    s_waitcnt lgkmcnt(6)
    v_mfma_f32_16x16x32_bf16 v[64:67], v[24:27], v[16:19], v[64:67]
    v_mfma_f32_16x16x32_bf16 v[68:71], v[24:27], v[20:23], v[68:71]
    v_mfma_f32_16x16x32_bf16 v[72:75], v[28:31], v[16:19], v[72:75]
    v_mfma_f32_16x16x32_bf16 v[76:79], v[28:31], v[20:23], v[76:79]
    s_waitcnt vmcnt(8)
    s_barrier
    s_add_u32 m0, s56, 98304
    s_nop 0
    buffer_load_dwordx4 v112, s[12:15], s52 offen lds
    s_add_u32 s52, s52, s45
    s_add_u32 m0, s57, 98304
    s_nop 0
    buffer_load_dwordx4 v113, s[12:15], s53 offen lds
    s_add_u32 s53, s53, s45
    s_add_u32 m0, s58, 98304
    s_nop 0
    buffer_load_dwordx4 v112, s[12:15], s54 offen lds
    s_add_u32 s54, s54, s45
    s_add_u32 m0, s59, 98304
    s_nop 0
    buffer_load_dwordx4 v113, s[12:15], s55 offen lds
    s_add_u32 s55, s55, s45
    s_add_u32 m0, s56, 114688
    s_nop 0
    buffer_load_dwordx4 v112, s[12:15], s52 offen lds
    s_add_u32 s52, s52, s45
    s_add_u32 m0, s57, 114688
    s_nop 0
    buffer_load_dwordx4 v113, s[12:15], s53 offen lds
    s_add_u32 s53, s53, s45
    s_add_u32 m0, s58, 114688
    s_nop 0
    buffer_load_dwordx4 v112, s[12:15], s54 offen lds
    s_add_u32 s54, s54, s45
    s_add_u32 m0, s59, 114688
    s_nop 0
    buffer_load_dwordx4 v113, s[12:15], s55 offen lds
    s_add_u32 s55, s55, s45
    ds_read_b128 v[16:19], v114 offset:32768
    ds_read_b128 v[20:23], v114 offset:34816
    ds_read_b64_tr_b16 v[24:25], v116 offset:32768
    ds_read_b64_tr_b16 v[26:27], v116 offset:33280
    ds_read_b64_tr_b16 v[28:29], v117 offset:32768
    ds_read_b64_tr_b16 v[30:31], v117 offset:33280
    s_waitcnt lgkmcnt(6)
    v_mfma_f32_16x16x32_bf16 v[64:67], v[48:51], v[40:43], v[64:67]
    v_mfma_f32_16x16x32_bf16 v[68:71], v[48:51], v[44:47], v[68:71]
    v_mfma_f32_16x16x32_bf16 v[72:75], v[52:55], v[40:43], v[72:75]
    v_mfma_f32_16x16x32_bf16 v[76:79], v[52:55], v[44:47], v[76:79]
    ds_read_b128 v[40:43], v115 offset:32768
    ds_read_b128 v[44:47], v115 offset:34816
    ds_read_b64_tr_b16 v[48:49], v116 offset:36864
    ds_read_b64_tr_b16 v[50:51], v116 offset:37376
    ds_read_b64_tr_b16 v[52:53], v117 offset:36864
    ds_read_b64_tr_b16 v[54:55], v117 offset:37376
    s_waitcnt lgkmcnt(6)
    v_mfma_f32_16x16x32_bf16 v[64:67], v[24:27], v[16:19], v[64:67]
    v_mfma_f32_16x16x32_bf16 v[68:71], v[24:27], v[20:23], v[68:71]
    v_mfma_f32_16x16x32_bf16 v[72:75], v[28:31], v[16:19], v[72:75]
    v_mfma_f32_16x16x32_bf16 v[76:79], v[28:31], v[20:23], v[76:79]
    ds_read_b128 v[16:19], v114 offset:49152
    ds_read_b128 v[20:23], v114 offset:51200
    ds_read_b64_tr_b16 v[24:25], v116 offset:49152
    ds_read_b64_tr_b16 v[26:27], v116 offset:49664
    ds_read_b64_tr_b16 v[28:29], v117 offset:49152
    ds_read_b64_tr_b16 v[30:31], v117 offset:49664
    s_waitcnt lgkmcnt(6)
    v_mfma_f32_16x16x32_bf16 v[64:67], v[48:51], v[40:43], v[64:67]
    v_mfma_f32_16x16x32_bf16 v[68:71], v[48:51], v[44:47], v[68:71]
    v_mfma_f32_16x16x32_bf16 v[72:75], v[52:55], v[40:43], v[72:75]
    v_mfma_f32_16x16x32_bf16 v[76:79], v[52:55], v[44:47], v[76:79]
    ds_read_b128 v[40:43], v115 offset:49152
    ds_read_b128 v[44:47], v115 offset:51200
    ds_read_b64_tr_b16 v[48:49], v116 offset:53248
    ds_read_b64_tr_b16 v[50:51], v116 offset:53760
    ds_read_b64_tr_b16 v[52:53], v117 offset:53248
    ds_read_b64_tr_b16 v[54:55], v117 offset:53760
    s_waitcnt lgkmcnt(6)
    v_mfma_f32_16x16x32_bf16 v[64:67], v[24:27], v[16:19], v[64:67]
    v_mfma_f32_16x16x32_bf16 v[68:71], v[24:27], v[20:23], v[68:71]
    v_mfma_f32_16x16x32_bf16 v[72:75], v[28:31], v[16:19], v[72:75]
    v_mfma_f32_16x16x32_bf16 v[76:79], v[28:31], v[20:23], v[76:79]
    s_waitcnt vmcnt(8)
    s_barrier
    s_add_u32 m0, s56, 0
    s_nop 0
    buffer_load_dwordx4 v112, s[12:15], s52 offen lds
    s_add_u32 s52, s52, s45
    s_add_u32 m0, s57, 0
    s_nop 0
    buffer_load_dwordx4 v113, s[12:15], s53 offen lds
    s_add_u32 s53, s53, s45
    s_add_u32 m0, s58, 0
    s_nop 0
    buffer_load_dwordx4 v112, s[12:15], s54 offen lds
    s_add_u32 s54, s54, s45
    s_add_u32 m0, s59, 0
    s_nop 0
    buffer_load_dwordx4 v113, s[12:15], s55 offen lds
    s_add_u32 s55, s55, s45
    s_add_u32 m0, s56, 16384
    s_nop 0
    buffer_load_dwordx4 v112, s[12:15], s52 offen lds
    s_add_u32 s52, s52, s45
    s_add_u32 m0, s57, 16384
    s_nop 0
    buffer_load_dwordx4 v113, s[12:15], s53 offen lds
    s_add_u32 s53, s53, s45
    s_add_u32 m0, s58, 16384
    s_nop 0
    buffer_load_dwordx4 v112, s[12:15], s54 offen lds
    s_add_u32 s54, s54, s45
    s_add_u32 m0, s59, 16384
    s_nop 0
    buffer_load_dwordx4 v113, s[12:15], s55 offen lds
    s_add_u32 s55, s55, s45
    ds_read_b128 v[16:19], v120 offset:0
    ds_read_b128 v[20:23], v120 offset:2048
    ds_read_b64_tr_b16 v[24:25], v122 offset:0
    ds_read_b64_tr_b16 v[26:27], v122 offset:512
    ds_read_b64_tr_b16 v[28:29], v123 offset:0
    ds_read_b64_tr_b16 v[30:31], v123 offset:512
    s_waitcnt lgkmcnt(6)
    v_mfma_f32_16x16x32_bf16 v[64:67], v[48:51], v[40:43], v[64:67]
    v_mfma_f32_16x16x32_bf16 v[68:71], v[48:51], v[44:47], v[68:71]
    v_mfma_f32_16x16x32_bf16 v[72:75], v[52:55], v[40:43], v[72:75]
    v_mfma_f32_16x16x32_bf16 v[76:79], v[52:55], v[44:47], v[76:79]
    ds_read_b128 v[40:43], v121 offset:0
    ds_read_b128 v[44:47], v121 offset:2048
    ds_read_b64_tr_b16 v[48:49], v122 offset:4096
    ds_read_b64_tr_b16 v[50:51], v122 offset:4608
    ds_read_b64_tr_b16 v[52:53], v123 offset:4096
    ds_read_b64_tr_b16 v[54:55], v123 offset:4608
    s_waitcnt lgkmcnt(6)
    v_mfma_f32_16x16x32_bf16 v[64:67], v[24:27], v[16:19], v[64:67]
    v_mfma_f32_16x16x32_bf16 v[68:71], v[24:27], v[20:23], v[68:71]
    v_mfma_f32_16x16x32_bf16 v[72:75], v[28:31], v[16:19], v[72:75]
    v_mfma_f32_16x16x32_bf16 v[76:79], v[28:31], v[20:23], v[76:79]
    ds_read_b128 v[16:19], v120 offset:16384
    ds_read_b128 v[20:23], v120 offset:18432
    ds_read_b64_tr_b16 v[24:25], v122 offset:16384
    ds_read_b64_tr_b16 v[26:27], v122 offset:16896
    ds_read_b64_tr_b16 v[28:29], v123 offset:16384
    ds_read_b64_tr_b16 v[30:31], v123 offset:16896
    s_waitcnt lgkmcnt(6)
    v_mfma_f32_16x16x32_bf16 v[64:67], v[48:51], v[40:43], v[64:67]
    v_mfma_f32_16x16x32_bf16 v[68:71], v[48:51], v[44:47], v[68:71]
    v_mfma_f32_16x16x32_bf16 v[72:75], v[52:55], v[40:43], v[72:75]
    v_mfma_f32_16x16x32_bf16 v[76:79], v[52:55], v[44:47], v[76:79]
    ds_read_b128 v[40:43], v121 offset:16384
    ds_read_b128 v[44:47], v121 offset:18432
    ds_read_b64_tr_b16 v[48:49], v122 offset:20480
    ds_read_b64_tr_b16 v[50:51], v122 offset:20992
    ds_read_b64_tr_b16 v[52:53], v123 offset:20480
    ds_read_b64_tr_b16 v[54:55], v123 offset:20992
    s_waitcnt lgkmcnt(6)
    v_mfma_f32_16x16x32_bf16 v[64:67], v[24:27], v[16:19], v[64:67]
    v_mfma_f32_16x16x32_bf16 v[68:71], v[24:27], v[20:23], v[68:71]
    v_mfma_f32_16x16x32_bf16 v[72:75], v[28:31], v[16:19], v[72:75]
    v_mfma_f32_16x16x32_bf16 v[76:79], v[28:31], v[20:23], v[76:79]
    s_waitcnt vmcnt(8)
    s_barrier
    s_add_u32 m0, s56, 32768
    s_nop 0
    buffer_load_dwordx4 v112, s[12:15], s52 offen lds
    s_add_u32 s52, s52, s45
    s_add_u32 m0, s57, 32768
    s_nop 0
    buffer_load_dwordx4 v113, s[12:15], s53 offen lds
    s_add_u32 s53, s53, s45
    s_add_u32 m0, s58, 32768
    s_nop 0
    buffer_load_dwordx4 v112, s[12:15], s54 offen lds
    s_add_u32 s54, s54, s45
    s_add_u32 m0, s59, 32768
    s_nop 0
    buffer_load_dwordx4 v113, s[12:15], s55 offen lds
    s_add_u32 s55, s55, s45
    s_add_u32 m0, s56, 49152
    s_nop 0
    buffer_load_dwordx4 v112, s[12:15], s52 offen lds
    s_add_u32 s52, s52, s45
    s_add_u32 m0, s57, 49152
    s_nop 0
    buffer_load_dwordx4 v113, s[12:15], s53 offen lds
    s_add_u32 s53, s53, s45
    s_add_u32 m0, s58, 49152
    s_nop 0
    buffer_load_dwordx4 v112, s[12:15], s54 offen lds
    s_add_u32 s54, s54, s45
    s_add_u32 m0, s59, 49152
    s_nop 0
    buffer_load_dwordx4 v113, s[12:15], s55 offen lds
    s_add_u32 s55, s55, s45
    ds_read_b128 v[16:19], v120 offset:32768
    ds_read_b128 v[20:23], v120 offset:34816
    ds_read_b64_tr_b16 v[24:25], v122 offset:32768
    ds_read_b64_tr_b16 v[26:27], v122 offset:33280
    ds_read_b64_tr_b16 v[28:29], v123 offset:32768
    ds_read_b64_tr_b16 v[30:31], v123 offset:33280
    s_waitcnt lgkmcnt(6)
    v_mfma_f32_16x16x32_bf16 v[64:67], v[48:51], v[40:43], v[64:67]
    v_mfma_f32_16x16x32_bf16 v[68:71], v[48:51], v[44:47], v[68:71]
    v_mfma_f32_16x16x32_bf16 v[72:75], v[52:55], v[40:43], v[72:75]
    v_mfma_f32_16x16x32_bf16 v[76:79], v[52:55], v[44:47], v[76:79]
    ds_read_b128 v[40:43], v121 offset:32768
    ds_read_b128 v[44:47], v121 offset:34816
    ds_read_b64_tr_b16 v[48:49], v122 offset:36864
    ds_read_b64_tr_b16 v[50:51], v122 offset:37376
    ds_read_b64_tr_b16 v[52:53], v123 offset:36864
    ds_read_b64_tr_b16 v[54:55], v123 offset:37376
    s_waitcnt lgkmcnt(6)
    v_mfma_f32_16x16x32_bf16 v[64:67], v[24:27], v[16:19], v[64:67]
    v_mfma_f32_16x16x32_bf16 v[68:71], v[24:27], v[20:23], v[68:71]
    v_mfma_f32_16x16x32_bf16 v[72:75], v[28:31], v[16:19], v[72:75]
    v_mfma_f32_16x16x32_bf16 v[76:79], v[28:31], v[20:23], v[76:79]
    ds_read_b128 v[16:19], v120 offset:49152
    ds_read_b128 v[20:23], v120 offset:51200
    ds_read_b64_tr_b16 v[24:25], v122 offset:49152
    ds_read_b64_tr_b16 v[26:27], v122 offset:49664
    ds_read_b64_tr_b16 v[28:29], v123 offset:49152
    ds_read_b64_tr_b16 v[30:31], v123 offset:49664
    s_waitcnt lgkmcnt(6)
    v_mfma_f32_16x16x32_bf16 v[64:67], v[48:51], v[40:43], v[64:67]
    v_mfma_f32_16x16x32_bf16 v[68:71], v[48:51], v[44:47], v[68:71]
    v_mfma_f32_16x16x32_bf16 v[72:75], v[52:55], v[40:43], v[72:75]
    v_mfma_f32_16x16x32_bf16 v[76:79], v[52:55], v[44:47], v[76:79]
    ds_read_b128 v[40:43], v121 offset:49152
    ds_read_b128 v[44:47], v121 offset:51200
    ds_read_b64_tr_b16 v[48:49], v122 offset:53248
    ds_read_b64_tr_b16 v[50:51], v122 offset:53760
    ds_read_b64_tr_b16 v[52:53], v123 offset:53248
    ds_read_b64_tr_b16 v[54:55], v123 offset:53760
    s_waitcnt lgkmcnt(6)
    v_mfma_f32_16x16x32_bf16 v[64:67], v[24:27], v[16:19], v[64:67]
    v_mfma_f32_16x16x32_bf16 v[68:71], v[24:27], v[20:23], v[68:71]
    v_mfma_f32_16x16x32_bf16 v[72:75], v[28:31], v[16:19], v[72:75]
    v_mfma_f32_16x16x32_bf16 v[76:79], v[28:31], v[20:23], v[76:79]
    s_waitcnt vmcnt(8)
    s_barrier
    ds_read_b128 v[16:19], v114 offset:0
    ds_read_b128 v[20:23], v114 offset:2048
    ds_read_b64_tr_b16 v[24:25], v116 offset:0
    ds_read_b64_tr_b16 v[26:27], v116 offset:512
    ds_read_b64_tr_b16 v[28:29], v117 offset:0
    ds_read_b64_tr_b16 v[30:31], v117 offset:512
    s_waitcnt lgkmcnt(6)
    v_mfma_f32_16x16x32_bf16 v[64:67], v[48:51], v[40:43], v[64:67]
    v_mfma_f32_16x16x32_bf16 v[68:71], v[48:51], v[44:47], v[68:71]
    v_mfma_f32_16x16x32_bf16 v[72:75], v[52:55], v[40:43], v[72:75]
    v_mfma_f32_16x16x32_bf16 v[76:79], v[52:55], v[44:47], v[76:79]
    ds_read_b128 v[40:43], v115 offset:0
    ds_read_b128 v[44:47], v115 offset:2048
    ds_read_b64_tr_b16 v[48:49], v116 offset:4096
    ds_read_b64_tr_b16 v[50:51], v116 offset:4608
    ds_read_b64_tr_b16 v[52:53], v117 offset:4096
    ds_read_b64_tr_b16 v[54:55], v117 offset:4608
    s_waitcnt lgkmcnt(6)
    v_mfma_f32_16x16x32_bf16 v[64:67], v[24:27], v[16:19], v[64:67]
    v_mfma_f32_16x16x32_bf16 v[68:71], v[24:27], v[20:23], v[68:71]
    v_mfma_f32_16x16x32_bf16 v[72:75], v[28:31], v[16:19], v[72:75]
    v_mfma_f32_16x16x32_bf16 v[76:79], v[28:31], v[20:23], v[76:79]
    ds_read_b128 v[16:19], v114 offset:16384
    ds_read_b128 v[20:23], v114 offset:18432
    ds_read_b64_tr_b16 v[24:25], v116 offset:16384
    ds_read_b64_tr_b16 v[26:27], v116 offset:16896
    ds_read_b64_tr_b16 v[28:29], v117 offset:16384
    ds_read_b64_tr_b16 v[30:31], v117 offset:16896
    s_waitcnt lgkmcnt(6)
    v_mfma_f32_16x16x32_bf16 v[64:67], v[48:51], v[40:43], v[64:67]
    v_mfma_f32_16x16x32_bf16 v[68:71], v[48:51], v[44:47], v[68:71]
    v_mfma_f32_16x16x32_bf16 v[72:75], v[52:55], v[40:43], v[72:75]
    v_mfma_f32_16x16x32_bf16 v[76:79], v[52:55], v[44:47], v[76:79]
    ds_read_b128 v[40:43], v115 offset:16384
    ds_read_b128 v[44:47], v115 offset:18432
    ds_read_b64_tr_b16 v[48:49], v116 offset:20480
    ds_read_b64_tr_b16 v[50:51], v116 offset:20992
    ds_read_b64_tr_b16 v[52:53], v117 offset:20480
    ds_read_b64_tr_b16 v[54:55], v117 offset:20992
    s_waitcnt lgkmcnt(6)
    v_mfma_f32_16x16x32_bf16 v[64:67], v[24:27], v[16:19], v[64:67]
    v_mfma_f32_16x16x32_bf16 v[68:71], v[24:27], v[20:23], v[68:71]
    v_mfma_f32_16x16x32_bf16 v[72:75], v[28:31], v[16:19], v[72:75]
    v_mfma_f32_16x16x32_bf16 v[76:79], v[28:31], v[20:23], v[76:79]
    s_waitcnt vmcnt(0)
    s_barrier
    ds_read_b128 v[16:19], v114 offset:32768
    ds_read_b128 v[20:23], v114 offset:34816
    ds_read_b64_tr_b16 v[24:25], v116 offset:32768
    ds_read_b64_tr_b16 v[26:27], v116 offset:33280
    ds_read_b64_tr_b16 v[28:29], v117 offset:32768
    ds_read_b64_tr_b16 v[30:31], v117 offset:33280
    s_waitcnt lgkmcnt(6)
    v_mfma_f32_16x16x32_bf16 v[64:67], v[48:51], v[40:43], v[64:67]
    v_mfma_f32_16x16x32_bf16 v[68:71], v[48:51], v[44:47], v[68:71]
    v_mfma_f32_16x16x32_bf16 v[72:75], v[52:55], v[40:43], v[72:75]
    v_mfma_f32_16x16x32_bf16 v[76:79], v[52:55], v[44:47], v[76:79]
    ds_read_b128 v[40:43], v115 offset:32768
    ds_read_b128 v[44:47], v115 offset:34816
    ds_read_b64_tr_b16 v[48:49], v116 offset:36864
    ds_read_b64_tr_b16 v[50:51], v116 offset:37376
    ds_read_b64_tr_b16 v[52:53], v117 offset:36864
    ds_read_b64_tr_b16 v[54:55], v117 offset:37376
    s_waitcnt lgkmcnt(6)
    v_mfma_f32_16x16x32_bf16 v[64:67], v[24:27], v[16:19], v[64:67]
    v_mfma_f32_16x16x32_bf16 v[68:71], v[24:27], v[20:23], v[68:71]
    v_mfma_f32_16x16x32_bf16 v[72:75], v[28:31], v[16:19], v[72:75]
    v_mfma_f32_16x16x32_bf16 v[76:79], v[28:31], v[20:23], v[76:79]
    ds_read_b128 v[16:19], v114 offset:49152
    ds_read_b128 v[20:23], v114 offset:51200
    ds_read_b64_tr_b16 v[24:25], v116 offset:49152
    ds_read_b64_tr_b16 v[26:27], v116 offset:49664
    ds_read_b64_tr_b16 v[28:29], v117 offset:49152
    ds_read_b64_tr_b16 v[30:31], v117 offset:49664
    s_waitcnt lgkmcnt(6)
    v_mfma_f32_16x16x32_bf16 v[64:67], v[48:51], v[40:43], v[64:67]
    v_mfma_f32_16x16x32_bf16 v[68:71], v[48:51], v[44:47], v[68:71]
    v_mfma_f32_16x16x32_bf16 v[72:75], v[52:55], v[40:43], v[72:75]
    v_mfma_f32_16x16x32_bf16 v[76:79], v[52:55], v[44:47], v[76:79]
    ds_read_b128 v[40:43], v115 offset:49152
    ds_read_b128 v[44:47], v115 offset:51200
    ds_read_b64_tr_b16 v[48:49], v116 offset:53248
    ds_read_b64_tr_b16 v[50:51], v116 offset:53760
    ds_read_b64_tr_b16 v[52:53], v117 offset:53248
    ds_read_b64_tr_b16 v[54:55], v117 offset:53760
    s_waitcnt lgkmcnt(6)
    v_mfma_f32_16x16x32_bf16 v[64:67], v[24:27], v[16:19], v[64:67]
    v_mfma_f32_16x16x32_bf16 v[68:71], v[24:27], v[20:23], v[68:71]
    v_mfma_f32_16x16x32_bf16 v[72:75], v[28:31], v[16:19], v[72:75]
    v_mfma_f32_16x16x32_bf16 v[76:79], v[28:31], v[20:23], v[76:79]
    s_waitcnt lgkmcnt(0)
    v_mfma_f32_16x16x32_bf16 v[64:67], v[48:51], v[40:43], v[64:67]
    v_mfma_f32_16x16x32_bf16 v[68:71], v[48:51], v[44:47], v[68:71]
    v_mfma_f32_16x16x32_bf16 v[72:75], v[52:55], v[40:43], v[72:75]
    v_mfma_f32_16x16x32_bf16 v[76:79], v[52:55], v[44:47], v[76:79]
    s_waitcnt vmcnt(0)
    v_lshlrev_b32 v96, 16, v80
    v_and_b32 v97, 0xffff0000, v80
    v_lshlrev_b32 v98, 16, v81
    v_and_b32 v99, 0xffff0000, v81
    v_fma_f32 v96, v88, v64, v96
    v_fma_f32 v97, v89, v65, v97
    v_fma_f32 v98, v90, v66, v98
    v_fma_f32 v99, v91, v67, v99
    v_cvt_pk_bf16_f32 v80, v96, v97
    v_cvt_pk_bf16_f32 v81, v98, v99
    s_mov_b32 s47, 0
    buffer_store_dwordx2 v[80:81], v118, s[28:31], s47 offen offset:0
    v_lshlrev_b32 v100, 16, v84
    v_and_b32 v101, 0xffff0000, v84
    v_lshlrev_b32 v102, 16, v85
    v_and_b32 v103, 0xffff0000, v85
    v_fma_f32 v100, v92, v72, v100
    v_fma_f32 v101, v93, v73, v101
    v_fma_f32 v102, v94, v74, v102
    v_fma_f32 v103, v95, v75, v103
    v_cvt_pk_bf16_f32 v84, v100, v101
    v_cvt_pk_bf16_f32 v85, v102, v103
    s_mov_b32 s47, 0
    buffer_store_dwordx2 v[84:85], v118, s[28:31], s47 offen offset:32
    v_lshlrev_b32 v96, 16, v82
    v_and_b32 v97, 0xffff0000, v82
    v_lshlrev_b32 v98, 16, v83
    v_and_b32 v99, 0xffff0000, v83
    v_fma_f32 v96, v88, v68, v96
    v_fma_f32 v97, v89, v69, v97
    v_fma_f32 v98, v90, v70, v98
    v_fma_f32 v99, v91, v71, v99
    v_cvt_pk_bf16_f32 v82, v96, v97
    v_cvt_pk_bf16_f32 v83, v98, v99
    s_mov_b32 s47, 16384
    buffer_store_dwordx2 v[82:83], v118, s[28:31], s47 offen offset:0
    v_lshlrev_b32 v100, 16, v86
    v_and_b32 v101, 0xffff0000, v86
    v_lshlrev_b32 v102, 16, v87
    v_and_b32 v103, 0xffff0000, v87
    v_fma_f32 v100, v92, v76, v100
    v_fma_f32 v101, v93, v77, v101
    v_fma_f32 v102, v94, v78, v102
    v_fma_f32 v103, v95, v79, v103
    v_cvt_pk_bf16_f32 v86, v100, v101
    v_cvt_pk_bf16_f32 v87, v102, v103
    s_mov_b32 s47, 16384
    buffer_store_dwordx2 v[86:87], v118, s[28:31], s47 offen offset:32
k4_kernel_end:
    s_endpgm
.section .rodata,"a"
.p2align 6
.amdhsa_kernel k0_kernel
  .amdhsa_next_free_vgpr 128
  .amdhsa_next_free_sgpr 100
  .amdhsa_accum_offset 128
  .amdhsa_group_segment_fixed_size 0
  .amdhsa_kernarg_size 96
  .amdhsa_user_sgpr_count 2
  .amdhsa_user_sgpr_kernarg_segment_ptr 1
  .amdhsa_system_sgpr_workgroup_id_x 1
.end_amdhsa_kernel
.p2align 6
.amdhsa_kernel k1_kernel
  .amdhsa_next_free_vgpr 216
  .amdhsa_next_free_sgpr 100
  .amdhsa_accum_offset 216
  .amdhsa_group_segment_fixed_size 0
  .amdhsa_kernarg_size 96
  .amdhsa_user_sgpr_count 2
  .amdhsa_user_sgpr_kernarg_segment_ptr 1
  .amdhsa_system_sgpr_workgroup_id_x 1
.end_amdhsa_kernel
.p2align 6
.amdhsa_kernel k2_kernel
  .amdhsa_next_free_vgpr 128
  .amdhsa_next_free_sgpr 100
  .amdhsa_accum_offset 128
  .amdhsa_group_segment_fixed_size 0
  .amdhsa_kernarg_size 96
  .amdhsa_user_sgpr_count 2
  .amdhsa_user_sgpr_kernarg_segment_ptr 1
  .amdhsa_system_sgpr_workgroup_id_x 1
.end_amdhsa_kernel
.p2align 6
.amdhsa_kernel k3_kernel
  .amdhsa_next_free_vgpr 248
  .amdhsa_next_free_sgpr 100
  .amdhsa_accum_offset 248
  .amdhsa_group_segment_fixed_size 0
  .amdhsa_kernarg_size 96
  .amdhsa_user_sgpr_count 2
  .amdhsa_user_sgpr_kernarg_segment_ptr 1
  .amdhsa_system_sgpr_workgroup_id_x 1
.end_amdhsa_kernel
.p2align 6
.amdhsa_kernel k4_kernel
  .amdhsa_next_free_vgpr 128
  .amdhsa_next_free_sgpr 100
  .amdhsa_accum_offset 128
  .amdhsa_group_segment_fixed_size 0
  .amdhsa_kernarg_size 96
  .amdhsa_user_sgpr_count 2
  .amdhsa_user_sgpr_kernarg_segment_ptr 1
  .amdhsa_system_sgpr_workgroup_id_x 1
.end_amdhsa_kernel
.p2align 6
```
